```python
import torch

def _softmax(x, axis=-1):
    return torch.softmax(x, dim=axis)

def _gelu(x):
    return torch.nn.functional.gelu(x, approximate='tanh')

def _silu(x):
    return torch.nn.functional.silu(x)

def _sigmoid(x):
    return torch.sigmoid(x)

def _layernorm(x, axis=-1, eps=1e-05):
    m = x.mean(dim=axis, keepdim=True)
    v = x.var(dim=axis, keepdim=True, unbiased=False)
    return (x - m) / torch.sqrt(v + eps)

def _scatter_add(tgt, idx, src, axis=0):
    return tgt.clone().index_add_(axis, idx, src)

def _segment_sum(src, seg, n):
    out = torch.zeros((n,) + src.shape[1:], dtype=src.dtype)
    return out.index_add_(0, seg, src)

def _pad(x, pw):
    flat = tuple((v for pair in reversed(pw) for v in pair))
    return torch.nn.functional.pad(x, flat)
kernel_name = 'recurrent_scan__memory_aug_recurrent_mem_tr__geglu_ffn__prompt'

def setup_inputs():

    _w = lambda a: (lambda t: t.to(torch.bfloat16) if t.is_floating_point() else t)(torch.as_tensor(a))

    def _A_setup():
        B, S, Dm = (1, 2048, 512)
        H, Dh = (32, 128)
        M, seg = (8, 32)
        seg = min(seg, S)
        S = S // seg * seg
        return {'x': _w((lambda *s: torch.randn(*s, dtype=torch.bfloat16) * 0.05)(B, S, Dm)), 'mem0': _w((lambda *s: torch.randn(*s, dtype=torch.bfloat16) * 0.2)(B, M, Dm)), 'Wq': _w((lambda *s: torch.randn(*s, dtype=torch.bfloat16) * 1.6)(Dm, H, Dh) * Dm ** (-0.5)), 'Wk': _w((lambda *s: torch.randn(*s, dtype=torch.bfloat16) * 1.6)(Dm, H, Dh) * Dm ** (-0.5)), 'Wv': _w((lambda *s: torch.randn(*s, dtype=torch.bfloat16) * 0.2)(Dm, H, Dh) * Dm ** (-0.5)), 'Wo': _w((lambda *s: torch.randn(*s, dtype=torch.bfloat16) * 0.2)(H, Dh, Dm) * (H * Dh) ** (-0.5)), 'seg_len': seg}
    _A_in = _A_setup()

    def _B_setup():
        B, S, D, F = (1, 2048, 512, 1376)
        return {'x': _w((lambda *s: torch.randn(*s, dtype=torch.bfloat16) * 0.05)(B, S, D)), 'w_gate': _w((lambda *s: torch.randn(*s, dtype=torch.bfloat16) * 0.1)(D, F)), 'w_up': _w((lambda *s: torch.randn(*s, dtype=torch.bfloat16) * 0.1)(D, F)), 'w_down': _w((lambda *s: torch.randn(*s, dtype=torch.bfloat16) * 0.1)(F, D))}
    _B_in = _B_setup()
    return {'A_x': _A_in['x'], 'A_mem0': _A_in['mem0'], 'A_Wq': _A_in['Wq'], 'A_Wk': _A_in['Wk'], 'A_Wv': _A_in['Wv'], 'A_Wo': _A_in['Wo'], 'A_seg_len': _A_in['seg_len'], 'B_x': _B_in['x'], 'B_w_gate': _B_in['w_gate'], 'B_w_up': _B_in['w_up'], 'B_w_down': _B_in['w_down']}

def reference(A_x, A_mem0, A_Wq, A_Wk, A_Wv, A_Wo, A_seg_len, B_x, B_w_gate, B_w_up, B_w_down):

    def _A_ref(x, mem0, Wq, Wk, Wv, Wo, seg_len):
        B, S, Dm = x.shape
        H, Dh = (Wq.shape[1], Wq.shape[2])
        M = mem0.shape[1]
        scale = Dh ** (-0.5)
        n_seg = S // seg_len
        L = M + seg_len
        idx = torch.arange(L)
        mask = (idx[:, None] < M) | (idx[:, None] >= idx[None, :])
        mem = mem0
        outs = []
        for s in range(n_seg):
            xs = x[:, s * seg_len:(s + 1) * seg_len, :].clone()
            h = torch.concatenate([mem, xs], axis=1)
            q = torch.einsum('btd,dhe->bhte', h, Wq)
            k = torch.einsum('btd,dhe->bhte', h, Wk)
            v = torch.einsum('btd,dhe->bhte', h, Wv)
            scores = torch.einsum('bhqe,bhke->bhqk', q, k) * scale
            scores = torch.where(mask[None, None], scores, -1000000000.0)
            p = _softmax(scores, axis=-1)
            o = torch.einsum('bhqk,bhke->bhqe', p, v)
            o = torch.einsum('bhte,hed->btd', o, Wo)
            mem = o[:, :M, :].clone()
            outs.append(o[:, M:, :])
        return torch.concatenate(outs, axis=1)

    def _B_ref(x, w_gate, w_up, w_down):
        return _gelu(x @ w_gate) * (x @ w_up) @ w_down
    x = A_x
    xn = _layernorm(x, axis=-1)
    s = _A_ref(xn, A_mem0, A_Wq, A_Wk, A_Wv, A_Wo, A_seg_len)
    g = _silu(_B_ref(xn, B_w_gate, B_w_up, B_w_down))
    return x + s * g
```

```asm
; @launch grid=(256,1,1) block=(256,1,1) lds=163840
.amdgcn_target "amdgcn-amd-amdhsa--gfx950"
.text
.globl recurrent_scan__memory_aug_recurrent_mem_tr__geglu_ffn__prompt_kernel
.p2align 8
.type recurrent_scan__memory_aug_recurrent_mem_tr__geglu_ffn__prompt_kernel,@function
recurrent_scan__memory_aug_recurrent_mem_tr__geglu_ffn__prompt_kernel:
    s_cmp_ge_u32 s2, 256
    s_cbranch_scc1 L_exit
    s_load_dwordx16 s[16:31], s[0:1], 0
    s_load_dwordx8 s[32:39], s[0:1], 64
    s_load_dwordx4 s[40:43], s[0:1], 96
    s_getreg_b32 s44, hwreg(HW_REG_XCC_ID, 0, 3)
    s_xor_b32 s44, s44, 3
    v_lshrrev_b32 v1, 6, v0
    s_mov_b32 s3, 0
    s_mov_b32 s12, 4290772927
    s_mov_b32 s13, 4290772927
    v_readfirstlane_b32 s46, v1
    s_waitcnt lgkmcnt(0)
    s_mov_b32 s4, s42
    s_mov_b32 s5, s43
    s_mov_b32 s6, 268435456
    s_mov_b32 s7, 0x20000
    s_cmp_lg_u32 s46, 0
    s_cbranch_scc1 L_asked
    s_lshl_b32 s47, s44, 4
    s_cmp_lt_u32 s44, 2
    s_cselect_b32 s48, 0, 128
    s_add_u32 s47, s47, s48
    v_mov_b32 v1, s47
    v_mov_b32 v2, 1
    s_mov_b64 exec, 1
    global_atomic_add v3, v1, v2, s[40:41] sc0
    s_mov_b64 exec, -1
L_asked:
    s_cmp_lg_u32 s46, 0
    s_cbranch_scc1 L_ticket
    s_waitcnt vmcnt(0)
L_got:
    v_mov_b32 v1, 0
    s_mov_b64 exec, 1
    ds_write_b32 v1, v3
    s_waitcnt lgkmcnt(0)
    s_mov_b64 exec, -1
L_ticket:
    s_barrier
    v_mov_b32 v1, 0
    ds_read_b32 v3, v1
    s_waitcnt lgkmcnt(0)
    v_readfirstlane_b32 s45, v3
    s_barrier
    s_and_b32 s45, s45, 31
    s_cmp_eq_u32 s44, 0
    s_cbranch_scc1 L_chain
    s_add_u32 s51, s45, 192
    s_cmp_eq_u32 s44, 1
    s_cbranch_scc1 L_wi
    s_sub_u32 s47, s44, 2
    s_min_u32 s48, s47, 2
    s_mul_i32 s48, s48, 5
    s_mul_i32 s49, s47, 25
    s_add_u32 s49, s49, s48
    s_cmp_lt_u32 s47, 2
    s_cselect_b32 s50, 30, 25
    s_add_u32 s51, s49, s45
    s_cmp_lt_u32 s45, s50
    s_cbranch_scc1 L_wi
    s_lshl_b32 s51, s47, 5
    s_sub_u32 s51, s51, s49
    s_add_u32 s51, s51, s45
    s_sub_u32 s51, s51, s50
    s_add_u32 s51, s51, 160
L_wi:
    s_cmp_ge_u32 s51, 160
    s_cbranch_scc1 L_ffn
    s_mul_i32 s54, s51, 52429
    s_lshr_b32 s54, s54, 18
    s_mul_i32 s47, s54, 5
    s_sub_u32 s53, s51, s47
    s_lshl_b32 s52, s54, 8
    s_add_u32 s59, s52, 1048576
    s_mov_b32 s8, s26
    s_mov_b32 s9, s27
    s_mov_b32 s10, 4194304
    s_mov_b32 s11, 0x20000
    v_min_u32 v126, 207, v0
    v_lshlrev_b32 v126, 7, v126
    s_mul_i32 s49, s51, 26624
    buffer_load_dword v127, v126, s[8:11], s49 offen
    s_sub_u32 s47, s44, 2
    s_cselect_b32 s47, 64, s47
    v_mov_b32 v11, 0
    v_mul_u32_u24 v10, 6, v0
    v_add_u32 v10, s47, v10
    v_cmp_gt_u32 vcc, 64, v10
    v_lshlrev_b32 v10, 7, v10
    s_lshl_b32 s48, s45, 2
    s_add_u32 s48, s48, 1064960
    v_mov_b32 v12, 0x40000000
    v_cndmask_b32 v10, v12, v10, vcc
    buffer_store_dword v11, v10, s[4:7], s48 offen sc1
    v_mov_b32 v11, 0
    v_mul_u32_u24 v10, 5, v0
    v_add_u32 v10, s53, v10
    v_cmp_gt_u32 vcc, 64, v10
    v_lshlrev_b32 v10, 2, v10
    v_mov_b32 v12, 0x40000000
    v_cndmask_b32 v10, v12, v10, vcc
    buffer_store_dword v11, v10, s[4:7], s59 offen sc1
    v_and_b32 v4, 63, v0
    v_lshlrev_b32 v1, 4, v4
    v_mov_b32 v2, v1
    s_lshl_b32 s61, s46, 13
    s_add_u32 s56, s61, 4194304
    s_mov_b32 s60, -1
    s_mov_b32 s55, s53
    v_bfe_u32 v5, v0, 4, 1
    v_mul_u32_u24 v8, 4096, v5
    v_bfe_u32 v5, v0, 5, 1
    v_lshl_add_u32 v8, v5, 8, v8
    v_and_b32 v5, 15, v0
    v_lshl_add_u32 v8, v5, 4, v8
    s_lshl_b32 s47, s46, 10
    v_add_u32 v8, s47, v8
    v_bfe_u32 v5, v0, 4, 1
    v_lshlrev_b32 v9, 10, v5
    v_bfe_u32 v5, v0, 5, 1
    v_lshl_add_u32 v9, v5, 9, v9
    v_and_b32 v5, 15, v0
    v_lshl_add_u32 v9, v5, 4, v9
    s_lshl_b32 s47, s46, 11
    s_add_u32 s47, s47, 8192
    v_add_u32 v9, s47, v9
    v_lshlrev_b32 v3, 4, v0
    v_mov_b64 v[104:105], s[12:13]
    v_mov_b64 v[106:107], s[12:13]
    v_and_b32 v4, 63, v0
    v_lshrrev_b32 v5, 4, v4
    v_and_b32 v6, 15, v4
    v_lshlrev_b32 v7, 2, v5
    v_xor_b32 v6, v6, v7
    v_lshlrev_b32 v13, 4, v6
    s_lshl_b32 s47, s46, 4
    v_add_u32 v6, s47, v5
    v_mul_u32_u24 v6, 8192, v6
    v_add3_u32 v13, v13, v6, s52
    v_bfe_u32 v6, v4, 2, 2
    v_xor_b32 v7, s46, v6
    v_lshlrev_b32 v7, 6, v7
    v_lshl_add_u32 v7, v6, 8, v7
    v_lshrrev_b32 v6, 5, v4
    v_lshl_add_u32 v7, v6, 11, v7
    v_add_u32 v7, 65536, v7
    v_and_b32 v5, 1, v5
    v_and_b32 v6, 3, v4
    v_lshl_add_u32 v15, v5, 5, v7
    v_lshl_add_u32 v15, v6, 3, v15
    v_lshl_add_u32 v14, v5, 4, v7
    v_and_b32 v6, 1, v4
    v_lshl_add_u32 v14, v6, 3, v14
    v_bfe_u32 v6, v4, 1, 1
    v_lshl_add_u32 v14, v6, 5, v14
    s_lshl_b32 s50, s46, 12
    s_add_u32 s50, s50, 65536
    s_mov_b32 s8, s22
    s_mov_b32 s9, s23
    s_mov_b32 s10, 4194304
    s_mov_b32 s11, 0x20000
    s_add_u32 m0, s50, 0
    s_mov_b32 s47, 0
    buffer_load_dwordx4 v13, s[8:11], s47 offen lds
    s_add_u32 m0, s50, 1024
    s_mov_b32 s47, 32768
    buffer_load_dwordx4 v13, s[8:11], s47 offen lds
    s_add_u32 m0, s50, 2048
    s_mov_b32 s47, 65536
    buffer_load_dwordx4 v13, s[8:11], s47 offen lds
    s_add_u32 m0, s50, 3072
    s_mov_b32 s47, 98304
    buffer_load_dwordx4 v13, s[8:11], s47 offen lds
    s_add_u32 m0, s50, 16384
    s_mov_b32 s47, 524288
    buffer_load_dwordx4 v13, s[8:11], s47 offen lds
    s_add_u32 m0, s50, 17408
    s_mov_b32 s47, 557056
    buffer_load_dwordx4 v13, s[8:11], s47 offen lds
    s_add_u32 m0, s50, 18432
    s_mov_b32 s47, 589824
    buffer_load_dwordx4 v13, s[8:11], s47 offen lds
    s_add_u32 m0, s50, 19456
    s_mov_b32 s47, 622592
    buffer_load_dwordx4 v13, s[8:11], s47 offen lds
    s_add_u32 m0, s50, 32768
    s_mov_b32 s47, 1048576
    buffer_load_dwordx4 v13, s[8:11], s47 offen lds
    s_add_u32 m0, s50, 33792
    s_mov_b32 s47, 1081344
    buffer_load_dwordx4 v13, s[8:11], s47 offen lds
    s_add_u32 m0, s50, 34816
    s_mov_b32 s47, 1114112
    buffer_load_dwordx4 v13, s[8:11], s47 offen lds
    s_add_u32 m0, s50, 35840
    s_mov_b32 s47, 1146880
    buffer_load_dwordx4 v13, s[8:11], s47 offen lds
    s_waitcnt vmcnt(8) lgkmcnt(0)
    s_barrier
    s_cmp_lg_u32 s46, 0
    s_cbranch_scc1 L_qkv_in
    v_mov_b32 v10, 8
    v_mov_b32 v11, 1
    s_mov_b64 exec, 1
    global_atomic_add v10, v11, s[40:41]
    s_mov_b64 exec, -1
L_qkv_in:
    s_add_u32 m0, s50, 49152
    s_mov_b32 s47, 1572864
    buffer_load_dwordx4 v13, s[8:11], s47 offen lds
    s_add_u32 m0, s50, 50176
    s_mov_b32 s47, 1605632
    buffer_load_dwordx4 v13, s[8:11], s47 offen lds
    s_add_u32 m0, s50, 51200
    s_mov_b32 s47, 1638400
    buffer_load_dwordx4 v13, s[8:11], s47 offen lds
    s_add_u32 m0, s50, 52224
    s_mov_b32 s47, 1671168
    buffer_load_dwordx4 v13, s[8:11], s47 offen lds
    ds_read_b64_tr_b16 a[0:1], v14 offset:0
    ds_read_b64_tr_b16 a[2:3], v14 offset:1024
    ds_read_b64_tr_b16 a[4:5], v14 offset:4096
    ds_read_b64_tr_b16 a[6:7], v14 offset:5120
    ds_read_b64_tr_b16 a[8:9], v14 offset:8192
    ds_read_b64_tr_b16 a[10:11], v14 offset:9216
    ds_read_b64_tr_b16 a[12:13], v14 offset:12288
    ds_read_b64_tr_b16 a[14:15], v14 offset:13312
    s_waitcnt vmcnt(8) lgkmcnt(0)
    s_barrier
    s_add_u32 m0, s50, 0
    s_mov_b32 s47, 2097152
    buffer_load_dwordx4 v13, s[8:11], s47 offen lds
    s_add_u32 m0, s50, 1024
    s_mov_b32 s47, 2129920
    buffer_load_dwordx4 v13, s[8:11], s47 offen lds
    s_add_u32 m0, s50, 2048
    s_mov_b32 s47, 2162688
    buffer_load_dwordx4 v13, s[8:11], s47 offen lds
    s_add_u32 m0, s50, 3072
    s_mov_b32 s47, 2195456
    buffer_load_dwordx4 v13, s[8:11], s47 offen lds
    ds_read_b64_tr_b16 a[16:17], v14 offset:16384
    ds_read_b64_tr_b16 a[18:19], v14 offset:17408
    ds_read_b64_tr_b16 a[20:21], v14 offset:20480
    ds_read_b64_tr_b16 a[22:23], v14 offset:21504
    ds_read_b64_tr_b16 a[24:25], v14 offset:24576
    ds_read_b64_tr_b16 a[26:27], v14 offset:25600
    ds_read_b64_tr_b16 a[28:29], v14 offset:28672
    ds_read_b64_tr_b16 a[30:31], v14 offset:29696
    s_waitcnt vmcnt(8) lgkmcnt(0)
    s_barrier
    s_add_u32 m0, s50, 16384
    s_mov_b32 s47, 2621440
    buffer_load_dwordx4 v13, s[8:11], s47 offen lds
    s_add_u32 m0, s50, 17408
    s_mov_b32 s47, 2654208
    buffer_load_dwordx4 v13, s[8:11], s47 offen lds
    s_add_u32 m0, s50, 18432
    s_mov_b32 s47, 2686976
    buffer_load_dwordx4 v13, s[8:11], s47 offen lds
    s_add_u32 m0, s50, 19456
    s_mov_b32 s47, 2719744
    buffer_load_dwordx4 v13, s[8:11], s47 offen lds
    ds_read_b64_tr_b16 a[32:33], v14 offset:32768
    ds_read_b64_tr_b16 a[34:35], v14 offset:33792
    ds_read_b64_tr_b16 a[36:37], v14 offset:36864
    ds_read_b64_tr_b16 a[38:39], v14 offset:37888
    ds_read_b64_tr_b16 a[40:41], v14 offset:40960
    ds_read_b64_tr_b16 a[42:43], v14 offset:41984
    ds_read_b64_tr_b16 a[44:45], v14 offset:45056
    ds_read_b64_tr_b16 a[46:47], v14 offset:46080
    s_waitcnt vmcnt(8) lgkmcnt(0)
    s_barrier
    s_add_u32 m0, s50, 32768
    s_mov_b32 s47, 3145728
    buffer_load_dwordx4 v13, s[8:11], s47 offen lds
    s_add_u32 m0, s50, 33792
    s_mov_b32 s47, 3178496
    buffer_load_dwordx4 v13, s[8:11], s47 offen lds
    s_add_u32 m0, s50, 34816
    s_mov_b32 s47, 3211264
    buffer_load_dwordx4 v13, s[8:11], s47 offen lds
    s_add_u32 m0, s50, 35840
    s_mov_b32 s47, 3244032
    buffer_load_dwordx4 v13, s[8:11], s47 offen lds
    ds_read_b64_tr_b16 a[48:49], v14 offset:49152
    ds_read_b64_tr_b16 a[50:51], v14 offset:50176
    ds_read_b64_tr_b16 a[52:53], v14 offset:53248
    ds_read_b64_tr_b16 a[54:55], v14 offset:54272
    ds_read_b64_tr_b16 a[56:57], v14 offset:57344
    ds_read_b64_tr_b16 a[58:59], v14 offset:58368
    ds_read_b64_tr_b16 a[60:61], v14 offset:61440
    ds_read_b64_tr_b16 a[62:63], v14 offset:62464
    s_waitcnt vmcnt(8) lgkmcnt(0)
    s_barrier
    s_add_u32 m0, s50, 49152
    s_mov_b32 s47, 3670016
    buffer_load_dwordx4 v13, s[8:11], s47 offen lds
    s_add_u32 m0, s50, 50176
    s_mov_b32 s47, 3702784
    buffer_load_dwordx4 v13, s[8:11], s47 offen lds
    s_add_u32 m0, s50, 51200
    s_mov_b32 s47, 3735552
    buffer_load_dwordx4 v13, s[8:11], s47 offen lds
    s_add_u32 m0, s50, 52224
    s_mov_b32 s47, 3768320
    buffer_load_dwordx4 v13, s[8:11], s47 offen lds
    ds_read_b64_tr_b16 a[64:65], v14 offset:0
    ds_read_b64_tr_b16 a[66:67], v14 offset:1024
    ds_read_b64_tr_b16 a[68:69], v14 offset:4096
    ds_read_b64_tr_b16 a[70:71], v14 offset:5120
    ds_read_b64_tr_b16 a[72:73], v14 offset:8192
    ds_read_b64_tr_b16 a[74:75], v14 offset:9216
    ds_read_b64_tr_b16 a[76:77], v14 offset:12288
    ds_read_b64_tr_b16 a[78:79], v14 offset:13312
    s_waitcnt vmcnt(8) lgkmcnt(0)
    s_barrier
    s_mov_b32 s8, s24
    s_mov_b32 s9, s25
    s_mov_b32 s10, 4194304
    s_mov_b32 s11, 0x20000
    s_add_u32 m0, s50, 0
    s_mov_b32 s47, 0
    buffer_load_dwordx4 v13, s[8:11], s47 offen lds
    s_add_u32 m0, s50, 1024
    s_mov_b32 s47, 32768
    buffer_load_dwordx4 v13, s[8:11], s47 offen lds
    s_add_u32 m0, s50, 2048
    s_mov_b32 s47, 65536
    buffer_load_dwordx4 v13, s[8:11], s47 offen lds
    s_add_u32 m0, s50, 3072
    s_mov_b32 s47, 98304
    buffer_load_dwordx4 v13, s[8:11], s47 offen lds
    ds_read_b64_tr_b16 a[80:81], v14 offset:16384
    ds_read_b64_tr_b16 a[82:83], v14 offset:17408
    ds_read_b64_tr_b16 a[84:85], v14 offset:20480
    ds_read_b64_tr_b16 a[86:87], v14 offset:21504
    ds_read_b64_tr_b16 a[88:89], v14 offset:24576
    ds_read_b64_tr_b16 a[90:91], v14 offset:25600
    ds_read_b64_tr_b16 a[92:93], v14 offset:28672
    ds_read_b64_tr_b16 a[94:95], v14 offset:29696
    s_waitcnt vmcnt(8) lgkmcnt(0)
    s_barrier
    s_add_u32 m0, s50, 16384
    s_mov_b32 s47, 524288
    buffer_load_dwordx4 v13, s[8:11], s47 offen lds
    s_add_u32 m0, s50, 17408
    s_mov_b32 s47, 557056
    buffer_load_dwordx4 v13, s[8:11], s47 offen lds
    s_add_u32 m0, s50, 18432
    s_mov_b32 s47, 589824
    buffer_load_dwordx4 v13, s[8:11], s47 offen lds
    s_add_u32 m0, s50, 19456
    s_mov_b32 s47, 622592
    buffer_load_dwordx4 v13, s[8:11], s47 offen lds
    ds_read_b64_tr_b16 a[96:97], v14 offset:32768
    ds_read_b64_tr_b16 a[98:99], v14 offset:33792
    ds_read_b64_tr_b16 a[100:101], v14 offset:36864
    ds_read_b64_tr_b16 a[102:103], v14 offset:37888
    ds_read_b64_tr_b16 a[104:105], v14 offset:40960
    ds_read_b64_tr_b16 a[106:107], v14 offset:41984
    ds_read_b64_tr_b16 a[108:109], v14 offset:45056
    ds_read_b64_tr_b16 a[110:111], v14 offset:46080
    s_waitcnt vmcnt(8) lgkmcnt(0)
    s_barrier
    s_add_u32 m0, s50, 32768
    s_mov_b32 s47, 1048576
    buffer_load_dwordx4 v13, s[8:11], s47 offen lds
    s_add_u32 m0, s50, 33792
    s_mov_b32 s47, 1081344
    buffer_load_dwordx4 v13, s[8:11], s47 offen lds
    s_add_u32 m0, s50, 34816
    s_mov_b32 s47, 1114112
    buffer_load_dwordx4 v13, s[8:11], s47 offen lds
    s_add_u32 m0, s50, 35840
    s_mov_b32 s47, 1146880
    buffer_load_dwordx4 v13, s[8:11], s47 offen lds
    ds_read_b64_tr_b16 a[112:113], v14 offset:49152
    ds_read_b64_tr_b16 a[114:115], v14 offset:50176
    ds_read_b64_tr_b16 a[116:117], v14 offset:53248
    ds_read_b64_tr_b16 a[118:119], v14 offset:54272
    ds_read_b64_tr_b16 a[120:121], v14 offset:57344
    ds_read_b64_tr_b16 a[122:123], v14 offset:58368
    ds_read_b64_tr_b16 a[124:125], v14 offset:61440
    ds_read_b64_tr_b16 a[126:127], v14 offset:62464
    s_waitcnt vmcnt(8) lgkmcnt(0)
    s_barrier
    s_add_u32 m0, s50, 49152
    s_mov_b32 s47, 1572864
    buffer_load_dwordx4 v13, s[8:11], s47 offen lds
    s_add_u32 m0, s50, 50176
    s_mov_b32 s47, 1605632
    buffer_load_dwordx4 v13, s[8:11], s47 offen lds
    s_add_u32 m0, s50, 51200
    s_mov_b32 s47, 1638400
    buffer_load_dwordx4 v13, s[8:11], s47 offen lds
    s_add_u32 m0, s50, 52224
    s_mov_b32 s47, 1671168
    buffer_load_dwordx4 v13, s[8:11], s47 offen lds
    ds_read_b64_tr_b16 a[128:129], v15 offset:0
    ds_read_b64_tr_b16 a[130:131], v15 offset:1024
    ds_read_b64_tr_b16 a[132:133], v15 offset:4096
    ds_read_b64_tr_b16 a[134:135], v15 offset:5120
    ds_read_b64_tr_b16 a[136:137], v15 offset:8192
    ds_read_b64_tr_b16 a[138:139], v15 offset:9216
    ds_read_b64_tr_b16 a[140:141], v15 offset:12288
    ds_read_b64_tr_b16 a[142:143], v15 offset:13312
    s_waitcnt vmcnt(8) lgkmcnt(0)
    s_barrier
    s_add_u32 m0, s50, 0
    s_mov_b32 s47, 2097152
    buffer_load_dwordx4 v13, s[8:11], s47 offen lds
    s_add_u32 m0, s50, 1024
    s_mov_b32 s47, 2129920
    buffer_load_dwordx4 v13, s[8:11], s47 offen lds
    s_add_u32 m0, s50, 2048
    s_mov_b32 s47, 2162688
    buffer_load_dwordx4 v13, s[8:11], s47 offen lds
    s_add_u32 m0, s50, 3072
    s_mov_b32 s47, 2195456
    buffer_load_dwordx4 v13, s[8:11], s47 offen lds
    ds_read_b64_tr_b16 a[144:145], v15 offset:16384
    ds_read_b64_tr_b16 a[146:147], v15 offset:17408
    ds_read_b64_tr_b16 a[148:149], v15 offset:20480
    ds_read_b64_tr_b16 a[150:151], v15 offset:21504
    ds_read_b64_tr_b16 a[152:153], v15 offset:24576
    ds_read_b64_tr_b16 a[154:155], v15 offset:25600
    ds_read_b64_tr_b16 a[156:157], v15 offset:28672
    ds_read_b64_tr_b16 a[158:159], v15 offset:29696
    s_waitcnt vmcnt(8) lgkmcnt(0)
    s_barrier
    s_cmp_lg_u32 s46, 0
    s_cbranch_scc1 L_qkv_ln_out
    v_mov_b32 v10, 132
L_qkv_ln:
    global_load_dword v11, v10, s[40:41] sc1
    s_add_u32 s3, s3, 1
    s_cmp_gt_u32 s3, 262144
    s_waitcnt vmcnt(0)
    s_cbranch_scc1 L_qkv_ln_out
    v_cmp_gt_u32 vcc, 64, v11
    s_cbranch_vccz L_qkv_ln_out
    s_sleep 8
    s_branch L_qkv_ln
L_qkv_ln_out:
    s_barrier
    s_lshl_b32 s49, s55, 15
    s_add_u32 s49, s49, s56
    s_add_u32 m0, s61, 0
    s_add_u32 s48, s49, 0
    buffer_load_dwordx4 v1, s[4:7], s48 offen offset:0 sc1 lds
    buffer_load_dwordx4 v1, s[4:7], s48 offen offset:1024 sc1 lds
    buffer_load_dwordx4 v1, s[4:7], s48 offen offset:2048 sc1 lds
    buffer_load_dwordx4 v1, s[4:7], s48 offen offset:3072 sc1 lds
    s_add_u32 m0, s61, 4096
    s_add_u32 s48, s49, 4096
    buffer_load_dwordx4 v1, s[4:7], s48 offen offset:0 sc1 lds
    buffer_load_dwordx4 v1, s[4:7], s48 offen offset:1024 sc1 lds
    buffer_load_dwordx4 v1, s[4:7], s48 offen offset:2048 sc1 lds
    buffer_load_dwordx4 v1, s[4:7], s48 offen offset:3072 sc1 lds
    s_xor_b32 s61, s61, 32768
    s_add_u32 m0, s50, 16384
    s_mov_b32 s47, 2621440
    buffer_load_dwordx4 v13, s[8:11], s47 offen lds
    s_add_u32 m0, s50, 17408
    s_mov_b32 s47, 2654208
    buffer_load_dwordx4 v13, s[8:11], s47 offen lds
    s_add_u32 m0, s50, 18432
    s_mov_b32 s47, 2686976
    buffer_load_dwordx4 v13, s[8:11], s47 offen lds
    s_add_u32 m0, s50, 19456
    s_mov_b32 s47, 2719744
    buffer_load_dwordx4 v13, s[8:11], s47 offen lds
    ds_read_b64_tr_b16 a[160:161], v15 offset:32768
    ds_read_b64_tr_b16 a[162:163], v15 offset:33792
    ds_read_b64_tr_b16 a[164:165], v15 offset:36864
    ds_read_b64_tr_b16 a[166:167], v15 offset:37888
    ds_read_b64_tr_b16 a[168:169], v15 offset:40960
    ds_read_b64_tr_b16 a[170:171], v15 offset:41984
    ds_read_b64_tr_b16 a[172:173], v15 offset:45056
    ds_read_b64_tr_b16 a[174:175], v15 offset:46080
    s_waitcnt vmcnt(8) lgkmcnt(0)
    s_barrier
    s_add_u32 m0, s50, 32768
    s_mov_b32 s47, 3145728
    buffer_load_dwordx4 v13, s[8:11], s47 offen lds
    s_add_u32 m0, s50, 33792
    s_mov_b32 s47, 3178496
    buffer_load_dwordx4 v13, s[8:11], s47 offen lds
    s_add_u32 m0, s50, 34816
    s_mov_b32 s47, 3211264
    buffer_load_dwordx4 v13, s[8:11], s47 offen lds
    s_add_u32 m0, s50, 35840
    s_mov_b32 s47, 3244032
    buffer_load_dwordx4 v13, s[8:11], s47 offen lds
    ds_read_b64_tr_b16 a[176:177], v15 offset:49152
    ds_read_b64_tr_b16 a[178:179], v15 offset:50176
    ds_read_b64_tr_b16 a[180:181], v15 offset:53248
    ds_read_b64_tr_b16 a[182:183], v15 offset:54272
    ds_read_b64_tr_b16 a[184:185], v15 offset:57344
    ds_read_b64_tr_b16 a[186:187], v15 offset:58368
    ds_read_b64_tr_b16 a[188:189], v15 offset:61440
    ds_read_b64_tr_b16 a[190:191], v15 offset:62464
    s_waitcnt vmcnt(8) lgkmcnt(0)
    s_barrier
    s_add_u32 m0, s50, 49152
    s_mov_b32 s47, 3670016
    buffer_load_dwordx4 v13, s[8:11], s47 offen lds
    s_add_u32 m0, s50, 50176
    s_mov_b32 s47, 3702784
    buffer_load_dwordx4 v13, s[8:11], s47 offen lds
    s_add_u32 m0, s50, 51200
    s_mov_b32 s47, 3735552
    buffer_load_dwordx4 v13, s[8:11], s47 offen lds
    s_add_u32 m0, s50, 52224
    s_mov_b32 s47, 3768320
    buffer_load_dwordx4 v13, s[8:11], s47 offen lds
    ds_read_b64_tr_b16 a[192:193], v15 offset:0
    ds_read_b64_tr_b16 a[194:195], v15 offset:1024
    ds_read_b64_tr_b16 a[196:197], v15 offset:4096
    ds_read_b64_tr_b16 a[198:199], v15 offset:5120
    ds_read_b64_tr_b16 a[200:201], v15 offset:8192
    ds_read_b64_tr_b16 a[202:203], v15 offset:9216
    ds_read_b64_tr_b16 a[204:205], v15 offset:12288
    ds_read_b64_tr_b16 a[206:207], v15 offset:13312
    s_waitcnt vmcnt(8) lgkmcnt(0)
    s_barrier
    s_mov_b32 s8, s20
    s_mov_b32 s9, s21
    s_mov_b32 s10, 4194304
    s_mov_b32 s11, 0x20000
    s_add_u32 m0, s50, 0
    s_mov_b32 s47, 0
    buffer_load_dwordx4 v13, s[8:11], s47 offen lds
    s_add_u32 m0, s50, 1024
    s_mov_b32 s47, 32768
    buffer_load_dwordx4 v13, s[8:11], s47 offen lds
    s_add_u32 m0, s50, 2048
    s_mov_b32 s47, 65536
    buffer_load_dwordx4 v13, s[8:11], s47 offen lds
    s_add_u32 m0, s50, 3072
    s_mov_b32 s47, 98304
    buffer_load_dwordx4 v13, s[8:11], s47 offen lds
    ds_read_b128 v[16:19], v2 offset:0
    ds_read_b128 v[20:23], v2 offset:1024
    ds_read_b128 v[24:27], v2 offset:2048
    s_waitcnt lgkmcnt(2)
    v_mfma_f32_32x32x16_bf16 v[32:47], a[0:3], v[16:19], 0
    ds_read_b128 v[28:31], v2 offset:3072
    v_mfma_f32_32x32x16_bf16 v[48:63], v[16:19], a[128:131], 0
    s_waitcnt lgkmcnt(2)
    v_mfma_f32_32x32x16_bf16 v[32:47], a[4:7], v[20:23], v[32:47]
    ds_read_b128 v[16:19], v2 offset:4096
    v_mfma_f32_32x32x16_bf16 v[48:63], v[20:23], a[132:135], v[48:63]
    s_waitcnt lgkmcnt(2)
    v_mfma_f32_32x32x16_bf16 v[32:47], a[8:11], v[24:27], v[32:47]
    ds_read_b128 v[20:23], v2 offset:5120
    v_mfma_f32_32x32x16_bf16 v[48:63], v[24:27], a[136:139], v[48:63]
    s_waitcnt lgkmcnt(2)
    v_mfma_f32_32x32x16_bf16 v[32:47], a[12:15], v[28:31], v[32:47]
    ds_read_b128 v[24:27], v2 offset:6144
    v_mfma_f32_32x32x16_bf16 v[48:63], v[28:31], a[140:143], v[48:63]
    s_waitcnt lgkmcnt(2)
    v_mfma_f32_32x32x16_bf16 v[32:47], a[16:19], v[16:19], v[32:47]
    ds_read_b128 v[28:31], v2 offset:7168
    v_mfma_f32_32x32x16_bf16 v[48:63], v[16:19], a[144:147], v[48:63]
    s_waitcnt lgkmcnt(2)
    v_mfma_f32_32x32x16_bf16 v[32:47], a[20:23], v[20:23], v[32:47]
    ds_read_b128 v[16:19], v2 offset:8192
    v_mfma_f32_32x32x16_bf16 v[48:63], v[20:23], a[148:151], v[48:63]
    s_waitcnt lgkmcnt(2)
    v_mfma_f32_32x32x16_bf16 v[32:47], a[24:27], v[24:27], v[32:47]
    ds_read_b128 v[20:23], v2 offset:9216
    v_mfma_f32_32x32x16_bf16 v[48:63], v[24:27], a[152:155], v[48:63]
    s_waitcnt lgkmcnt(2)
    v_mfma_f32_32x32x16_bf16 v[32:47], a[28:31], v[28:31], v[32:47]
    v_mfma_f32_32x32x16_bf16 v[48:63], v[28:31], a[156:159], v[48:63]
    s_waitcnt lgkmcnt(1)
    v_mfma_f32_32x32x16_bf16 v[32:47], a[32:35], v[16:19], v[32:47]
    v_mfma_f32_32x32x16_bf16 v[48:63], v[16:19], a[160:163], v[48:63]
    s_waitcnt lgkmcnt(0)
    v_mfma_f32_32x32x16_bf16 v[32:47], a[36:39], v[20:23], v[32:47]
    v_mfma_f32_32x32x16_bf16 v[48:63], v[20:23], a[164:167], v[48:63]
    ds_read_b64_tr_b16 a[208:209], v15 offset:16384
    ds_read_b64_tr_b16 a[210:211], v15 offset:17408
    ds_read_b64_tr_b16 a[212:213], v15 offset:20480
    ds_read_b64_tr_b16 a[214:215], v15 offset:21504
    ds_read_b64_tr_b16 a[216:217], v15 offset:24576
    ds_read_b64_tr_b16 a[218:219], v15 offset:25600
    ds_read_b64_tr_b16 a[220:221], v15 offset:28672
    ds_read_b64_tr_b16 a[222:223], v15 offset:29696
    s_waitcnt vmcnt(8) lgkmcnt(0)
    s_barrier
    s_add_u32 m0, s50, 16384
    s_mov_b32 s47, 524288
    buffer_load_dwordx4 v13, s[8:11], s47 offen lds
    s_add_u32 m0, s50, 17408
    s_mov_b32 s47, 557056
    buffer_load_dwordx4 v13, s[8:11], s47 offen lds
    s_add_u32 m0, s50, 18432
    s_mov_b32 s47, 589824
    buffer_load_dwordx4 v13, s[8:11], s47 offen lds
    s_add_u32 m0, s50, 19456
    s_mov_b32 s47, 622592
    buffer_load_dwordx4 v13, s[8:11], s47 offen lds
    ds_read_b128 v[24:27], v2 offset:10240
    ds_read_b128 v[28:31], v2 offset:11264
    ds_read_b128 v[16:19], v2 offset:12288
    s_waitcnt lgkmcnt(2)
    v_mfma_f32_32x32x16_bf16 v[32:47], a[40:43], v[24:27], v[32:47]
    ds_read_b128 v[20:23], v2 offset:13312
    v_mfma_f32_32x32x16_bf16 v[48:63], v[24:27], a[168:171], v[48:63]
    s_waitcnt lgkmcnt(2)
    v_mfma_f32_32x32x16_bf16 v[32:47], a[44:47], v[28:31], v[32:47]
    ds_read_b128 v[24:27], v2 offset:14336
    v_mfma_f32_32x32x16_bf16 v[48:63], v[28:31], a[172:175], v[48:63]
    s_waitcnt lgkmcnt(2)
    v_mfma_f32_32x32x16_bf16 v[32:47], a[48:51], v[16:19], v[32:47]
    ds_read_b128 v[28:31], v2 offset:15360
    v_mfma_f32_32x32x16_bf16 v[48:63], v[16:19], a[176:179], v[48:63]
    s_waitcnt lgkmcnt(2)
    v_mfma_f32_32x32x16_bf16 v[32:47], a[52:55], v[20:23], v[32:47]
    ds_read_b128 v[16:19], v2 offset:16384
    v_mfma_f32_32x32x16_bf16 v[48:63], v[20:23], a[180:183], v[48:63]
    s_waitcnt lgkmcnt(2)
    v_mfma_f32_32x32x16_bf16 v[32:47], a[56:59], v[24:27], v[32:47]
    ds_read_b128 v[20:23], v2 offset:17408
    v_mfma_f32_32x32x16_bf16 v[48:63], v[24:27], a[184:187], v[48:63]
    s_waitcnt lgkmcnt(2)
    v_mfma_f32_32x32x16_bf16 v[32:47], a[60:63], v[28:31], v[32:47]
    ds_read_b128 v[24:27], v2 offset:18432
    v_mfma_f32_32x32x16_bf16 v[48:63], v[28:31], a[188:191], v[48:63]
    s_waitcnt lgkmcnt(2)
    v_mfma_f32_32x32x16_bf16 v[32:47], a[64:67], v[16:19], v[32:47]
    ds_read_b128 v[28:31], v2 offset:19456
    v_mfma_f32_32x32x16_bf16 v[48:63], v[16:19], a[192:195], v[48:63]
    s_waitcnt lgkmcnt(2)
    v_mfma_f32_32x32x16_bf16 v[32:47], a[68:71], v[20:23], v[32:47]
    v_mfma_f32_32x32x16_bf16 v[48:63], v[20:23], a[196:199], v[48:63]
    s_waitcnt lgkmcnt(1)
    v_mfma_f32_32x32x16_bf16 v[32:47], a[72:75], v[24:27], v[32:47]
    v_mfma_f32_32x32x16_bf16 v[48:63], v[24:27], a[200:203], v[48:63]
    s_waitcnt lgkmcnt(0)
    v_mfma_f32_32x32x16_bf16 v[32:47], a[76:79], v[28:31], v[32:47]
    v_mfma_f32_32x32x16_bf16 v[48:63], v[28:31], a[204:207], v[48:63]
    ds_read_b64_tr_b16 a[224:225], v15 offset:32768
    ds_read_b64_tr_b16 a[226:227], v15 offset:33792
    ds_read_b64_tr_b16 a[228:229], v15 offset:36864
    ds_read_b64_tr_b16 a[230:231], v15 offset:37888
    ds_read_b64_tr_b16 a[232:233], v15 offset:40960
    ds_read_b64_tr_b16 a[234:235], v15 offset:41984
    ds_read_b64_tr_b16 a[236:237], v15 offset:45056
    ds_read_b64_tr_b16 a[238:239], v15 offset:46080
    s_waitcnt vmcnt(8) lgkmcnt(0)
    s_barrier
    s_add_u32 m0, s50, 32768
    s_mov_b32 s47, 1048576
    buffer_load_dwordx4 v13, s[8:11], s47 offen lds
    s_add_u32 m0, s50, 33792
    s_mov_b32 s47, 1081344
    buffer_load_dwordx4 v13, s[8:11], s47 offen lds
    s_add_u32 m0, s50, 34816
    s_mov_b32 s47, 1114112
    buffer_load_dwordx4 v13, s[8:11], s47 offen lds
    s_add_u32 m0, s50, 35840
    s_mov_b32 s47, 1146880
    buffer_load_dwordx4 v13, s[8:11], s47 offen lds
    ds_read_b128 v[16:19], v2 offset:20480
    ds_read_b128 v[20:23], v2 offset:21504
    ds_read_b128 v[24:27], v2 offset:22528
    s_waitcnt lgkmcnt(2)
    v_mfma_f32_32x32x16_bf16 v[32:47], a[80:83], v[16:19], v[32:47]
    ds_read_b128 v[28:31], v2 offset:23552
    v_mfma_f32_32x32x16_bf16 v[48:63], v[16:19], a[208:211], v[48:63]
    s_waitcnt lgkmcnt(2)
    v_mfma_f32_32x32x16_bf16 v[32:47], a[84:87], v[20:23], v[32:47]
    ds_read_b128 v[16:19], v2 offset:24576
    v_mfma_f32_32x32x16_bf16 v[48:63], v[20:23], a[212:215], v[48:63]
    s_waitcnt lgkmcnt(2)
    v_mfma_f32_32x32x16_bf16 v[32:47], a[88:91], v[24:27], v[32:47]
    ds_read_b128 v[20:23], v2 offset:25600
    v_mfma_f32_32x32x16_bf16 v[48:63], v[24:27], a[216:219], v[48:63]
    s_waitcnt lgkmcnt(2)
    v_mfma_f32_32x32x16_bf16 v[32:47], a[92:95], v[28:31], v[32:47]
    ds_read_b128 v[24:27], v2 offset:26624
    v_mfma_f32_32x32x16_bf16 v[48:63], v[28:31], a[220:223], v[48:63]
    s_waitcnt lgkmcnt(2)
    v_mfma_f32_32x32x16_bf16 v[32:47], a[96:99], v[16:19], v[32:47]
    ds_read_b128 v[28:31], v2 offset:27648
    v_mfma_f32_32x32x16_bf16 v[48:63], v[16:19], a[224:227], v[48:63]
    s_waitcnt lgkmcnt(2)
    v_mfma_f32_32x32x16_bf16 v[32:47], a[100:103], v[20:23], v[32:47]
    v_mfma_f32_32x32x16_bf16 v[48:63], v[20:23], a[228:231], v[48:63]
    s_waitcnt lgkmcnt(1)
    v_mfma_f32_32x32x16_bf16 v[32:47], a[104:107], v[24:27], v[32:47]
    v_mfma_f32_32x32x16_bf16 v[48:63], v[24:27], a[232:235], v[48:63]
    s_waitcnt lgkmcnt(0)
    v_mfma_f32_32x32x16_bf16 v[32:47], a[108:111], v[28:31], v[32:47]
    v_mfma_f32_32x32x16_bf16 v[48:63], v[28:31], a[236:239], v[48:63]
    ds_read_b64_tr_b16 a[240:241], v15 offset:49152
    ds_read_b64_tr_b16 a[242:243], v15 offset:50176
    ds_read_b64_tr_b16 a[244:245], v15 offset:53248
    ds_read_b64_tr_b16 a[246:247], v15 offset:54272
    ds_read_b64_tr_b16 a[248:249], v15 offset:57344
    ds_read_b64_tr_b16 a[250:251], v15 offset:58368
    ds_read_b64_tr_b16 a[252:253], v15 offset:61440
    ds_read_b64_tr_b16 a[254:255], v15 offset:62464
    s_waitcnt vmcnt(8) lgkmcnt(0)
    s_barrier
    ds_read_b128 v[16:19], v2 offset:28672
    ds_read_b128 v[20:23], v2 offset:29696
    ds_read_b128 v[24:27], v2 offset:30720
    s_waitcnt lgkmcnt(2)
    v_mfma_f32_32x32x16_bf16 v[32:47], a[112:115], v[16:19], v[32:47]
    ds_read_b128 v[28:31], v2 offset:31744
    v_mfma_f32_32x32x16_bf16 v[48:63], v[16:19], a[240:243], v[48:63]
    s_waitcnt lgkmcnt(2)
    v_mfma_f32_32x32x16_bf16 v[32:47], a[116:119], v[20:23], v[32:47]
    v_mfma_f32_32x32x16_bf16 v[48:63], v[20:23], a[244:247], v[48:63]
    s_waitcnt lgkmcnt(1)
    v_mfma_f32_32x32x16_bf16 v[32:47], a[120:123], v[24:27], v[32:47]
    v_mfma_f32_32x32x16_bf16 v[48:63], v[24:27], a[248:251], v[48:63]
    s_waitcnt lgkmcnt(0)
    v_mfma_f32_32x32x16_bf16 v[32:47], a[124:127], v[28:31], v[32:47]
    v_mfma_f32_32x32x16_bf16 v[48:63], v[28:31], a[252:255], v[48:63]
    s_nop 3
    s_lshl_b32 s57, s53, 5
    s_add_u32 s57, s57, s54
    s_lshl_b32 s67, s57, 12
    s_add_u32 s67, s67, 59768832
    s_lshl_b32 s58, s57, 13
    s_add_u32 s58, s58, 41943040
    s_lshl_b32 s57, s57, 14
    s_add_u32 s57, s57, 8388608
    v_cvt_pk_bf16_f32 v80, v32, v36
    v_cvt_pk_bf16_f32 v81, v33, v37
    v_cvt_pk_bf16_f32 v82, v34, v38
    v_cvt_pk_bf16_f32 v83, v35, v39
    v_cvt_pk_bf16_f32 v84, v40, v44
    v_cvt_pk_bf16_f32 v85, v41, v45
    v_cvt_pk_bf16_f32 v86, v42, v46
    v_cvt_pk_bf16_f32 v87, v43, v47
    v_cvt_pk_bf16_f32 v88, v48, v49
    v_cvt_pk_bf16_f32 v89, v56, v57
    v_cvt_pk_bf16_f32 v90, v52, v53
    v_cvt_pk_bf16_f32 v91, v60, v61
    v_cvt_pk_bf16_f32 v92, v50, v51
    v_cvt_pk_bf16_f32 v93, v58, v59
    v_cvt_pk_bf16_f32 v94, v54, v55
    v_cvt_pk_bf16_f32 v95, v62, v63
    buffer_store_dwordx4 v[80:83], v8, s[4:7], s57 offen offset:0 sc1
    buffer_store_dwordx4 v[84:87], v8, s[4:7], s57 offen offset:512 sc1
    buffer_store_dwordx4 v[88:91], v9, s[4:7], s57 offen offset:0 sc1
    buffer_store_dwordx4 v[92:95], v9, s[4:7], s57 offen offset:256 sc1
    buffer_store_dwordx4 v[104:107], v3, s[4:7], s67 offen sc1
    s_add_u32 m0, s50, 49152
    s_mov_b32 s47, 1572864
    buffer_load_dwordx4 v13, s[8:11], s47 offen lds
    s_add_u32 m0, s50, 50176
    s_mov_b32 s47, 1605632
    buffer_load_dwordx4 v13, s[8:11], s47 offen lds
    s_add_u32 m0, s50, 51200
    s_mov_b32 s47, 1638400
    buffer_load_dwordx4 v13, s[8:11], s47 offen lds
    s_add_u32 m0, s50, 52224
    s_mov_b32 s47, 1671168
    buffer_load_dwordx4 v13, s[8:11], s47 offen lds
    ds_read_b64_tr_b16 v[128:129], v14 offset:0
    ds_read_b64_tr_b16 v[130:131], v14 offset:1024
    ds_read_b64_tr_b16 v[132:133], v14 offset:4096
    ds_read_b64_tr_b16 v[134:135], v14 offset:5120
    ds_read_b64_tr_b16 v[136:137], v14 offset:8192
    ds_read_b64_tr_b16 v[138:139], v14 offset:9216
    ds_read_b64_tr_b16 v[140:141], v14 offset:12288
    ds_read_b64_tr_b16 v[142:143], v14 offset:13312
    s_waitcnt vmcnt(4) lgkmcnt(0)
    s_barrier
    s_lshl_b32 s48, s53, 2
    s_add_u32 s48, s48, s59
    s_cmp_lg_u32 s46, 0
    s_cbranch_scc1 L_qkv_ff
    v_mov_b32 v10, 0
    v_mov_b32 v11, 1
    s_mov_b64 exec, 1
    buffer_store_dword v11, v10, s[4:7], s48 offen sc1
    s_mov_b64 exec, -1
L_qkv_ff:
    s_mov_b32 s57, 0x40000000
    s_mov_b32 s67, 0x40000000
    s_add_u32 m0, s50, 0
    s_mov_b32 s47, 2097152
    buffer_load_dwordx4 v13, s[8:11], s47 offen lds
    s_add_u32 m0, s50, 1024
    s_mov_b32 s47, 2129920
    buffer_load_dwordx4 v13, s[8:11], s47 offen lds
    s_add_u32 m0, s50, 2048
    s_mov_b32 s47, 2162688
    buffer_load_dwordx4 v13, s[8:11], s47 offen lds
    s_add_u32 m0, s50, 3072
    s_mov_b32 s47, 2195456
    buffer_load_dwordx4 v13, s[8:11], s47 offen lds
    ds_read_b128 v[16:19], v2 offset:0
    ds_read_b128 v[20:23], v2 offset:1024
    ds_read_b128 v[24:27], v2 offset:2048
    s_waitcnt lgkmcnt(2)
    v_mfma_f32_32x32x16_bf16 v[64:79], v[128:131], v[16:19], 0
    ds_read_b128 v[28:31], v2 offset:3072
    s_waitcnt lgkmcnt(2)
    v_mfma_f32_32x32x16_bf16 v[64:79], v[132:135], v[20:23], v[64:79]
    s_waitcnt lgkmcnt(1)
    v_mfma_f32_32x32x16_bf16 v[64:79], v[136:139], v[24:27], v[64:79]
    s_waitcnt lgkmcnt(0)
    v_mfma_f32_32x32x16_bf16 v[64:79], v[140:143], v[28:31], v[64:79]
    ds_read_b64_tr_b16 v[144:145], v14 offset:16384
    ds_read_b64_tr_b16 v[146:147], v14 offset:17408
    ds_read_b64_tr_b16 v[148:149], v14 offset:20480
    ds_read_b64_tr_b16 v[150:151], v14 offset:21504
    ds_read_b64_tr_b16 v[152:153], v14 offset:24576
    ds_read_b64_tr_b16 v[154:155], v14 offset:25600
    ds_read_b64_tr_b16 v[156:157], v14 offset:28672
    ds_read_b64_tr_b16 v[158:159], v14 offset:29696
    s_waitcnt vmcnt(8) lgkmcnt(0)
    s_barrier
    s_add_u32 m0, s50, 16384
    s_mov_b32 s47, 2621440
    buffer_load_dwordx4 v13, s[8:11], s47 offen lds
    s_add_u32 m0, s50, 17408
    s_mov_b32 s47, 2654208
    buffer_load_dwordx4 v13, s[8:11], s47 offen lds
    s_add_u32 m0, s50, 18432
    s_mov_b32 s47, 2686976
    buffer_load_dwordx4 v13, s[8:11], s47 offen lds
    s_add_u32 m0, s50, 19456
    s_mov_b32 s47, 2719744
    buffer_load_dwordx4 v13, s[8:11], s47 offen lds
    ds_read_b128 v[16:19], v2 offset:4096
    ds_read_b128 v[20:23], v2 offset:5120
    ds_read_b128 v[24:27], v2 offset:6144
    s_waitcnt lgkmcnt(2)
    v_mfma_f32_32x32x16_bf16 v[64:79], v[144:147], v[16:19], v[64:79]
    ds_read_b128 v[28:31], v2 offset:7168
    s_waitcnt lgkmcnt(2)
    v_mfma_f32_32x32x16_bf16 v[64:79], v[148:151], v[20:23], v[64:79]
    s_waitcnt lgkmcnt(1)
    v_mfma_f32_32x32x16_bf16 v[64:79], v[152:155], v[24:27], v[64:79]
    s_waitcnt lgkmcnt(0)
    v_mfma_f32_32x32x16_bf16 v[64:79], v[156:159], v[28:31], v[64:79]
    ds_read_b64_tr_b16 v[160:161], v14 offset:32768
    ds_read_b64_tr_b16 v[162:163], v14 offset:33792
    ds_read_b64_tr_b16 v[164:165], v14 offset:36864
    ds_read_b64_tr_b16 v[166:167], v14 offset:37888
    ds_read_b64_tr_b16 v[168:169], v14 offset:40960
    ds_read_b64_tr_b16 v[170:171], v14 offset:41984
    ds_read_b64_tr_b16 v[172:173], v14 offset:45056
    ds_read_b64_tr_b16 v[174:175], v14 offset:46080
    s_waitcnt vmcnt(8) lgkmcnt(0)
    s_barrier
    s_add_u32 m0, s50, 32768
    s_mov_b32 s47, 3145728
    buffer_load_dwordx4 v13, s[8:11], s47 offen lds
    s_add_u32 m0, s50, 33792
    s_mov_b32 s47, 3178496
    buffer_load_dwordx4 v13, s[8:11], s47 offen lds
    s_add_u32 m0, s50, 34816
    s_mov_b32 s47, 3211264
    buffer_load_dwordx4 v13, s[8:11], s47 offen lds
    s_add_u32 m0, s50, 35840
    s_mov_b32 s47, 3244032
    buffer_load_dwordx4 v13, s[8:11], s47 offen lds
    ds_read_b128 v[16:19], v2 offset:8192
    ds_read_b128 v[20:23], v2 offset:9216
    ds_read_b128 v[24:27], v2 offset:10240
    s_waitcnt lgkmcnt(2)
    v_mfma_f32_32x32x16_bf16 v[64:79], v[160:163], v[16:19], v[64:79]
    ds_read_b128 v[28:31], v2 offset:11264
    s_waitcnt lgkmcnt(2)
    v_mfma_f32_32x32x16_bf16 v[64:79], v[164:167], v[20:23], v[64:79]
    s_waitcnt lgkmcnt(1)
    v_mfma_f32_32x32x16_bf16 v[64:79], v[168:171], v[24:27], v[64:79]
    s_waitcnt lgkmcnt(0)
    v_mfma_f32_32x32x16_bf16 v[64:79], v[172:175], v[28:31], v[64:79]
    ds_read_b64_tr_b16 v[176:177], v14 offset:49152
    ds_read_b64_tr_b16 v[178:179], v14 offset:50176
    ds_read_b64_tr_b16 v[180:181], v14 offset:53248
    ds_read_b64_tr_b16 v[182:183], v14 offset:54272
    ds_read_b64_tr_b16 v[184:185], v14 offset:57344
    ds_read_b64_tr_b16 v[186:187], v14 offset:58368
    ds_read_b64_tr_b16 v[188:189], v14 offset:61440
    ds_read_b64_tr_b16 v[190:191], v14 offset:62464
    s_waitcnt vmcnt(8) lgkmcnt(0)
    s_barrier
    s_add_u32 s55, s53, 5
    s_lshl_b32 s49, s55, 15
    s_add_u32 s49, s49, s56
    s_add_u32 m0, s61, 0
    s_add_u32 s48, s49, 0
    buffer_load_dwordx4 v1, s[4:7], s48 offen offset:0 sc1 lds
    buffer_load_dwordx4 v1, s[4:7], s48 offen offset:1024 sc1 lds
    buffer_load_dwordx4 v1, s[4:7], s48 offen offset:2048 sc1 lds
    buffer_load_dwordx4 v1, s[4:7], s48 offen offset:3072 sc1 lds
    s_add_u32 m0, s61, 4096
    s_add_u32 s48, s49, 4096
    buffer_load_dwordx4 v1, s[4:7], s48 offen offset:0 sc1 lds
    buffer_load_dwordx4 v1, s[4:7], s48 offen offset:1024 sc1 lds
    buffer_load_dwordx4 v1, s[4:7], s48 offen offset:2048 sc1 lds
    buffer_load_dwordx4 v1, s[4:7], s48 offen offset:3072 sc1 lds
    s_xor_b32 s61, s61, 32768
    s_add_u32 m0, s50, 49152
    s_mov_b32 s47, 3670016
    buffer_load_dwordx4 v13, s[8:11], s47 offen lds
    s_add_u32 m0, s50, 50176
    s_mov_b32 s47, 3702784
    buffer_load_dwordx4 v13, s[8:11], s47 offen lds
    s_add_u32 m0, s50, 51200
    s_mov_b32 s47, 3735552
    buffer_load_dwordx4 v13, s[8:11], s47 offen lds
    s_add_u32 m0, s50, 52224
    s_mov_b32 s47, 3768320
    buffer_load_dwordx4 v13, s[8:11], s47 offen lds
    ds_read_b128 v[16:19], v2 offset:12288
    ds_read_b128 v[20:23], v2 offset:13312
    ds_read_b128 v[24:27], v2 offset:14336
    s_waitcnt lgkmcnt(2)
    v_mfma_f32_32x32x16_bf16 v[64:79], v[176:179], v[16:19], v[64:79]
    ds_read_b128 v[28:31], v2 offset:15360
    s_waitcnt lgkmcnt(2)
    v_mfma_f32_32x32x16_bf16 v[64:79], v[180:183], v[20:23], v[64:79]
    s_waitcnt lgkmcnt(1)
    v_mfma_f32_32x32x16_bf16 v[64:79], v[184:187], v[24:27], v[64:79]
    s_waitcnt lgkmcnt(0)
    v_mfma_f32_32x32x16_bf16 v[64:79], v[188:191], v[28:31], v[64:79]
    ds_read_b64_tr_b16 v[192:193], v14 offset:0
    ds_read_b64_tr_b16 v[194:195], v14 offset:1024
    ds_read_b64_tr_b16 v[196:197], v14 offset:4096
    ds_read_b64_tr_b16 v[198:199], v14 offset:5120
    ds_read_b64_tr_b16 v[200:201], v14 offset:8192
    ds_read_b64_tr_b16 v[202:203], v14 offset:9216
    ds_read_b64_tr_b16 v[204:205], v14 offset:12288
    ds_read_b64_tr_b16 v[206:207], v14 offset:13312
    s_waitcnt vmcnt(8) lgkmcnt(0)
    s_barrier
    ds_read_b128 v[16:19], v2 offset:16384
    ds_read_b128 v[20:23], v2 offset:17408
    ds_read_b128 v[24:27], v2 offset:18432
    s_waitcnt lgkmcnt(2)
    v_mfma_f32_32x32x16_bf16 v[64:79], v[192:195], v[16:19], v[64:79]
    ds_read_b128 v[28:31], v2 offset:19456
    s_waitcnt lgkmcnt(2)
    v_mfma_f32_32x32x16_bf16 v[64:79], v[196:199], v[20:23], v[64:79]
    s_waitcnt lgkmcnt(1)
    v_mfma_f32_32x32x16_bf16 v[64:79], v[200:203], v[24:27], v[64:79]
    s_waitcnt lgkmcnt(0)
    v_mfma_f32_32x32x16_bf16 v[64:79], v[204:207], v[28:31], v[64:79]
    ds_read_b64_tr_b16 v[208:209], v14 offset:16384
    ds_read_b64_tr_b16 v[210:211], v14 offset:17408
    ds_read_b64_tr_b16 v[212:213], v14 offset:20480
    ds_read_b64_tr_b16 v[214:215], v14 offset:21504
    ds_read_b64_tr_b16 v[216:217], v14 offset:24576
    ds_read_b64_tr_b16 v[218:219], v14 offset:25600
    ds_read_b64_tr_b16 v[220:221], v14 offset:28672
    ds_read_b64_tr_b16 v[222:223], v14 offset:29696
    s_waitcnt vmcnt(4) lgkmcnt(0)
    s_barrier
    ds_read_b128 v[16:19], v2 offset:20480
    ds_read_b128 v[20:23], v2 offset:21504
    ds_read_b128 v[24:27], v2 offset:22528
    s_waitcnt lgkmcnt(2)
    v_mfma_f32_32x32x16_bf16 v[64:79], v[208:211], v[16:19], v[64:79]
    ds_read_b128 v[28:31], v2 offset:23552
    s_waitcnt lgkmcnt(2)
    v_mfma_f32_32x32x16_bf16 v[64:79], v[212:215], v[20:23], v[64:79]
    s_waitcnt lgkmcnt(1)
    v_mfma_f32_32x32x16_bf16 v[64:79], v[216:219], v[24:27], v[64:79]
    s_waitcnt lgkmcnt(0)
    v_mfma_f32_32x32x16_bf16 v[64:79], v[220:223], v[28:31], v[64:79]
    ds_read_b64_tr_b16 v[224:225], v14 offset:32768
    ds_read_b64_tr_b16 v[226:227], v14 offset:33792
    ds_read_b64_tr_b16 v[228:229], v14 offset:36864
    ds_read_b64_tr_b16 v[230:231], v14 offset:37888
    ds_read_b64_tr_b16 v[232:233], v14 offset:40960
    ds_read_b64_tr_b16 v[234:235], v14 offset:41984
    ds_read_b64_tr_b16 v[236:237], v14 offset:45056
    ds_read_b64_tr_b16 v[238:239], v14 offset:46080
    s_waitcnt vmcnt(0) lgkmcnt(0)
    s_barrier
    ds_read_b128 v[16:19], v2 offset:24576
    ds_read_b128 v[20:23], v2 offset:25600
    ds_read_b128 v[24:27], v2 offset:26624
    s_waitcnt lgkmcnt(2)
    v_mfma_f32_32x32x16_bf16 v[64:79], v[224:227], v[16:19], v[64:79]
    ds_read_b128 v[28:31], v2 offset:27648
    s_waitcnt lgkmcnt(2)
    v_mfma_f32_32x32x16_bf16 v[64:79], v[228:231], v[20:23], v[64:79]
    s_waitcnt lgkmcnt(1)
    v_mfma_f32_32x32x16_bf16 v[64:79], v[232:235], v[24:27], v[64:79]
    s_waitcnt lgkmcnt(0)
    v_mfma_f32_32x32x16_bf16 v[64:79], v[236:239], v[28:31], v[64:79]
    ds_read_b64_tr_b16 v[240:241], v14 offset:49152
    ds_read_b64_tr_b16 v[242:243], v14 offset:50176
    ds_read_b64_tr_b16 v[244:245], v14 offset:53248
    ds_read_b64_tr_b16 v[246:247], v14 offset:54272
    ds_read_b64_tr_b16 v[248:249], v14 offset:57344
    ds_read_b64_tr_b16 v[250:251], v14 offset:58368
    ds_read_b64_tr_b16 v[252:253], v14 offset:61440
    ds_read_b64_tr_b16 v[254:255], v14 offset:62464
    s_waitcnt lgkmcnt(0)
    ds_read_b128 v[16:19], v2 offset:28672
    ds_read_b128 v[20:23], v2 offset:29696
    ds_read_b128 v[24:27], v2 offset:30720
    s_waitcnt lgkmcnt(2)
    v_mfma_f32_32x32x16_bf16 v[64:79], v[240:243], v[16:19], v[64:79]
    ds_read_b128 v[28:31], v2 offset:31744
    s_waitcnt lgkmcnt(2)
    v_mfma_f32_32x32x16_bf16 v[64:79], v[244:247], v[20:23], v[64:79]
    s_waitcnt lgkmcnt(1)
    v_mfma_f32_32x32x16_bf16 v[64:79], v[248:251], v[24:27], v[64:79]
    s_waitcnt lgkmcnt(0)
    v_mfma_f32_32x32x16_bf16 v[64:79], v[252:255], v[28:31], v[64:79]
    v_xor_b32 v2, 0x8000, v2
    s_mov_b32 s53, s55
    s_nop 7
    s_nop 1
    v_cvt_pk_bf16_f32 v96, v64, v68
    v_cvt_pk_bf16_f32 v97, v65, v69
    v_cvt_pk_bf16_f32 v98, v66, v70
    v_cvt_pk_bf16_f32 v99, v67, v71
    v_cvt_pk_bf16_f32 v100, v72, v76
    v_cvt_pk_bf16_f32 v101, v73, v77
    v_cvt_pk_bf16_f32 v102, v74, v78
    v_cvt_pk_bf16_f32 v103, v75, v79
L_qkv_seg:
    s_add_u32 s55, s53, 5
    s_waitcnt vmcnt(0)
    s_barrier
    ds_read_b128 v[16:19], v2 offset:0
    ds_read_b128 v[20:23], v2 offset:1024
    ds_read_b128 v[24:27], v2 offset:2048
    s_waitcnt lgkmcnt(2)
    v_mfma_f32_32x32x16_bf16 v[32:47], a[0:3], v[16:19], 0
    ds_read_b128 v[28:31], v2 offset:3072
    v_mfma_f32_32x32x16_bf16 v[48:63], v[16:19], a[128:131], 0
    buffer_store_dwordx4 v[80:83], v8, s[4:7], s57 offen offset:0 sc1
    v_mfma_f32_32x32x16_bf16 v[64:79], v[128:131], v[16:19], 0
    s_waitcnt lgkmcnt(2)
    v_mfma_f32_32x32x16_bf16 v[32:47], a[4:7], v[20:23], v[32:47]
    ds_read_b128 v[16:19], v2 offset:4096
    v_mfma_f32_32x32x16_bf16 v[48:63], v[20:23], a[132:135], v[48:63]
    buffer_store_dwordx4 v[84:87], v8, s[4:7], s57 offen offset:512 sc1
    v_mfma_f32_32x32x16_bf16 v[64:79], v[132:135], v[20:23], v[64:79]
    s_waitcnt lgkmcnt(2)
    v_mfma_f32_32x32x16_bf16 v[32:47], a[8:11], v[24:27], v[32:47]
    ds_read_b128 v[20:23], v2 offset:5120
    v_mfma_f32_32x32x16_bf16 v[48:63], v[24:27], a[136:139], v[48:63]
    buffer_store_dwordx4 v[88:91], v9, s[4:7], s57 offen offset:0 sc1
    v_mfma_f32_32x32x16_bf16 v[64:79], v[136:139], v[24:27], v[64:79]
    s_waitcnt lgkmcnt(2)
    v_mfma_f32_32x32x16_bf16 v[32:47], a[12:15], v[28:31], v[32:47]
    ds_read_b128 v[24:27], v2 offset:6144
    v_mfma_f32_32x32x16_bf16 v[48:63], v[28:31], a[140:143], v[48:63]
    buffer_store_dwordx4 v[92:95], v9, s[4:7], s57 offen offset:256 sc1
    v_mfma_f32_32x32x16_bf16 v[64:79], v[140:143], v[28:31], v[64:79]
    s_waitcnt lgkmcnt(2)
    v_mfma_f32_32x32x16_bf16 v[32:47], a[16:19], v[16:19], v[32:47]
    ds_read_b128 v[28:31], v2 offset:7168
    v_mfma_f32_32x32x16_bf16 v[48:63], v[16:19], a[144:147], v[48:63]
    buffer_store_dwordx4 v[104:107], v3, s[4:7], s67 offen sc1
    v_mfma_f32_32x32x16_bf16 v[64:79], v[144:147], v[16:19], v[64:79]
    s_waitcnt lgkmcnt(2)
    v_mfma_f32_32x32x16_bf16 v[32:47], a[20:23], v[20:23], v[32:47]
    ds_read_b128 v[16:19], v2 offset:8192
    v_mfma_f32_32x32x16_bf16 v[48:63], v[20:23], a[148:151], v[48:63]
    buffer_store_dwordx4 v[96:99], v8, s[4:7], s58 offen offset:0 sc1
    v_mfma_f32_32x32x16_bf16 v[64:79], v[148:151], v[20:23], v[64:79]
    s_waitcnt lgkmcnt(2)
    v_mfma_f32_32x32x16_bf16 v[32:47], a[24:27], v[24:27], v[32:47]
    ds_read_b128 v[20:23], v2 offset:9216
    v_mfma_f32_32x32x16_bf16 v[48:63], v[24:27], a[152:155], v[48:63]
    buffer_store_dwordx4 v[100:103], v8, s[4:7], s58 offen offset:512 sc1
    v_mfma_f32_32x32x16_bf16 v[64:79], v[152:155], v[24:27], v[64:79]
    s_waitcnt lgkmcnt(2)
    v_mfma_f32_32x32x16_bf16 v[32:47], a[28:31], v[28:31], v[32:47]
    ds_read_b128 v[24:27], v2 offset:10240
    v_mfma_f32_32x32x16_bf16 v[48:63], v[28:31], a[156:159], v[48:63]
    s_lshl_b32 s49, s55, 15
    s_add_u32 s49, s49, s56
    s_add_u32 m0, s61, 0
    s_add_u32 s48, s49, 0
    buffer_load_dwordx4 v1, s[4:7], s48 offen offset:0 sc1 lds
    v_mfma_f32_32x32x16_bf16 v[64:79], v[156:159], v[28:31], v[64:79]
    s_waitcnt lgkmcnt(2)
    v_mfma_f32_32x32x16_bf16 v[32:47], a[32:35], v[16:19], v[32:47]
    ds_read_b128 v[28:31], v2 offset:11264
    v_mfma_f32_32x32x16_bf16 v[48:63], v[16:19], a[160:163], v[48:63]
    buffer_load_dwordx4 v1, s[4:7], s48 offen offset:1024 sc1 lds
    v_mfma_f32_32x32x16_bf16 v[64:79], v[160:163], v[16:19], v[64:79]
    s_waitcnt lgkmcnt(2)
    v_mfma_f32_32x32x16_bf16 v[32:47], a[36:39], v[20:23], v[32:47]
    ds_read_b128 v[16:19], v2 offset:12288
    v_mfma_f32_32x32x16_bf16 v[48:63], v[20:23], a[164:167], v[48:63]
    buffer_load_dwordx4 v1, s[4:7], s48 offen offset:2048 sc1 lds
    v_mfma_f32_32x32x16_bf16 v[64:79], v[164:167], v[20:23], v[64:79]
    s_waitcnt lgkmcnt(2)
    v_mfma_f32_32x32x16_bf16 v[32:47], a[40:43], v[24:27], v[32:47]
    ds_read_b128 v[20:23], v2 offset:13312
    v_mfma_f32_32x32x16_bf16 v[48:63], v[24:27], a[168:171], v[48:63]
    buffer_load_dwordx4 v1, s[4:7], s48 offen offset:3072 sc1 lds
    v_mfma_f32_32x32x16_bf16 v[64:79], v[168:171], v[24:27], v[64:79]
    s_waitcnt lgkmcnt(2)
    v_mfma_f32_32x32x16_bf16 v[32:47], a[44:47], v[28:31], v[32:47]
    ds_read_b128 v[24:27], v2 offset:14336
    v_mfma_f32_32x32x16_bf16 v[48:63], v[28:31], a[172:175], v[48:63]
    s_add_u32 m0, s61, 4096
    s_add_u32 s48, s49, 4096
    buffer_load_dwordx4 v1, s[4:7], s48 offen offset:0 sc1 lds
    v_mfma_f32_32x32x16_bf16 v[64:79], v[172:175], v[28:31], v[64:79]
    s_waitcnt lgkmcnt(2)
    v_mfma_f32_32x32x16_bf16 v[32:47], a[48:51], v[16:19], v[32:47]
    ds_read_b128 v[28:31], v2 offset:15360
    v_mfma_f32_32x32x16_bf16 v[48:63], v[16:19], a[176:179], v[48:63]
    buffer_load_dwordx4 v1, s[4:7], s48 offen offset:1024 sc1 lds
    v_mfma_f32_32x32x16_bf16 v[64:79], v[176:179], v[16:19], v[64:79]
    s_waitcnt lgkmcnt(2)
    v_mfma_f32_32x32x16_bf16 v[32:47], a[52:55], v[20:23], v[32:47]
    ds_read_b128 v[16:19], v2 offset:16384
    v_mfma_f32_32x32x16_bf16 v[48:63], v[20:23], a[180:183], v[48:63]
    buffer_load_dwordx4 v1, s[4:7], s48 offen offset:2048 sc1 lds
    v_mfma_f32_32x32x16_bf16 v[64:79], v[180:183], v[20:23], v[64:79]
    s_waitcnt lgkmcnt(2)
    v_mfma_f32_32x32x16_bf16 v[32:47], a[56:59], v[24:27], v[32:47]
    ds_read_b128 v[20:23], v2 offset:17408
    v_mfma_f32_32x32x16_bf16 v[48:63], v[24:27], a[184:187], v[48:63]
    buffer_load_dwordx4 v1, s[4:7], s48 offen offset:3072 sc1 lds
    v_mfma_f32_32x32x16_bf16 v[64:79], v[184:187], v[24:27], v[64:79]
    s_waitcnt lgkmcnt(2)
    v_mfma_f32_32x32x16_bf16 v[32:47], a[60:63], v[28:31], v[32:47]
    ds_read_b128 v[24:27], v2 offset:18432
    v_mfma_f32_32x32x16_bf16 v[48:63], v[28:31], a[188:191], v[48:63]
    s_xor_b32 s61, s61, 32768
    v_mfma_f32_32x32x16_bf16 v[64:79], v[188:191], v[28:31], v[64:79]
    s_waitcnt lgkmcnt(2)
    v_mfma_f32_32x32x16_bf16 v[32:47], a[64:67], v[16:19], v[32:47]
    ds_read_b128 v[28:31], v2 offset:19456
    v_mfma_f32_32x32x16_bf16 v[48:63], v[16:19], a[192:195], v[48:63]
    v_mfma_f32_32x32x16_bf16 v[64:79], v[192:195], v[16:19], v[64:79]
    s_waitcnt lgkmcnt(2)
    v_mfma_f32_32x32x16_bf16 v[32:47], a[68:71], v[20:23], v[32:47]
    ds_read_b128 v[16:19], v2 offset:20480
    v_mfma_f32_32x32x16_bf16 v[48:63], v[20:23], a[196:199], v[48:63]
    v_mfma_f32_32x32x16_bf16 v[64:79], v[196:199], v[20:23], v[64:79]
    s_waitcnt lgkmcnt(2)
    v_mfma_f32_32x32x16_bf16 v[32:47], a[72:75], v[24:27], v[32:47]
    ds_read_b128 v[20:23], v2 offset:21504
    v_mfma_f32_32x32x16_bf16 v[48:63], v[24:27], a[200:203], v[48:63]
    v_mfma_f32_32x32x16_bf16 v[64:79], v[200:203], v[24:27], v[64:79]
    s_waitcnt lgkmcnt(2)
    v_mfma_f32_32x32x16_bf16 v[32:47], a[76:79], v[28:31], v[32:47]
    ds_read_b128 v[24:27], v2 offset:22528
    v_mfma_f32_32x32x16_bf16 v[48:63], v[28:31], a[204:207], v[48:63]
    v_mfma_f32_32x32x16_bf16 v[64:79], v[204:207], v[28:31], v[64:79]
    s_waitcnt lgkmcnt(2)
    v_mfma_f32_32x32x16_bf16 v[32:47], a[80:83], v[16:19], v[32:47]
    ds_read_b128 v[28:31], v2 offset:23552
    v_mfma_f32_32x32x16_bf16 v[48:63], v[16:19], a[208:211], v[48:63]
    v_mfma_f32_32x32x16_bf16 v[64:79], v[208:211], v[16:19], v[64:79]
    s_waitcnt lgkmcnt(2)
    v_mfma_f32_32x32x16_bf16 v[32:47], a[84:87], v[20:23], v[32:47]
    ds_read_b128 v[16:19], v2 offset:24576
    v_mfma_f32_32x32x16_bf16 v[48:63], v[20:23], a[212:215], v[48:63]
    v_mfma_f32_32x32x16_bf16 v[64:79], v[212:215], v[20:23], v[64:79]
    s_waitcnt lgkmcnt(2)
    v_mfma_f32_32x32x16_bf16 v[32:47], a[88:91], v[24:27], v[32:47]
    ds_read_b128 v[20:23], v2 offset:25600
    v_mfma_f32_32x32x16_bf16 v[48:63], v[24:27], a[216:219], v[48:63]
    v_mfma_f32_32x32x16_bf16 v[64:79], v[216:219], v[24:27], v[64:79]
    s_waitcnt lgkmcnt(2)
    v_mfma_f32_32x32x16_bf16 v[32:47], a[92:95], v[28:31], v[32:47]
    ds_read_b128 v[24:27], v2 offset:26624
    v_mfma_f32_32x32x16_bf16 v[48:63], v[28:31], a[220:223], v[48:63]
    v_mfma_f32_32x32x16_bf16 v[64:79], v[220:223], v[28:31], v[64:79]
    s_waitcnt lgkmcnt(2)
    v_mfma_f32_32x32x16_bf16 v[32:47], a[96:99], v[16:19], v[32:47]
    ds_read_b128 v[28:31], v2 offset:27648
    v_mfma_f32_32x32x16_bf16 v[48:63], v[16:19], a[224:227], v[48:63]
    v_mfma_f32_32x32x16_bf16 v[64:79], v[224:227], v[16:19], v[64:79]
    s_cmp_lt_i32 s60, 0
    s_cbranch_scc1 L_qkv_nf
    s_waitcnt vmcnt(8)
    s_barrier
    s_cmp_lg_u32 s46, 0
    s_cbranch_scc1 L_qkv_nf
    v_mov_b32 v10, 0
    v_mov_b32 v11, 1
    s_mov_b64 exec, 1
    buffer_store_dword v11, v10, s[4:7], s60 offen sc1
    s_mov_b64 exec, -1
L_qkv_nf:
    s_waitcnt lgkmcnt(2)
    v_mfma_f32_32x32x16_bf16 v[32:47], a[100:103], v[20:23], v[32:47]
    ds_read_b128 v[16:19], v2 offset:28672
    v_mfma_f32_32x32x16_bf16 v[48:63], v[20:23], a[228:231], v[48:63]
    v_mfma_f32_32x32x16_bf16 v[64:79], v[228:231], v[20:23], v[64:79]
    s_waitcnt lgkmcnt(2)
    v_mfma_f32_32x32x16_bf16 v[32:47], a[104:107], v[24:27], v[32:47]
    ds_read_b128 v[20:23], v2 offset:29696
    v_mfma_f32_32x32x16_bf16 v[48:63], v[24:27], a[232:235], v[48:63]
    v_mfma_f32_32x32x16_bf16 v[64:79], v[232:235], v[24:27], v[64:79]
    s_waitcnt lgkmcnt(2)
    v_mfma_f32_32x32x16_bf16 v[32:47], a[108:111], v[28:31], v[32:47]
    ds_read_b128 v[24:27], v2 offset:30720
    v_mfma_f32_32x32x16_bf16 v[48:63], v[28:31], a[236:239], v[48:63]
    v_mfma_f32_32x32x16_bf16 v[64:79], v[236:239], v[28:31], v[64:79]
    s_waitcnt lgkmcnt(2)
    v_mfma_f32_32x32x16_bf16 v[32:47], a[112:115], v[16:19], v[32:47]
    ds_read_b128 v[28:31], v2 offset:31744
    v_mfma_f32_32x32x16_bf16 v[48:63], v[16:19], a[240:243], v[48:63]
    v_mfma_f32_32x32x16_bf16 v[64:79], v[240:243], v[16:19], v[64:79]
    s_waitcnt lgkmcnt(2)
    v_mfma_f32_32x32x16_bf16 v[32:47], a[116:119], v[20:23], v[32:47]
    v_mfma_f32_32x32x16_bf16 v[48:63], v[20:23], a[244:247], v[48:63]
    v_mfma_f32_32x32x16_bf16 v[64:79], v[244:247], v[20:23], v[64:79]
    s_waitcnt lgkmcnt(1)
    v_mfma_f32_32x32x16_bf16 v[32:47], a[120:123], v[24:27], v[32:47]
    v_mfma_f32_32x32x16_bf16 v[48:63], v[24:27], a[248:251], v[48:63]
    v_mfma_f32_32x32x16_bf16 v[64:79], v[248:251], v[24:27], v[64:79]
    s_waitcnt lgkmcnt(0)
    v_mfma_f32_32x32x16_bf16 v[32:47], a[124:127], v[28:31], v[32:47]
    v_mfma_f32_32x32x16_bf16 v[48:63], v[28:31], a[252:255], v[48:63]
    v_mfma_f32_32x32x16_bf16 v[64:79], v[252:255], v[28:31], v[64:79]
    v_xor_b32 v2, 0x8000, v2
    s_nop 7
    s_nop 1
    s_lshl_b32 s57, s53, 5
    s_add_u32 s57, s57, s54
    s_lshl_b32 s67, s57, 12
    s_add_u32 s67, s67, 59768832
    s_lshl_b32 s58, s57, 13
    s_add_u32 s58, s58, 41943040
    s_lshl_b32 s57, s57, 14
    s_add_u32 s57, s57, 8388608
    v_cvt_pk_bf16_f32 v80, v32, v36
    v_cvt_pk_bf16_f32 v81, v33, v37
    v_cvt_pk_bf16_f32 v82, v34, v38
    v_cvt_pk_bf16_f32 v83, v35, v39
    v_cvt_pk_bf16_f32 v84, v40, v44
    v_cvt_pk_bf16_f32 v85, v41, v45
    v_cvt_pk_bf16_f32 v86, v42, v46
    v_cvt_pk_bf16_f32 v87, v43, v47
    v_cvt_pk_bf16_f32 v88, v48, v49
    v_cvt_pk_bf16_f32 v89, v56, v57
    v_cvt_pk_bf16_f32 v90, v52, v53
    v_cvt_pk_bf16_f32 v91, v60, v61
    v_cvt_pk_bf16_f32 v92, v50, v51
    v_cvt_pk_bf16_f32 v93, v58, v59
    v_cvt_pk_bf16_f32 v94, v54, v55
    v_cvt_pk_bf16_f32 v95, v62, v63
    v_cvt_pk_bf16_f32 v96, v64, v68
    v_cvt_pk_bf16_f32 v97, v65, v69
    v_cvt_pk_bf16_f32 v98, v66, v70
    v_cvt_pk_bf16_f32 v99, v67, v71
    v_cvt_pk_bf16_f32 v100, v72, v76
    v_cvt_pk_bf16_f32 v101, v73, v77
    v_cvt_pk_bf16_f32 v102, v74, v78
    v_cvt_pk_bf16_f32 v103, v75, v79
    s_lshl_b32 s60, s53, 2
    s_add_u32 s60, s60, s59
    s_mov_b32 s53, s55
    s_cmp_lt_u32 s53, 64
    s_cbranch_scc1 L_qkv_seg
    buffer_store_dwordx4 v[80:83], v8, s[4:7], s57 offen offset:0 sc1
    buffer_store_dwordx4 v[84:87], v8, s[4:7], s57 offen offset:512 sc1
    buffer_store_dwordx4 v[88:91], v9, s[4:7], s57 offen offset:0 sc1
    buffer_store_dwordx4 v[92:95], v9, s[4:7], s57 offen offset:256 sc1
    buffer_store_dwordx4 v[104:107], v3, s[4:7], s67 offen sc1
    buffer_store_dwordx4 v[96:99], v8, s[4:7], s58 offen offset:0 sc1
    buffer_store_dwordx4 v[100:103], v8, s[4:7], s58 offen offset:512 sc1
    s_waitcnt vmcnt(0)
    s_barrier
    s_cmp_lg_u32 s46, 0
    s_cbranch_scc1 L_qkv_done
    v_mov_b32 v10, 136
    v_mov_b32 v11, 1
    s_mov_b64 exec, 1
    global_atomic_add v10, v11, s[40:41]
    s_mov_b64 exec, -1
L_qkv_done:
    s_cmp_lg_u32 s46, 0
    s_cbranch_scc1 L_qkv_lf
    v_mov_b32 v10, 0
    v_mov_b32 v11, 1
    s_mov_b64 exec, 1
    buffer_store_dword v11, v10, s[4:7], s60 offen sc1
    s_mov_b64 exec, -1
L_qkv_lf:
    s_branch L_p3
L_ffn:
    s_sub_u32 s57, s51, 160
    s_mul_i32 s54, s57, 43691
    s_lshr_b32 s54, s54, 17
    s_mul_i32 s47, s54, 3
    s_sub_u32 s53, s57, s47
    s_mov_b32 s58, 3
    s_cmp_lg_u32 s44, 9
    s_cbranch_scc1 L_ffn_own
    s_mul_i32 s53, s45, 3
    s_add_u32 s53, s53, 2
    s_mov_b32 s58, 64
    s_cmp_lt_u32 s53, 64
    s_cselect_b32 s54, 10, 11
L_ffn_own:
    s_lshl_b32 s52, s54, 8
    s_sub_u32 s47, s44, 2
    s_cselect_b32 s47, 64, s47
    v_mov_b32 v11, 0
    v_mul_u32_u24 v10, 6, v0
    v_add_u32 v10, s47, v10
    v_cmp_gt_u32 vcc, 64, v10
    v_lshlrev_b32 v10, 7, v10
    s_lshl_b32 s48, s45, 2
    s_add_u32 s48, s48, 1064960
    v_mov_b32 v12, 0x40000000
    v_cndmask_b32 v10, v12, v10, vcc
    buffer_store_dword v11, v10, s[4:7], s48 offen sc1
    s_cmp_eq_u32 s44, 1
    s_cbranch_scc1 L_ln
    v_lshlrev_b32 v126, 7, v0
    s_mov_b32 s8, s20
    s_mov_b32 s9, s21
    s_mov_b32 s10, 4194304
    s_mov_b32 s11, 0x20000
    s_mul_i32 s49, s57, 131072
    buffer_load_dword v127, v126, s[8:11], s49 offen
    s_add_u32 s49, s49, 32768
    buffer_load_dword v127, v126, s[8:11], s49 offen
    s_add_u32 s49, s49, 32768
    buffer_load_dword v127, v126, s[8:11], s49 offen
    s_add_u32 s49, s49, 32768
    buffer_load_dword v127, v126, s[8:11], s49 offen
    s_add_u32 s49, s49, 32768
    s_waitcnt vmcnt(0)
    s_barrier
    s_cmp_lg_u32 s46, 0
    s_cbranch_scc1 L_ffn_in2
    v_mov_b32 v10, 8
    v_mov_b32 v11, 1
    s_mov_b64 exec, 1
    global_atomic_add v10, v11, s[40:41]
    s_mov_b64 exec, -1
L_ffn_in2:
    s_branch L_ffn_w
L_ln:
    s_mov_b32 s8, s16
    s_mov_b32 s9, s17
    s_mov_b32 s10, 2097152
    s_mov_b32 s11, 0x20000
    v_lshrrev_b32 v1, 3, v0
    v_and_b32 v2, 7, v0
    v_lshlrev_b32 v3, 10, v1
    v_lshl_add_u32 v3, v2, 4, v3
    s_lshl_b32 s47, s45, 15
    buffer_load_dwordx4 v[80:83], v3, s[8:11], s47 offen offset:0
    buffer_load_dwordx4 v[84:87], v3, s[8:11], s47 offen offset:128
    buffer_load_dwordx4 v[88:91], v3, s[8:11], s47 offen offset:256
    buffer_load_dwordx4 v[92:95], v3, s[8:11], s47 offen offset:384
    buffer_load_dwordx4 v[96:99], v3, s[8:11], s47 offen offset:512
    buffer_load_dwordx4 v[100:103], v3, s[8:11], s47 offen offset:640
    buffer_load_dwordx4 v[104:107], v3, s[8:11], s47 offen offset:768
    buffer_load_dwordx4 v[108:111], v3, s[8:11], s47 offen offset:896
    s_lshl_b32 s49, s57, 15
    buffer_load_dwordx4 v[128:131], v3, s[8:11], s49 offen offset:0
    buffer_load_dwordx4 v[132:135], v3, s[8:11], s49 offen offset:128
    buffer_load_dwordx4 v[136:139], v3, s[8:11], s49 offen offset:256
    buffer_load_dwordx4 v[140:143], v3, s[8:11], s49 offen offset:384
    buffer_load_dwordx4 v[144:147], v3, s[8:11], s49 offen offset:512
    buffer_load_dwordx4 v[148:151], v3, s[8:11], s49 offen offset:640
    buffer_load_dwordx4 v[152:155], v3, s[8:11], s49 offen offset:768
    buffer_load_dwordx4 v[156:159], v3, s[8:11], s49 offen offset:896
    v_lshrrev_b32 v4, 1, v2
    v_lshlrev_b32 v4, 10, v4
    v_and_b32 v5, 1, v2
    v_lshl_add_u32 v4, v5, 9, v4
    v_lshl_add_u32 v4, v1, 4, v4
    s_add_u32 s47, s47, 4194304
    s_mov_b32 s48, 0xffff0000
    s_waitcnt vmcnt(8)
    v_lshlrev_b32 v16, 16, v80
    v_and_b32 v17, s48, v80
    v_lshlrev_b32 v18, 16, v81
    v_and_b32 v19, s48, v81
    v_lshlrev_b32 v20, 16, v82
    v_and_b32 v21, s48, v82
    v_lshlrev_b32 v22, 16, v83
    v_and_b32 v23, s48, v83
    v_lshlrev_b32 v24, 16, v84
    v_and_b32 v25, s48, v84
    v_lshlrev_b32 v26, 16, v85
    v_and_b32 v27, s48, v85
    v_lshlrev_b32 v28, 16, v86
    v_and_b32 v29, s48, v86
    v_lshlrev_b32 v30, 16, v87
    v_and_b32 v31, s48, v87
    v_lshlrev_b32 v32, 16, v88
    v_and_b32 v33, s48, v88
    v_lshlrev_b32 v34, 16, v89
    v_and_b32 v35, s48, v89
    v_lshlrev_b32 v36, 16, v90
    v_and_b32 v37, s48, v90
    v_lshlrev_b32 v38, 16, v91
    v_and_b32 v39, s48, v91
    v_lshlrev_b32 v40, 16, v92
    v_and_b32 v41, s48, v92
    v_lshlrev_b32 v42, 16, v93
    v_and_b32 v43, s48, v93
    v_lshlrev_b32 v44, 16, v94
    v_and_b32 v45, s48, v94
    v_lshlrev_b32 v46, 16, v95
    v_and_b32 v47, s48, v95
    v_lshlrev_b32 v48, 16, v96
    v_and_b32 v49, s48, v96
    v_lshlrev_b32 v50, 16, v97
    v_and_b32 v51, s48, v97
    v_lshlrev_b32 v52, 16, v98
    v_and_b32 v53, s48, v98
    v_lshlrev_b32 v54, 16, v99
    v_and_b32 v55, s48, v99
    v_lshlrev_b32 v56, 16, v100
    v_and_b32 v57, s48, v100
    v_lshlrev_b32 v58, 16, v101
    v_and_b32 v59, s48, v101
    v_lshlrev_b32 v60, 16, v102
    v_and_b32 v61, s48, v102
    v_lshlrev_b32 v62, 16, v103
    v_and_b32 v63, s48, v103
    v_lshlrev_b32 v64, 16, v104
    v_and_b32 v65, s48, v104
    v_lshlrev_b32 v66, 16, v105
    v_and_b32 v67, s48, v105
    v_lshlrev_b32 v68, 16, v106
    v_and_b32 v69, s48, v106
    v_lshlrev_b32 v70, 16, v107
    v_and_b32 v71, s48, v107
    v_lshlrev_b32 v72, 16, v108
    v_and_b32 v73, s48, v108
    v_lshlrev_b32 v74, 16, v109
    v_and_b32 v75, s48, v109
    v_lshlrev_b32 v76, 16, v110
    v_and_b32 v77, s48, v110
    v_lshlrev_b32 v78, 16, v111
    v_and_b32 v79, s48, v111
    v_pk_add_f32 v[6:7], v[16:17], v[18:19]
    v_pk_add_f32 v[6:7], v[6:7], v[20:21]
    v_pk_add_f32 v[6:7], v[6:7], v[22:23]
    v_pk_add_f32 v[6:7], v[6:7], v[24:25]
    v_pk_add_f32 v[6:7], v[6:7], v[26:27]
    v_pk_add_f32 v[6:7], v[6:7], v[28:29]
    v_pk_add_f32 v[6:7], v[6:7], v[30:31]
    v_pk_add_f32 v[6:7], v[6:7], v[32:33]
    v_pk_add_f32 v[6:7], v[6:7], v[34:35]
    v_pk_add_f32 v[6:7], v[6:7], v[36:37]
    v_pk_add_f32 v[6:7], v[6:7], v[38:39]
    v_pk_add_f32 v[6:7], v[6:7], v[40:41]
    v_pk_add_f32 v[6:7], v[6:7], v[42:43]
    v_pk_add_f32 v[6:7], v[6:7], v[44:45]
    v_pk_add_f32 v[6:7], v[6:7], v[46:47]
    v_pk_add_f32 v[6:7], v[6:7], v[48:49]
    v_pk_add_f32 v[6:7], v[6:7], v[50:51]
    v_pk_add_f32 v[6:7], v[6:7], v[52:53]
    v_pk_add_f32 v[6:7], v[6:7], v[54:55]
    v_pk_add_f32 v[6:7], v[6:7], v[56:57]
    v_pk_add_f32 v[6:7], v[6:7], v[58:59]
    v_pk_add_f32 v[6:7], v[6:7], v[60:61]
    v_pk_add_f32 v[6:7], v[6:7], v[62:63]
    v_pk_add_f32 v[6:7], v[6:7], v[64:65]
    v_pk_add_f32 v[6:7], v[6:7], v[66:67]
    v_pk_add_f32 v[6:7], v[6:7], v[68:69]
    v_pk_add_f32 v[6:7], v[6:7], v[70:71]
    v_pk_add_f32 v[6:7], v[6:7], v[72:73]
    v_pk_add_f32 v[6:7], v[6:7], v[74:75]
    v_pk_add_f32 v[6:7], v[6:7], v[76:77]
    v_pk_add_f32 v[6:7], v[6:7], v[78:79]
    v_add_f32 v6, v6, v7
    s_nop 1
    v_add_f32_dpp v6, v6, v6 quad_perm:[1,0,3,2] row_mask:0xf bank_mask:0xf
    s_nop 1
    v_add_f32_dpp v6, v6, v6 quad_perm:[2,3,0,1] row_mask:0xf bank_mask:0xf
    s_nop 1
    v_add_f32_dpp v6, v6, v6 row_half_mirror row_mask:0xf bank_mask:0xf
    v_mul_f32 v6, 0x3b000000, v6
    v_mov_b32 v8, 0
    v_mov_b32 v9, 0
    v_sub_f32 v7, v16, v6
    v_fmac_f32 v8, v7, v7
    v_sub_f32 v7, v17, v6
    v_fmac_f32 v9, v7, v7
    v_sub_f32 v7, v18, v6
    v_fmac_f32 v8, v7, v7
    v_sub_f32 v7, v19, v6
    v_fmac_f32 v9, v7, v7
    v_sub_f32 v7, v20, v6
    v_fmac_f32 v8, v7, v7
    v_sub_f32 v7, v21, v6
    v_fmac_f32 v9, v7, v7
    v_sub_f32 v7, v22, v6
    v_fmac_f32 v8, v7, v7
    v_sub_f32 v7, v23, v6
    v_fmac_f32 v9, v7, v7
    v_sub_f32 v7, v24, v6
    v_fmac_f32 v8, v7, v7
    v_sub_f32 v7, v25, v6
    v_fmac_f32 v9, v7, v7
    v_sub_f32 v7, v26, v6
    v_fmac_f32 v8, v7, v7
    v_sub_f32 v7, v27, v6
    v_fmac_f32 v9, v7, v7
    v_sub_f32 v7, v28, v6
    v_fmac_f32 v8, v7, v7
    v_sub_f32 v7, v29, v6
    v_fmac_f32 v9, v7, v7
    v_sub_f32 v7, v30, v6
    v_fmac_f32 v8, v7, v7
    v_sub_f32 v7, v31, v6
    v_fmac_f32 v9, v7, v7
    v_sub_f32 v7, v32, v6
    v_fmac_f32 v8, v7, v7
    v_sub_f32 v7, v33, v6
    v_fmac_f32 v9, v7, v7
    v_sub_f32 v7, v34, v6
    v_fmac_f32 v8, v7, v7
    v_sub_f32 v7, v35, v6
    v_fmac_f32 v9, v7, v7
    v_sub_f32 v7, v36, v6
    v_fmac_f32 v8, v7, v7
    v_sub_f32 v7, v37, v6
    v_fmac_f32 v9, v7, v7
    v_sub_f32 v7, v38, v6
    v_fmac_f32 v8, v7, v7
    v_sub_f32 v7, v39, v6
    v_fmac_f32 v9, v7, v7
    v_sub_f32 v7, v40, v6
    v_fmac_f32 v8, v7, v7
    v_sub_f32 v7, v41, v6
    v_fmac_f32 v9, v7, v7
    v_sub_f32 v7, v42, v6
    v_fmac_f32 v8, v7, v7
    v_sub_f32 v7, v43, v6
    v_fmac_f32 v9, v7, v7
    v_sub_f32 v7, v44, v6
    v_fmac_f32 v8, v7, v7
    v_sub_f32 v7, v45, v6
    v_fmac_f32 v9, v7, v7
    v_sub_f32 v7, v46, v6
    v_fmac_f32 v8, v7, v7
    v_sub_f32 v7, v47, v6
    v_fmac_f32 v9, v7, v7
    v_sub_f32 v7, v48, v6
    v_fmac_f32 v8, v7, v7
    v_sub_f32 v7, v49, v6
    v_fmac_f32 v9, v7, v7
    v_sub_f32 v7, v50, v6
    v_fmac_f32 v8, v7, v7
    v_sub_f32 v7, v51, v6
    v_fmac_f32 v9, v7, v7
    v_sub_f32 v7, v52, v6
    v_fmac_f32 v8, v7, v7
    v_sub_f32 v7, v53, v6
    v_fmac_f32 v9, v7, v7
    v_sub_f32 v7, v54, v6
    v_fmac_f32 v8, v7, v7
    v_sub_f32 v7, v55, v6
    v_fmac_f32 v9, v7, v7
    v_sub_f32 v7, v56, v6
    v_fmac_f32 v8, v7, v7
    v_sub_f32 v7, v57, v6
    v_fmac_f32 v9, v7, v7
    v_sub_f32 v7, v58, v6
    v_fmac_f32 v8, v7, v7
    v_sub_f32 v7, v59, v6
    v_fmac_f32 v9, v7, v7
    v_sub_f32 v7, v60, v6
    v_fmac_f32 v8, v7, v7
    v_sub_f32 v7, v61, v6
    v_fmac_f32 v9, v7, v7
    v_sub_f32 v7, v62, v6
    v_fmac_f32 v8, v7, v7
    v_sub_f32 v7, v63, v6
    v_fmac_f32 v9, v7, v7
    v_sub_f32 v7, v64, v6
    v_fmac_f32 v8, v7, v7
    v_sub_f32 v7, v65, v6
    v_fmac_f32 v9, v7, v7
    v_sub_f32 v7, v66, v6
    v_fmac_f32 v8, v7, v7
    v_sub_f32 v7, v67, v6
    v_fmac_f32 v9, v7, v7
    v_sub_f32 v7, v68, v6
    v_fmac_f32 v8, v7, v7
    v_sub_f32 v7, v69, v6
    v_fmac_f32 v9, v7, v7
    v_sub_f32 v7, v70, v6
    v_fmac_f32 v8, v7, v7
    v_sub_f32 v7, v71, v6
    v_fmac_f32 v9, v7, v7
    v_sub_f32 v7, v72, v6
    v_fmac_f32 v8, v7, v7
    v_sub_f32 v7, v73, v6
    v_fmac_f32 v9, v7, v7
    v_sub_f32 v7, v74, v6
    v_fmac_f32 v8, v7, v7
    v_sub_f32 v7, v75, v6
    v_fmac_f32 v9, v7, v7
    v_sub_f32 v7, v76, v6
    v_fmac_f32 v8, v7, v7
    v_sub_f32 v7, v77, v6
    v_fmac_f32 v9, v7, v7
    v_sub_f32 v7, v78, v6
    v_fmac_f32 v8, v7, v7
    v_sub_f32 v7, v79, v6
    v_fmac_f32 v9, v7, v7
    v_add_f32 v8, v8, v9
    s_nop 1
    v_add_f32_dpp v8, v8, v8 quad_perm:[1,0,3,2] row_mask:0xf bank_mask:0xf
    s_nop 1
    v_add_f32_dpp v8, v8, v8 quad_perm:[2,3,0,1] row_mask:0xf bank_mask:0xf
    s_nop 1
    v_add_f32_dpp v8, v8, v8 row_half_mirror row_mask:0xf bank_mask:0xf
    v_mul_f32 v8, 0x3b000000, v8
    v_cvt_pk_bf16_f32 v6, v6, v8
    v_and_b32 v8, s48, v6
    v_lshlrev_b32 v6, 16, v6
    v_add_f32 v8, 0x3727c5ac, v8
    v_cvt_pk_bf16_f32 v8, v8, v8
    v_and_b32 v8, s48, v8
    v_sqrt_f32 v8, v8
    s_nop 0
    v_cvt_pk_bf16_f32 v8, v8, v8
    v_and_b32 v8, s48, v8
    v_rcp_f32 v8, v8
    v_sub_f32 v16, v16, v6
    v_sub_f32 v17, v17, v6
    v_cvt_pk_bf16_f32 v16, v16, v17
    v_and_b32 v17, s48, v16
    v_lshlrev_b32 v16, 16, v16
    v_mul_f32 v16, v16, v8
    v_mul_f32 v17, v17, v8
    v_cvt_pk_bf16_f32 v80, v16, v17
    v_sub_f32 v18, v18, v6
    v_sub_f32 v19, v19, v6
    v_cvt_pk_bf16_f32 v18, v18, v19
    v_and_b32 v19, s48, v18
    v_lshlrev_b32 v18, 16, v18
    v_mul_f32 v18, v18, v8
    v_mul_f32 v19, v19, v8
    v_cvt_pk_bf16_f32 v81, v18, v19
    v_sub_f32 v20, v20, v6
    v_sub_f32 v21, v21, v6
    v_cvt_pk_bf16_f32 v20, v20, v21
    v_and_b32 v21, s48, v20
    v_lshlrev_b32 v20, 16, v20
    v_mul_f32 v20, v20, v8
    v_mul_f32 v21, v21, v8
    v_cvt_pk_bf16_f32 v82, v20, v21
    v_sub_f32 v22, v22, v6
    v_sub_f32 v23, v23, v6
    v_cvt_pk_bf16_f32 v22, v22, v23
    v_and_b32 v23, s48, v22
    v_lshlrev_b32 v22, 16, v22
    v_mul_f32 v22, v22, v8
    v_mul_f32 v23, v23, v8
    v_cvt_pk_bf16_f32 v83, v22, v23
    buffer_store_dwordx4 v[80:83], v4, s[4:7], s47 offen sc1
    s_add_u32 s47, s47, 4096
    v_sub_f32 v24, v24, v6
    v_sub_f32 v25, v25, v6
    v_cvt_pk_bf16_f32 v24, v24, v25
    v_and_b32 v25, s48, v24
    v_lshlrev_b32 v24, 16, v24
    v_mul_f32 v24, v24, v8
    v_mul_f32 v25, v25, v8
    v_cvt_pk_bf16_f32 v84, v24, v25
    v_sub_f32 v26, v26, v6
    v_sub_f32 v27, v27, v6
    v_cvt_pk_bf16_f32 v26, v26, v27
    v_and_b32 v27, s48, v26
    v_lshlrev_b32 v26, 16, v26
    v_mul_f32 v26, v26, v8
    v_mul_f32 v27, v27, v8
    v_cvt_pk_bf16_f32 v85, v26, v27
    v_sub_f32 v28, v28, v6
    v_sub_f32 v29, v29, v6
    v_cvt_pk_bf16_f32 v28, v28, v29
    v_and_b32 v29, s48, v28
    v_lshlrev_b32 v28, 16, v28
    v_mul_f32 v28, v28, v8
    v_mul_f32 v29, v29, v8
    v_cvt_pk_bf16_f32 v86, v28, v29
    v_sub_f32 v30, v30, v6
    v_sub_f32 v31, v31, v6
    v_cvt_pk_bf16_f32 v30, v30, v31
    v_and_b32 v31, s48, v30
    v_lshlrev_b32 v30, 16, v30
    v_mul_f32 v30, v30, v8
    v_mul_f32 v31, v31, v8
    v_cvt_pk_bf16_f32 v87, v30, v31
    buffer_store_dwordx4 v[84:87], v4, s[4:7], s47 offen sc1
    s_add_u32 s47, s47, 4096
    v_sub_f32 v32, v32, v6
    v_sub_f32 v33, v33, v6
    v_cvt_pk_bf16_f32 v32, v32, v33
    v_and_b32 v33, s48, v32
    v_lshlrev_b32 v32, 16, v32
    v_mul_f32 v32, v32, v8
    v_mul_f32 v33, v33, v8
    v_cvt_pk_bf16_f32 v88, v32, v33
    v_sub_f32 v34, v34, v6
    v_sub_f32 v35, v35, v6
    v_cvt_pk_bf16_f32 v34, v34, v35
    v_and_b32 v35, s48, v34
    v_lshlrev_b32 v34, 16, v34
    v_mul_f32 v34, v34, v8
    v_mul_f32 v35, v35, v8
    v_cvt_pk_bf16_f32 v89, v34, v35
    v_sub_f32 v36, v36, v6
    v_sub_f32 v37, v37, v6
    v_cvt_pk_bf16_f32 v36, v36, v37
    v_and_b32 v37, s48, v36
    v_lshlrev_b32 v36, 16, v36
    v_mul_f32 v36, v36, v8
    v_mul_f32 v37, v37, v8
    v_cvt_pk_bf16_f32 v90, v36, v37
    v_sub_f32 v38, v38, v6
    v_sub_f32 v39, v39, v6
    v_cvt_pk_bf16_f32 v38, v38, v39
    v_and_b32 v39, s48, v38
    v_lshlrev_b32 v38, 16, v38
    v_mul_f32 v38, v38, v8
    v_mul_f32 v39, v39, v8
    v_cvt_pk_bf16_f32 v91, v38, v39
    buffer_store_dwordx4 v[88:91], v4, s[4:7], s47 offen sc1
    s_add_u32 s47, s47, 4096
    v_sub_f32 v40, v40, v6
    v_sub_f32 v41, v41, v6
    v_cvt_pk_bf16_f32 v40, v40, v41
    v_and_b32 v41, s48, v40
    v_lshlrev_b32 v40, 16, v40
    v_mul_f32 v40, v40, v8
    v_mul_f32 v41, v41, v8
    v_cvt_pk_bf16_f32 v92, v40, v41
    v_sub_f32 v42, v42, v6
    v_sub_f32 v43, v43, v6
    v_cvt_pk_bf16_f32 v42, v42, v43
    v_and_b32 v43, s48, v42
    v_lshlrev_b32 v42, 16, v42
    v_mul_f32 v42, v42, v8
    v_mul_f32 v43, v43, v8
    v_cvt_pk_bf16_f32 v93, v42, v43
    v_sub_f32 v44, v44, v6
    v_sub_f32 v45, v45, v6
    v_cvt_pk_bf16_f32 v44, v44, v45
    v_and_b32 v45, s48, v44
    v_lshlrev_b32 v44, 16, v44
    v_mul_f32 v44, v44, v8
    v_mul_f32 v45, v45, v8
    v_cvt_pk_bf16_f32 v94, v44, v45
    v_sub_f32 v46, v46, v6
    v_sub_f32 v47, v47, v6
    v_cvt_pk_bf16_f32 v46, v46, v47
    v_and_b32 v47, s48, v46
    v_lshlrev_b32 v46, 16, v46
    v_mul_f32 v46, v46, v8
    v_mul_f32 v47, v47, v8
    v_cvt_pk_bf16_f32 v95, v46, v47
    buffer_store_dwordx4 v[92:95], v4, s[4:7], s47 offen sc1
    s_add_u32 s47, s47, 4096
    v_sub_f32 v48, v48, v6
    v_sub_f32 v49, v49, v6
    v_cvt_pk_bf16_f32 v48, v48, v49
    v_and_b32 v49, s48, v48
    v_lshlrev_b32 v48, 16, v48
    v_mul_f32 v48, v48, v8
    v_mul_f32 v49, v49, v8
    v_cvt_pk_bf16_f32 v96, v48, v49
    v_sub_f32 v50, v50, v6
    v_sub_f32 v51, v51, v6
    v_cvt_pk_bf16_f32 v50, v50, v51
    v_and_b32 v51, s48, v50
    v_lshlrev_b32 v50, 16, v50
    v_mul_f32 v50, v50, v8
    v_mul_f32 v51, v51, v8
    v_cvt_pk_bf16_f32 v97, v50, v51
    v_sub_f32 v52, v52, v6
    v_sub_f32 v53, v53, v6
    v_cvt_pk_bf16_f32 v52, v52, v53
    v_and_b32 v53, s48, v52
    v_lshlrev_b32 v52, 16, v52
    v_mul_f32 v52, v52, v8
    v_mul_f32 v53, v53, v8
    v_cvt_pk_bf16_f32 v98, v52, v53
    v_sub_f32 v54, v54, v6
    v_sub_f32 v55, v55, v6
    v_cvt_pk_bf16_f32 v54, v54, v55
    v_and_b32 v55, s48, v54
    v_lshlrev_b32 v54, 16, v54
    v_mul_f32 v54, v54, v8
    v_mul_f32 v55, v55, v8
    v_cvt_pk_bf16_f32 v99, v54, v55
    buffer_store_dwordx4 v[96:99], v4, s[4:7], s47 offen sc1
    s_add_u32 s47, s47, 4096
    v_sub_f32 v56, v56, v6
    v_sub_f32 v57, v57, v6
    v_cvt_pk_bf16_f32 v56, v56, v57
    v_and_b32 v57, s48, v56
    v_lshlrev_b32 v56, 16, v56
    v_mul_f32 v56, v56, v8
    v_mul_f32 v57, v57, v8
    v_cvt_pk_bf16_f32 v100, v56, v57
    v_sub_f32 v58, v58, v6
    v_sub_f32 v59, v59, v6
    v_cvt_pk_bf16_f32 v58, v58, v59
    v_and_b32 v59, s48, v58
    v_lshlrev_b32 v58, 16, v58
    v_mul_f32 v58, v58, v8
    v_mul_f32 v59, v59, v8
    v_cvt_pk_bf16_f32 v101, v58, v59
    v_sub_f32 v60, v60, v6
    v_sub_f32 v61, v61, v6
    v_cvt_pk_bf16_f32 v60, v60, v61
    v_and_b32 v61, s48, v60
    v_lshlrev_b32 v60, 16, v60
    v_mul_f32 v60, v60, v8
    v_mul_f32 v61, v61, v8
    v_cvt_pk_bf16_f32 v102, v60, v61
    v_sub_f32 v62, v62, v6
    v_sub_f32 v63, v63, v6
    v_cvt_pk_bf16_f32 v62, v62, v63
    v_and_b32 v63, s48, v62
    v_lshlrev_b32 v62, 16, v62
    v_mul_f32 v62, v62, v8
    v_mul_f32 v63, v63, v8
    v_cvt_pk_bf16_f32 v103, v62, v63
    buffer_store_dwordx4 v[100:103], v4, s[4:7], s47 offen sc1
    s_add_u32 s47, s47, 4096
    v_sub_f32 v64, v64, v6
    v_sub_f32 v65, v65, v6
    v_cvt_pk_bf16_f32 v64, v64, v65
    v_and_b32 v65, s48, v64
    v_lshlrev_b32 v64, 16, v64
    v_mul_f32 v64, v64, v8
    v_mul_f32 v65, v65, v8
    v_cvt_pk_bf16_f32 v104, v64, v65
    v_sub_f32 v66, v66, v6
    v_sub_f32 v67, v67, v6
    v_cvt_pk_bf16_f32 v66, v66, v67
    v_and_b32 v67, s48, v66
    v_lshlrev_b32 v66, 16, v66
    v_mul_f32 v66, v66, v8
    v_mul_f32 v67, v67, v8
    v_cvt_pk_bf16_f32 v105, v66, v67
    v_sub_f32 v68, v68, v6
    v_sub_f32 v69, v69, v6
    v_cvt_pk_bf16_f32 v68, v68, v69
    v_and_b32 v69, s48, v68
    v_lshlrev_b32 v68, 16, v68
    v_mul_f32 v68, v68, v8
    v_mul_f32 v69, v69, v8
    v_cvt_pk_bf16_f32 v106, v68, v69
    v_sub_f32 v70, v70, v6
    v_sub_f32 v71, v71, v6
    v_cvt_pk_bf16_f32 v70, v70, v71
    v_and_b32 v71, s48, v70
    v_lshlrev_b32 v70, 16, v70
    v_mul_f32 v70, v70, v8
    v_mul_f32 v71, v71, v8
    v_cvt_pk_bf16_f32 v107, v70, v71
    buffer_store_dwordx4 v[104:107], v4, s[4:7], s47 offen sc1
    s_add_u32 s47, s47, 4096
    v_sub_f32 v72, v72, v6
    v_sub_f32 v73, v73, v6
    v_cvt_pk_bf16_f32 v72, v72, v73
    v_and_b32 v73, s48, v72
    v_lshlrev_b32 v72, 16, v72
    v_mul_f32 v72, v72, v8
    v_mul_f32 v73, v73, v8
    v_cvt_pk_bf16_f32 v108, v72, v73
    v_sub_f32 v74, v74, v6
    v_sub_f32 v75, v75, v6
    v_cvt_pk_bf16_f32 v74, v74, v75
    v_and_b32 v75, s48, v74
    v_lshlrev_b32 v74, 16, v74
    v_mul_f32 v74, v74, v8
    v_mul_f32 v75, v75, v8
    v_cvt_pk_bf16_f32 v109, v74, v75
    v_sub_f32 v76, v76, v6
    v_sub_f32 v77, v77, v6
    v_cvt_pk_bf16_f32 v76, v76, v77
    v_and_b32 v77, s48, v76
    v_lshlrev_b32 v76, 16, v76
    v_mul_f32 v76, v76, v8
    v_mul_f32 v77, v77, v8
    v_cvt_pk_bf16_f32 v110, v76, v77
    v_sub_f32 v78, v78, v6
    v_sub_f32 v79, v79, v6
    v_cvt_pk_bf16_f32 v78, v78, v79
    v_and_b32 v79, s48, v78
    v_lshlrev_b32 v78, 16, v78
    v_mul_f32 v78, v78, v8
    v_mul_f32 v79, v79, v8
    v_cvt_pk_bf16_f32 v111, v78, v79
    buffer_store_dwordx4 v[108:111], v4, s[4:7], s47 offen sc1
    s_add_u32 s47, s47, 4096
    s_add_u32 s47, s49, 4194304
    s_waitcnt vmcnt(8)
    v_lshlrev_b32 v16, 16, v128
    v_and_b32 v17, s48, v128
    v_lshlrev_b32 v18, 16, v129
    v_and_b32 v19, s48, v129
    v_lshlrev_b32 v20, 16, v130
    v_and_b32 v21, s48, v130
    v_lshlrev_b32 v22, 16, v131
    v_and_b32 v23, s48, v131
    v_lshlrev_b32 v24, 16, v132
    v_and_b32 v25, s48, v132
    v_lshlrev_b32 v26, 16, v133
    v_and_b32 v27, s48, v133
    v_lshlrev_b32 v28, 16, v134
    v_and_b32 v29, s48, v134
    v_lshlrev_b32 v30, 16, v135
    v_and_b32 v31, s48, v135
    v_lshlrev_b32 v32, 16, v136
    v_and_b32 v33, s48, v136
    v_lshlrev_b32 v34, 16, v137
    v_and_b32 v35, s48, v137
    v_lshlrev_b32 v36, 16, v138
    v_and_b32 v37, s48, v138
    v_lshlrev_b32 v38, 16, v139
    v_and_b32 v39, s48, v139
    v_lshlrev_b32 v40, 16, v140
    v_and_b32 v41, s48, v140
    v_lshlrev_b32 v42, 16, v141
    v_and_b32 v43, s48, v141
    v_lshlrev_b32 v44, 16, v142
    v_and_b32 v45, s48, v142
    v_lshlrev_b32 v46, 16, v143
    v_and_b32 v47, s48, v143
    v_lshlrev_b32 v48, 16, v144
    v_and_b32 v49, s48, v144
    v_lshlrev_b32 v50, 16, v145
    v_and_b32 v51, s48, v145
    v_lshlrev_b32 v52, 16, v146
    v_and_b32 v53, s48, v146
    v_lshlrev_b32 v54, 16, v147
    v_and_b32 v55, s48, v147
    v_lshlrev_b32 v56, 16, v148
    v_and_b32 v57, s48, v148
    v_lshlrev_b32 v58, 16, v149
    v_and_b32 v59, s48, v149
    v_lshlrev_b32 v60, 16, v150
    v_and_b32 v61, s48, v150
    v_lshlrev_b32 v62, 16, v151
    v_and_b32 v63, s48, v151
    v_lshlrev_b32 v64, 16, v152
    v_and_b32 v65, s48, v152
    v_lshlrev_b32 v66, 16, v153
    v_and_b32 v67, s48, v153
    v_lshlrev_b32 v68, 16, v154
    v_and_b32 v69, s48, v154
    v_lshlrev_b32 v70, 16, v155
    v_and_b32 v71, s48, v155
    v_lshlrev_b32 v72, 16, v156
    v_and_b32 v73, s48, v156
    v_lshlrev_b32 v74, 16, v157
    v_and_b32 v75, s48, v157
    v_lshlrev_b32 v76, 16, v158
    v_and_b32 v77, s48, v158
    v_lshlrev_b32 v78, 16, v159
    v_and_b32 v79, s48, v159
    v_pk_add_f32 v[6:7], v[16:17], v[18:19]
    v_pk_add_f32 v[6:7], v[6:7], v[20:21]
    v_pk_add_f32 v[6:7], v[6:7], v[22:23]
    v_pk_add_f32 v[6:7], v[6:7], v[24:25]
    v_pk_add_f32 v[6:7], v[6:7], v[26:27]
    v_pk_add_f32 v[6:7], v[6:7], v[28:29]
    v_pk_add_f32 v[6:7], v[6:7], v[30:31]
    v_pk_add_f32 v[6:7], v[6:7], v[32:33]
    v_pk_add_f32 v[6:7], v[6:7], v[34:35]
    v_pk_add_f32 v[6:7], v[6:7], v[36:37]
    v_pk_add_f32 v[6:7], v[6:7], v[38:39]
    v_pk_add_f32 v[6:7], v[6:7], v[40:41]
    v_pk_add_f32 v[6:7], v[6:7], v[42:43]
    v_pk_add_f32 v[6:7], v[6:7], v[44:45]
    v_pk_add_f32 v[6:7], v[6:7], v[46:47]
    v_pk_add_f32 v[6:7], v[6:7], v[48:49]
    v_pk_add_f32 v[6:7], v[6:7], v[50:51]
    v_pk_add_f32 v[6:7], v[6:7], v[52:53]
    v_pk_add_f32 v[6:7], v[6:7], v[54:55]
    v_pk_add_f32 v[6:7], v[6:7], v[56:57]
    v_pk_add_f32 v[6:7], v[6:7], v[58:59]
    v_pk_add_f32 v[6:7], v[6:7], v[60:61]
    v_pk_add_f32 v[6:7], v[6:7], v[62:63]
    v_pk_add_f32 v[6:7], v[6:7], v[64:65]
    v_pk_add_f32 v[6:7], v[6:7], v[66:67]
    v_pk_add_f32 v[6:7], v[6:7], v[68:69]
    v_pk_add_f32 v[6:7], v[6:7], v[70:71]
    v_pk_add_f32 v[6:7], v[6:7], v[72:73]
    v_pk_add_f32 v[6:7], v[6:7], v[74:75]
    v_pk_add_f32 v[6:7], v[6:7], v[76:77]
    v_pk_add_f32 v[6:7], v[6:7], v[78:79]
    v_add_f32 v6, v6, v7
    s_nop 1
    v_add_f32_dpp v6, v6, v6 quad_perm:[1,0,3,2] row_mask:0xf bank_mask:0xf
    s_nop 1
    v_add_f32_dpp v6, v6, v6 quad_perm:[2,3,0,1] row_mask:0xf bank_mask:0xf
    s_nop 1
    v_add_f32_dpp v6, v6, v6 row_half_mirror row_mask:0xf bank_mask:0xf
    v_mul_f32 v6, 0x3b000000, v6
    v_mov_b32 v8, 0
    v_mov_b32 v9, 0
    v_sub_f32 v7, v16, v6
    v_fmac_f32 v8, v7, v7
    v_sub_f32 v7, v17, v6
    v_fmac_f32 v9, v7, v7
    v_sub_f32 v7, v18, v6
    v_fmac_f32 v8, v7, v7
    v_sub_f32 v7, v19, v6
    v_fmac_f32 v9, v7, v7
    v_sub_f32 v7, v20, v6
    v_fmac_f32 v8, v7, v7
    v_sub_f32 v7, v21, v6
    v_fmac_f32 v9, v7, v7
    v_sub_f32 v7, v22, v6
    v_fmac_f32 v8, v7, v7
    v_sub_f32 v7, v23, v6
    v_fmac_f32 v9, v7, v7
    v_sub_f32 v7, v24, v6
    v_fmac_f32 v8, v7, v7
    v_sub_f32 v7, v25, v6
    v_fmac_f32 v9, v7, v7
    v_sub_f32 v7, v26, v6
    v_fmac_f32 v8, v7, v7
    v_sub_f32 v7, v27, v6
    v_fmac_f32 v9, v7, v7
    v_sub_f32 v7, v28, v6
    v_fmac_f32 v8, v7, v7
    v_sub_f32 v7, v29, v6
    v_fmac_f32 v9, v7, v7
    v_sub_f32 v7, v30, v6
    v_fmac_f32 v8, v7, v7
    v_sub_f32 v7, v31, v6
    v_fmac_f32 v9, v7, v7
    v_sub_f32 v7, v32, v6
    v_fmac_f32 v8, v7, v7
    v_sub_f32 v7, v33, v6
    v_fmac_f32 v9, v7, v7
    v_sub_f32 v7, v34, v6
    v_fmac_f32 v8, v7, v7
    v_sub_f32 v7, v35, v6
    v_fmac_f32 v9, v7, v7
    v_sub_f32 v7, v36, v6
    v_fmac_f32 v8, v7, v7
    v_sub_f32 v7, v37, v6
    v_fmac_f32 v9, v7, v7
    v_sub_f32 v7, v38, v6
    v_fmac_f32 v8, v7, v7
    v_sub_f32 v7, v39, v6
    v_fmac_f32 v9, v7, v7
    v_sub_f32 v7, v40, v6
    v_fmac_f32 v8, v7, v7
    v_sub_f32 v7, v41, v6
    v_fmac_f32 v9, v7, v7
    v_sub_f32 v7, v42, v6
    v_fmac_f32 v8, v7, v7
    v_sub_f32 v7, v43, v6
    v_fmac_f32 v9, v7, v7
    v_sub_f32 v7, v44, v6
    v_fmac_f32 v8, v7, v7
    v_sub_f32 v7, v45, v6
    v_fmac_f32 v9, v7, v7
    v_sub_f32 v7, v46, v6
    v_fmac_f32 v8, v7, v7
    v_sub_f32 v7, v47, v6
    v_fmac_f32 v9, v7, v7
    v_sub_f32 v7, v48, v6
    v_fmac_f32 v8, v7, v7
    v_sub_f32 v7, v49, v6
    v_fmac_f32 v9, v7, v7
    v_sub_f32 v7, v50, v6
    v_fmac_f32 v8, v7, v7
    v_sub_f32 v7, v51, v6
    v_fmac_f32 v9, v7, v7
    v_sub_f32 v7, v52, v6
    v_fmac_f32 v8, v7, v7
    v_sub_f32 v7, v53, v6
    v_fmac_f32 v9, v7, v7
    v_sub_f32 v7, v54, v6
    v_fmac_f32 v8, v7, v7
    v_sub_f32 v7, v55, v6
    v_fmac_f32 v9, v7, v7
    v_sub_f32 v7, v56, v6
    v_fmac_f32 v8, v7, v7
    v_sub_f32 v7, v57, v6
    v_fmac_f32 v9, v7, v7
    v_sub_f32 v7, v58, v6
    v_fmac_f32 v8, v7, v7
    v_sub_f32 v7, v59, v6
    v_fmac_f32 v9, v7, v7
    v_sub_f32 v7, v60, v6
    v_fmac_f32 v8, v7, v7
    v_sub_f32 v7, v61, v6
    v_fmac_f32 v9, v7, v7
    v_sub_f32 v7, v62, v6
    v_fmac_f32 v8, v7, v7
    v_sub_f32 v7, v63, v6
    v_fmac_f32 v9, v7, v7
    v_sub_f32 v7, v64, v6
    v_fmac_f32 v8, v7, v7
    v_sub_f32 v7, v65, v6
    v_fmac_f32 v9, v7, v7
    v_sub_f32 v7, v66, v6
    v_fmac_f32 v8, v7, v7
    v_sub_f32 v7, v67, v6
    v_fmac_f32 v9, v7, v7
    v_sub_f32 v7, v68, v6
    v_fmac_f32 v8, v7, v7
    v_sub_f32 v7, v69, v6
    v_fmac_f32 v9, v7, v7
    v_sub_f32 v7, v70, v6
    v_fmac_f32 v8, v7, v7
    v_sub_f32 v7, v71, v6
    v_fmac_f32 v9, v7, v7
    v_sub_f32 v7, v72, v6
    v_fmac_f32 v8, v7, v7
    v_sub_f32 v7, v73, v6
    v_fmac_f32 v9, v7, v7
    v_sub_f32 v7, v74, v6
    v_fmac_f32 v8, v7, v7
    v_sub_f32 v7, v75, v6
    v_fmac_f32 v9, v7, v7
    v_sub_f32 v7, v76, v6
    v_fmac_f32 v8, v7, v7
    v_sub_f32 v7, v77, v6
    v_fmac_f32 v9, v7, v7
    v_sub_f32 v7, v78, v6
    v_fmac_f32 v8, v7, v7
    v_sub_f32 v7, v79, v6
    v_fmac_f32 v9, v7, v7
    v_add_f32 v8, v8, v9
    s_nop 1
    v_add_f32_dpp v8, v8, v8 quad_perm:[1,0,3,2] row_mask:0xf bank_mask:0xf
    s_nop 1
    v_add_f32_dpp v8, v8, v8 quad_perm:[2,3,0,1] row_mask:0xf bank_mask:0xf
    s_nop 1
    v_add_f32_dpp v8, v8, v8 row_half_mirror row_mask:0xf bank_mask:0xf
    v_mul_f32 v8, 0x3b000000, v8
    v_cvt_pk_bf16_f32 v6, v6, v8
    v_and_b32 v8, s48, v6
    v_lshlrev_b32 v6, 16, v6
    v_add_f32 v8, 0x3727c5ac, v8
    v_cvt_pk_bf16_f32 v8, v8, v8
    v_and_b32 v8, s48, v8
    v_sqrt_f32 v8, v8
    s_nop 0
    v_cvt_pk_bf16_f32 v8, v8, v8
    v_and_b32 v8, s48, v8
    v_rcp_f32 v8, v8
    v_sub_f32 v16, v16, v6
    v_sub_f32 v17, v17, v6
    v_cvt_pk_bf16_f32 v16, v16, v17
    v_and_b32 v17, s48, v16
    v_lshlrev_b32 v16, 16, v16
    v_mul_f32 v16, v16, v8
    v_mul_f32 v17, v17, v8
    v_cvt_pk_bf16_f32 v128, v16, v17
    v_sub_f32 v18, v18, v6
    v_sub_f32 v19, v19, v6
    v_cvt_pk_bf16_f32 v18, v18, v19
    v_and_b32 v19, s48, v18
    v_lshlrev_b32 v18, 16, v18
    v_mul_f32 v18, v18, v8
    v_mul_f32 v19, v19, v8
    v_cvt_pk_bf16_f32 v129, v18, v19
    v_sub_f32 v20, v20, v6
    v_sub_f32 v21, v21, v6
    v_cvt_pk_bf16_f32 v20, v20, v21
    v_and_b32 v21, s48, v20
    v_lshlrev_b32 v20, 16, v20
    v_mul_f32 v20, v20, v8
    v_mul_f32 v21, v21, v8
    v_cvt_pk_bf16_f32 v130, v20, v21
    v_sub_f32 v22, v22, v6
    v_sub_f32 v23, v23, v6
    v_cvt_pk_bf16_f32 v22, v22, v23
    v_and_b32 v23, s48, v22
    v_lshlrev_b32 v22, 16, v22
    v_mul_f32 v22, v22, v8
    v_mul_f32 v23, v23, v8
    v_cvt_pk_bf16_f32 v131, v22, v23
    buffer_store_dwordx4 v[128:131], v4, s[4:7], s47 offen sc1
    s_add_u32 s47, s47, 4096
    v_sub_f32 v24, v24, v6
    v_sub_f32 v25, v25, v6
    v_cvt_pk_bf16_f32 v24, v24, v25
    v_and_b32 v25, s48, v24
    v_lshlrev_b32 v24, 16, v24
    v_mul_f32 v24, v24, v8
    v_mul_f32 v25, v25, v8
    v_cvt_pk_bf16_f32 v132, v24, v25
    v_sub_f32 v26, v26, v6
    v_sub_f32 v27, v27, v6
    v_cvt_pk_bf16_f32 v26, v26, v27
    v_and_b32 v27, s48, v26
    v_lshlrev_b32 v26, 16, v26
    v_mul_f32 v26, v26, v8
    v_mul_f32 v27, v27, v8
    v_cvt_pk_bf16_f32 v133, v26, v27
    v_sub_f32 v28, v28, v6
    v_sub_f32 v29, v29, v6
    v_cvt_pk_bf16_f32 v28, v28, v29
    v_and_b32 v29, s48, v28
    v_lshlrev_b32 v28, 16, v28
    v_mul_f32 v28, v28, v8
    v_mul_f32 v29, v29, v8
    v_cvt_pk_bf16_f32 v134, v28, v29
    v_sub_f32 v30, v30, v6
    v_sub_f32 v31, v31, v6
    v_cvt_pk_bf16_f32 v30, v30, v31
    v_and_b32 v31, s48, v30
    v_lshlrev_b32 v30, 16, v30
    v_mul_f32 v30, v30, v8
    v_mul_f32 v31, v31, v8
    v_cvt_pk_bf16_f32 v135, v30, v31
    buffer_store_dwordx4 v[132:135], v4, s[4:7], s47 offen sc1
    s_add_u32 s47, s47, 4096
    v_sub_f32 v32, v32, v6
    v_sub_f32 v33, v33, v6
    v_cvt_pk_bf16_f32 v32, v32, v33
    v_and_b32 v33, s48, v32
    v_lshlrev_b32 v32, 16, v32
    v_mul_f32 v32, v32, v8
    v_mul_f32 v33, v33, v8
    v_cvt_pk_bf16_f32 v136, v32, v33
    v_sub_f32 v34, v34, v6
    v_sub_f32 v35, v35, v6
    v_cvt_pk_bf16_f32 v34, v34, v35
    v_and_b32 v35, s48, v34
    v_lshlrev_b32 v34, 16, v34
    v_mul_f32 v34, v34, v8
    v_mul_f32 v35, v35, v8
    v_cvt_pk_bf16_f32 v137, v34, v35
    v_sub_f32 v36, v36, v6
    v_sub_f32 v37, v37, v6
    v_cvt_pk_bf16_f32 v36, v36, v37
    v_and_b32 v37, s48, v36
    v_lshlrev_b32 v36, 16, v36
    v_mul_f32 v36, v36, v8
    v_mul_f32 v37, v37, v8
    v_cvt_pk_bf16_f32 v138, v36, v37
    v_sub_f32 v38, v38, v6
    v_sub_f32 v39, v39, v6
    v_cvt_pk_bf16_f32 v38, v38, v39
    v_and_b32 v39, s48, v38
    v_lshlrev_b32 v38, 16, v38
    v_mul_f32 v38, v38, v8
    v_mul_f32 v39, v39, v8
    v_cvt_pk_bf16_f32 v139, v38, v39
    buffer_store_dwordx4 v[136:139], v4, s[4:7], s47 offen sc1
    s_add_u32 s47, s47, 4096
    v_sub_f32 v40, v40, v6
    v_sub_f32 v41, v41, v6
    v_cvt_pk_bf16_f32 v40, v40, v41
    v_and_b32 v41, s48, v40
    v_lshlrev_b32 v40, 16, v40
    v_mul_f32 v40, v40, v8
    v_mul_f32 v41, v41, v8
    v_cvt_pk_bf16_f32 v140, v40, v41
    v_sub_f32 v42, v42, v6
    v_sub_f32 v43, v43, v6
    v_cvt_pk_bf16_f32 v42, v42, v43
    v_and_b32 v43, s48, v42
    v_lshlrev_b32 v42, 16, v42
    v_mul_f32 v42, v42, v8
    v_mul_f32 v43, v43, v8
    v_cvt_pk_bf16_f32 v141, v42, v43
    v_sub_f32 v44, v44, v6
    v_sub_f32 v45, v45, v6
    v_cvt_pk_bf16_f32 v44, v44, v45
    v_and_b32 v45, s48, v44
    v_lshlrev_b32 v44, 16, v44
    v_mul_f32 v44, v44, v8
    v_mul_f32 v45, v45, v8
    v_cvt_pk_bf16_f32 v142, v44, v45
    v_sub_f32 v46, v46, v6
    v_sub_f32 v47, v47, v6
    v_cvt_pk_bf16_f32 v46, v46, v47
    v_and_b32 v47, s48, v46
    v_lshlrev_b32 v46, 16, v46
    v_mul_f32 v46, v46, v8
    v_mul_f32 v47, v47, v8
    v_cvt_pk_bf16_f32 v143, v46, v47
    buffer_store_dwordx4 v[140:143], v4, s[4:7], s47 offen sc1
    s_add_u32 s47, s47, 4096
    v_sub_f32 v48, v48, v6
    v_sub_f32 v49, v49, v6
    v_cvt_pk_bf16_f32 v48, v48, v49
    v_and_b32 v49, s48, v48
    v_lshlrev_b32 v48, 16, v48
    v_mul_f32 v48, v48, v8
    v_mul_f32 v49, v49, v8
    v_cvt_pk_bf16_f32 v144, v48, v49
    v_sub_f32 v50, v50, v6
    v_sub_f32 v51, v51, v6
    v_cvt_pk_bf16_f32 v50, v50, v51
    v_and_b32 v51, s48, v50
    v_lshlrev_b32 v50, 16, v50
    v_mul_f32 v50, v50, v8
    v_mul_f32 v51, v51, v8
    v_cvt_pk_bf16_f32 v145, v50, v51
    v_sub_f32 v52, v52, v6
    v_sub_f32 v53, v53, v6
    v_cvt_pk_bf16_f32 v52, v52, v53
    v_and_b32 v53, s48, v52
    v_lshlrev_b32 v52, 16, v52
    v_mul_f32 v52, v52, v8
    v_mul_f32 v53, v53, v8
    v_cvt_pk_bf16_f32 v146, v52, v53
    v_sub_f32 v54, v54, v6
    v_sub_f32 v55, v55, v6
    v_cvt_pk_bf16_f32 v54, v54, v55
    v_and_b32 v55, s48, v54
    v_lshlrev_b32 v54, 16, v54
    v_mul_f32 v54, v54, v8
    v_mul_f32 v55, v55, v8
    v_cvt_pk_bf16_f32 v147, v54, v55
    buffer_store_dwordx4 v[144:147], v4, s[4:7], s47 offen sc1
    s_add_u32 s47, s47, 4096
    v_sub_f32 v56, v56, v6
    v_sub_f32 v57, v57, v6
    v_cvt_pk_bf16_f32 v56, v56, v57
    v_and_b32 v57, s48, v56
    v_lshlrev_b32 v56, 16, v56
    v_mul_f32 v56, v56, v8
    v_mul_f32 v57, v57, v8
    v_cvt_pk_bf16_f32 v148, v56, v57
    v_sub_f32 v58, v58, v6
    v_sub_f32 v59, v59, v6
    v_cvt_pk_bf16_f32 v58, v58, v59
    v_and_b32 v59, s48, v58
    v_lshlrev_b32 v58, 16, v58
    v_mul_f32 v58, v58, v8
    v_mul_f32 v59, v59, v8
    v_cvt_pk_bf16_f32 v149, v58, v59
    v_sub_f32 v60, v60, v6
    v_sub_f32 v61, v61, v6
    v_cvt_pk_bf16_f32 v60, v60, v61
    v_and_b32 v61, s48, v60
    v_lshlrev_b32 v60, 16, v60
    v_mul_f32 v60, v60, v8
    v_mul_f32 v61, v61, v8
    v_cvt_pk_bf16_f32 v150, v60, v61
    v_sub_f32 v62, v62, v6
    v_sub_f32 v63, v63, v6
    v_cvt_pk_bf16_f32 v62, v62, v63
    v_and_b32 v63, s48, v62
    v_lshlrev_b32 v62, 16, v62
    v_mul_f32 v62, v62, v8
    v_mul_f32 v63, v63, v8
    v_cvt_pk_bf16_f32 v151, v62, v63
    buffer_store_dwordx4 v[148:151], v4, s[4:7], s47 offen sc1
    s_add_u32 s47, s47, 4096
    v_sub_f32 v64, v64, v6
    v_sub_f32 v65, v65, v6
    v_cvt_pk_bf16_f32 v64, v64, v65
    v_and_b32 v65, s48, v64
    v_lshlrev_b32 v64, 16, v64
    v_mul_f32 v64, v64, v8
    v_mul_f32 v65, v65, v8
    v_cvt_pk_bf16_f32 v152, v64, v65
    v_sub_f32 v66, v66, v6
    v_sub_f32 v67, v67, v6
    v_cvt_pk_bf16_f32 v66, v66, v67
    v_and_b32 v67, s48, v66
    v_lshlrev_b32 v66, 16, v66
    v_mul_f32 v66, v66, v8
    v_mul_f32 v67, v67, v8
    v_cvt_pk_bf16_f32 v153, v66, v67
    v_sub_f32 v68, v68, v6
    v_sub_f32 v69, v69, v6
    v_cvt_pk_bf16_f32 v68, v68, v69
    v_and_b32 v69, s48, v68
    v_lshlrev_b32 v68, 16, v68
    v_mul_f32 v68, v68, v8
    v_mul_f32 v69, v69, v8
    v_cvt_pk_bf16_f32 v154, v68, v69
    v_sub_f32 v70, v70, v6
    v_sub_f32 v71, v71, v6
    v_cvt_pk_bf16_f32 v70, v70, v71
    v_and_b32 v71, s48, v70
    v_lshlrev_b32 v70, 16, v70
    v_mul_f32 v70, v70, v8
    v_mul_f32 v71, v71, v8
    v_cvt_pk_bf16_f32 v155, v70, v71
    buffer_store_dwordx4 v[152:155], v4, s[4:7], s47 offen sc1
    s_add_u32 s47, s47, 4096
    v_sub_f32 v72, v72, v6
    v_sub_f32 v73, v73, v6
    v_cvt_pk_bf16_f32 v72, v72, v73
    v_and_b32 v73, s48, v72
    v_lshlrev_b32 v72, 16, v72
    v_mul_f32 v72, v72, v8
    v_mul_f32 v73, v73, v8
    v_cvt_pk_bf16_f32 v156, v72, v73
    v_sub_f32 v74, v74, v6
    v_sub_f32 v75, v75, v6
    v_cvt_pk_bf16_f32 v74, v74, v75
    v_and_b32 v75, s48, v74
    v_lshlrev_b32 v74, 16, v74
    v_mul_f32 v74, v74, v8
    v_mul_f32 v75, v75, v8
    v_cvt_pk_bf16_f32 v157, v74, v75
    v_sub_f32 v76, v76, v6
    v_sub_f32 v77, v77, v6
    v_cvt_pk_bf16_f32 v76, v76, v77
    v_and_b32 v77, s48, v76
    v_lshlrev_b32 v76, 16, v76
    v_mul_f32 v76, v76, v8
    v_mul_f32 v77, v77, v8
    v_cvt_pk_bf16_f32 v158, v76, v77
    v_sub_f32 v78, v78, v6
    v_sub_f32 v79, v79, v6
    v_cvt_pk_bf16_f32 v78, v78, v79
    v_and_b32 v79, s48, v78
    v_lshlrev_b32 v78, 16, v78
    v_mul_f32 v78, v78, v8
    v_mul_f32 v79, v79, v8
    v_cvt_pk_bf16_f32 v159, v78, v79
    buffer_store_dwordx4 v[156:159], v4, s[4:7], s47 offen sc1
    s_add_u32 s47, s47, 4096
    s_waitcnt vmcnt(0)
    s_barrier
    s_cmp_lg_u32 s46, 0
    s_cbranch_scc1 L_ffn_lnup
    v_mov_b32 v10, 132
    v_mov_b32 v11, 2
    s_mov_b64 exec, 1
    global_atomic_add v10, v11, s[40:41]
    s_mov_b64 exec, -1
L_ffn_lnup:
    s_cmp_lg_u32 s46, 0
    s_cbranch_scc1 L_ffn_in
    v_mov_b32 v10, 8
    v_mov_b32 v11, 1
    s_mov_b64 exec, 1
    global_atomic_add v10, v11, s[40:41]
    s_mov_b64 exec, -1
L_ffn_in:
    s_cmp_ge_u32 s54, 11
    s_cbranch_scc1 L_leave
L_ffn_w:
    v_and_b32 v4, 63, v0
    v_lshrrev_b32 v5, 4, v4
    v_and_b32 v6, 15, v4
    v_lshlrev_b32 v7, 2, v5
    v_xor_b32 v6, v6, v7
    v_lshlrev_b32 v13, 4, v6
    s_lshl_b32 s47, s46, 4
    v_add_u32 v6, s47, v5
    v_mul_u32_u24 v6, 2752, v6
    v_add3_u32 v13, v13, v6, s52
    v_bfe_u32 v6, v4, 2, 2
    v_xor_b32 v7, s46, v6
    v_lshlrev_b32 v7, 6, v7
    v_lshl_add_u32 v7, v6, 8, v7
    v_lshrrev_b32 v6, 5, v4
    v_lshl_add_u32 v7, v6, 11, v7
    v_add_u32 v7, 65536, v7
    v_and_b32 v5, 1, v5
    v_and_b32 v6, 3, v4
    v_lshl_add_u32 v15, v5, 5, v7
    v_lshl_add_u32 v15, v6, 3, v15
    v_lshl_add_u32 v14, v5, 4, v7
    v_and_b32 v6, 1, v4
    v_lshl_add_u32 v14, v6, 3, v14
    v_bfe_u32 v6, v4, 1, 1
    v_lshl_add_u32 v14, v6, 5, v14
    s_lshl_b32 s50, s46, 12
    s_add_u32 s50, s50, 65536
    s_mov_b32 s8, s32
    s_mov_b32 s9, s33
    s_mov_b32 s10, 1409024
    s_mov_b32 s11, 0x20000
    s_add_u32 m0, s50, 0
    s_mov_b32 s47, 0
    buffer_load_dwordx4 v13, s[8:11], s47 offen lds
    s_add_u32 m0, s50, 1024
    s_mov_b32 s47, 11008
    buffer_load_dwordx4 v13, s[8:11], s47 offen lds
    s_add_u32 m0, s50, 2048
    s_mov_b32 s47, 22016
    buffer_load_dwordx4 v13, s[8:11], s47 offen lds
    s_add_u32 m0, s50, 3072
    s_mov_b32 s47, 33024
    buffer_load_dwordx4 v13, s[8:11], s47 offen lds
    s_add_u32 m0, s50, 16384
    s_mov_b32 s47, 176128
    buffer_load_dwordx4 v13, s[8:11], s47 offen lds
    s_add_u32 m0, s50, 17408
    s_mov_b32 s47, 187136
    buffer_load_dwordx4 v13, s[8:11], s47 offen lds
    s_add_u32 m0, s50, 18432
    s_mov_b32 s47, 198144
    buffer_load_dwordx4 v13, s[8:11], s47 offen lds
    s_add_u32 m0, s50, 19456
    s_mov_b32 s47, 209152
    buffer_load_dwordx4 v13, s[8:11], s47 offen lds
    s_add_u32 m0, s50, 32768
    s_mov_b32 s47, 352256
    buffer_load_dwordx4 v13, s[8:11], s47 offen lds
    s_add_u32 m0, s50, 33792
    s_mov_b32 s47, 363264
    buffer_load_dwordx4 v13, s[8:11], s47 offen lds
    s_add_u32 m0, s50, 34816
    s_mov_b32 s47, 374272
    buffer_load_dwordx4 v13, s[8:11], s47 offen lds
    s_add_u32 m0, s50, 35840
    s_mov_b32 s47, 385280
    buffer_load_dwordx4 v13, s[8:11], s47 offen lds
    s_waitcnt vmcnt(8) lgkmcnt(0)
    s_barrier
    s_add_u32 m0, s50, 49152
    s_mov_b32 s47, 528384
    buffer_load_dwordx4 v13, s[8:11], s47 offen lds
    s_add_u32 m0, s50, 50176
    s_mov_b32 s47, 539392
    buffer_load_dwordx4 v13, s[8:11], s47 offen lds
    s_add_u32 m0, s50, 51200
    s_mov_b32 s47, 550400
    buffer_load_dwordx4 v13, s[8:11], s47 offen lds
    s_add_u32 m0, s50, 52224
    s_mov_b32 s47, 561408
    buffer_load_dwordx4 v13, s[8:11], s47 offen lds
    ds_read_b64_tr_b16 a[0:1], v14 offset:0
    ds_read_b64_tr_b16 a[2:3], v14 offset:1024
    ds_read_b64_tr_b16 a[4:5], v14 offset:4096
    ds_read_b64_tr_b16 a[6:7], v14 offset:5120
    ds_read_b64_tr_b16 a[8:9], v14 offset:8192
    ds_read_b64_tr_b16 a[10:11], v14 offset:9216
    ds_read_b64_tr_b16 a[12:13], v14 offset:12288
    ds_read_b64_tr_b16 a[14:15], v14 offset:13312
    s_waitcnt vmcnt(8) lgkmcnt(0)
    s_barrier
    s_add_u32 m0, s50, 0
    s_mov_b32 s47, 704512
    buffer_load_dwordx4 v13, s[8:11], s47 offen lds
    s_add_u32 m0, s50, 1024
    s_mov_b32 s47, 715520
    buffer_load_dwordx4 v13, s[8:11], s47 offen lds
    s_add_u32 m0, s50, 2048
    s_mov_b32 s47, 726528
    buffer_load_dwordx4 v13, s[8:11], s47 offen lds
    s_add_u32 m0, s50, 3072
    s_mov_b32 s47, 737536
    buffer_load_dwordx4 v13, s[8:11], s47 offen lds
    ds_read_b64_tr_b16 a[16:17], v14 offset:16384
    ds_read_b64_tr_b16 a[18:19], v14 offset:17408
    ds_read_b64_tr_b16 a[20:21], v14 offset:20480
    ds_read_b64_tr_b16 a[22:23], v14 offset:21504
    ds_read_b64_tr_b16 a[24:25], v14 offset:24576
    ds_read_b64_tr_b16 a[26:27], v14 offset:25600
    ds_read_b64_tr_b16 a[28:29], v14 offset:28672
    ds_read_b64_tr_b16 a[30:31], v14 offset:29696
    s_waitcnt vmcnt(8) lgkmcnt(0)
    s_barrier
    s_add_u32 m0, s50, 16384
    s_mov_b32 s47, 880640
    buffer_load_dwordx4 v13, s[8:11], s47 offen lds
    s_add_u32 m0, s50, 17408
    s_mov_b32 s47, 891648
    buffer_load_dwordx4 v13, s[8:11], s47 offen lds
    s_add_u32 m0, s50, 18432
    s_mov_b32 s47, 902656
    buffer_load_dwordx4 v13, s[8:11], s47 offen lds
    s_add_u32 m0, s50, 19456
    s_mov_b32 s47, 913664
    buffer_load_dwordx4 v13, s[8:11], s47 offen lds
    ds_read_b64_tr_b16 a[32:33], v14 offset:32768
    ds_read_b64_tr_b16 a[34:35], v14 offset:33792
    ds_read_b64_tr_b16 a[36:37], v14 offset:36864
    ds_read_b64_tr_b16 a[38:39], v14 offset:37888
    ds_read_b64_tr_b16 a[40:41], v14 offset:40960
    ds_read_b64_tr_b16 a[42:43], v14 offset:41984
    ds_read_b64_tr_b16 a[44:45], v14 offset:45056
    ds_read_b64_tr_b16 a[46:47], v14 offset:46080
    s_waitcnt vmcnt(8) lgkmcnt(0)
    s_barrier
    s_add_u32 m0, s50, 32768
    s_mov_b32 s47, 1056768
    buffer_load_dwordx4 v13, s[8:11], s47 offen lds
    s_add_u32 m0, s50, 33792
    s_mov_b32 s47, 1067776
    buffer_load_dwordx4 v13, s[8:11], s47 offen lds
    s_add_u32 m0, s50, 34816
    s_mov_b32 s47, 1078784
    buffer_load_dwordx4 v13, s[8:11], s47 offen lds
    s_add_u32 m0, s50, 35840
    s_mov_b32 s47, 1089792
    buffer_load_dwordx4 v13, s[8:11], s47 offen lds
    ds_read_b64_tr_b16 a[48:49], v14 offset:49152
    ds_read_b64_tr_b16 a[50:51], v14 offset:50176
    ds_read_b64_tr_b16 a[52:53], v14 offset:53248
    ds_read_b64_tr_b16 a[54:55], v14 offset:54272
    ds_read_b64_tr_b16 a[56:57], v14 offset:57344
    ds_read_b64_tr_b16 a[58:59], v14 offset:58368
    ds_read_b64_tr_b16 a[60:61], v14 offset:61440
    ds_read_b64_tr_b16 a[62:63], v14 offset:62464
    s_waitcnt vmcnt(8) lgkmcnt(0)
    s_barrier
    s_add_u32 m0, s50, 49152
    s_mov_b32 s47, 1232896
    buffer_load_dwordx4 v13, s[8:11], s47 offen lds
    s_add_u32 m0, s50, 50176
    s_mov_b32 s47, 1243904
    buffer_load_dwordx4 v13, s[8:11], s47 offen lds
    s_add_u32 m0, s50, 51200
    s_mov_b32 s47, 1254912
    buffer_load_dwordx4 v13, s[8:11], s47 offen lds
    s_add_u32 m0, s50, 52224
    s_mov_b32 s47, 1265920
    buffer_load_dwordx4 v13, s[8:11], s47 offen lds
    ds_read_b64_tr_b16 a[64:65], v14 offset:0
    ds_read_b64_tr_b16 a[66:67], v14 offset:1024
    ds_read_b64_tr_b16 a[68:69], v14 offset:4096
    ds_read_b64_tr_b16 a[70:71], v14 offset:5120
    ds_read_b64_tr_b16 a[72:73], v14 offset:8192
    ds_read_b64_tr_b16 a[74:75], v14 offset:9216
    ds_read_b64_tr_b16 a[76:77], v14 offset:12288
    ds_read_b64_tr_b16 a[78:79], v14 offset:13312
    s_waitcnt vmcnt(8) lgkmcnt(0)
    s_barrier
    s_mov_b32 s8, s34
    s_mov_b32 s9, s35
    s_mov_b32 s10, 1409024
    s_mov_b32 s11, 0x20000
    s_add_u32 m0, s50, 0
    s_mov_b32 s47, 0
    buffer_load_dwordx4 v13, s[8:11], s47 offen lds
    s_add_u32 m0, s50, 1024
    s_mov_b32 s47, 11008
    buffer_load_dwordx4 v13, s[8:11], s47 offen lds
    s_add_u32 m0, s50, 2048
    s_mov_b32 s47, 22016
    buffer_load_dwordx4 v13, s[8:11], s47 offen lds
    s_add_u32 m0, s50, 3072
    s_mov_b32 s47, 33024
    buffer_load_dwordx4 v13, s[8:11], s47 offen lds
    ds_read_b64_tr_b16 a[80:81], v14 offset:16384
    ds_read_b64_tr_b16 a[82:83], v14 offset:17408
    ds_read_b64_tr_b16 a[84:85], v14 offset:20480
    ds_read_b64_tr_b16 a[86:87], v14 offset:21504
    ds_read_b64_tr_b16 a[88:89], v14 offset:24576
    ds_read_b64_tr_b16 a[90:91], v14 offset:25600
    ds_read_b64_tr_b16 a[92:93], v14 offset:28672
    ds_read_b64_tr_b16 a[94:95], v14 offset:29696
    s_waitcnt vmcnt(8) lgkmcnt(0)
    s_barrier
    s_add_u32 m0, s50, 16384
    s_mov_b32 s47, 176128
    buffer_load_dwordx4 v13, s[8:11], s47 offen lds
    s_add_u32 m0, s50, 17408
    s_mov_b32 s47, 187136
    buffer_load_dwordx4 v13, s[8:11], s47 offen lds
    s_add_u32 m0, s50, 18432
    s_mov_b32 s47, 198144
    buffer_load_dwordx4 v13, s[8:11], s47 offen lds
    s_add_u32 m0, s50, 19456
    s_mov_b32 s47, 209152
    buffer_load_dwordx4 v13, s[8:11], s47 offen lds
    ds_read_b64_tr_b16 a[96:97], v14 offset:32768
    ds_read_b64_tr_b16 a[98:99], v14 offset:33792
    ds_read_b64_tr_b16 a[100:101], v14 offset:36864
    ds_read_b64_tr_b16 a[102:103], v14 offset:37888
    ds_read_b64_tr_b16 a[104:105], v14 offset:40960
    ds_read_b64_tr_b16 a[106:107], v14 offset:41984
    ds_read_b64_tr_b16 a[108:109], v14 offset:45056
    ds_read_b64_tr_b16 a[110:111], v14 offset:46080
    s_waitcnt vmcnt(8) lgkmcnt(0)
    s_barrier
    s_add_u32 m0, s50, 32768
    s_mov_b32 s47, 352256
    buffer_load_dwordx4 v13, s[8:11], s47 offen lds
    s_add_u32 m0, s50, 33792
    s_mov_b32 s47, 363264
    buffer_load_dwordx4 v13, s[8:11], s47 offen lds
    s_add_u32 m0, s50, 34816
    s_mov_b32 s47, 374272
    buffer_load_dwordx4 v13, s[8:11], s47 offen lds
    s_add_u32 m0, s50, 35840
    s_mov_b32 s47, 385280
    buffer_load_dwordx4 v13, s[8:11], s47 offen lds
    ds_read_b64_tr_b16 a[112:113], v14 offset:49152
    ds_read_b64_tr_b16 a[114:115], v14 offset:50176
    ds_read_b64_tr_b16 a[116:117], v14 offset:53248
    ds_read_b64_tr_b16 a[118:119], v14 offset:54272
    ds_read_b64_tr_b16 a[120:121], v14 offset:57344
    ds_read_b64_tr_b16 a[122:123], v14 offset:58368
    ds_read_b64_tr_b16 a[124:125], v14 offset:61440
    ds_read_b64_tr_b16 a[126:127], v14 offset:62464
    s_waitcnt vmcnt(8) lgkmcnt(0)
    s_barrier
    s_add_u32 m0, s50, 49152
    s_mov_b32 s47, 528384
    buffer_load_dwordx4 v13, s[8:11], s47 offen lds
    s_add_u32 m0, s50, 50176
    s_mov_b32 s47, 539392
    buffer_load_dwordx4 v13, s[8:11], s47 offen lds
    s_add_u32 m0, s50, 51200
    s_mov_b32 s47, 550400
    buffer_load_dwordx4 v13, s[8:11], s47 offen lds
    s_add_u32 m0, s50, 52224
    s_mov_b32 s47, 561408
    buffer_load_dwordx4 v13, s[8:11], s47 offen lds
    ds_read_b64_tr_b16 a[128:129], v14 offset:0
    ds_read_b64_tr_b16 a[130:131], v14 offset:1024
    ds_read_b64_tr_b16 a[132:133], v14 offset:4096
    ds_read_b64_tr_b16 a[134:135], v14 offset:5120
    ds_read_b64_tr_b16 a[136:137], v14 offset:8192
    ds_read_b64_tr_b16 a[138:139], v14 offset:9216
    ds_read_b64_tr_b16 a[140:141], v14 offset:12288
    ds_read_b64_tr_b16 a[142:143], v14 offset:13312
    s_waitcnt vmcnt(8) lgkmcnt(0)
    s_barrier
    s_add_u32 m0, s50, 0
    s_mov_b32 s47, 704512
    buffer_load_dwordx4 v13, s[8:11], s47 offen lds
    s_add_u32 m0, s50, 1024
    s_mov_b32 s47, 715520
    buffer_load_dwordx4 v13, s[8:11], s47 offen lds
    s_add_u32 m0, s50, 2048
    s_mov_b32 s47, 726528
    buffer_load_dwordx4 v13, s[8:11], s47 offen lds
    s_add_u32 m0, s50, 3072
    s_mov_b32 s47, 737536
    buffer_load_dwordx4 v13, s[8:11], s47 offen lds
    ds_read_b64_tr_b16 a[144:145], v14 offset:16384
    ds_read_b64_tr_b16 a[146:147], v14 offset:17408
    ds_read_b64_tr_b16 a[148:149], v14 offset:20480
    ds_read_b64_tr_b16 a[150:151], v14 offset:21504
    ds_read_b64_tr_b16 a[152:153], v14 offset:24576
    ds_read_b64_tr_b16 a[154:155], v14 offset:25600
    ds_read_b64_tr_b16 a[156:157], v14 offset:28672
    ds_read_b64_tr_b16 a[158:159], v14 offset:29696
    s_waitcnt vmcnt(8) lgkmcnt(0)
    s_barrier
    s_add_u32 m0, s50, 16384
    s_mov_b32 s47, 880640
    buffer_load_dwordx4 v13, s[8:11], s47 offen lds
    s_add_u32 m0, s50, 17408
    s_mov_b32 s47, 891648
    buffer_load_dwordx4 v13, s[8:11], s47 offen lds
    s_add_u32 m0, s50, 18432
    s_mov_b32 s47, 902656
    buffer_load_dwordx4 v13, s[8:11], s47 offen lds
    s_add_u32 m0, s50, 19456
    s_mov_b32 s47, 913664
    buffer_load_dwordx4 v13, s[8:11], s47 offen lds
    ds_read_b64_tr_b16 a[160:161], v14 offset:32768
    ds_read_b64_tr_b16 a[162:163], v14 offset:33792
    ds_read_b64_tr_b16 a[164:165], v14 offset:36864
    ds_read_b64_tr_b16 a[166:167], v14 offset:37888
    ds_read_b64_tr_b16 a[168:169], v14 offset:40960
    ds_read_b64_tr_b16 a[170:171], v14 offset:41984
    ds_read_b64_tr_b16 a[172:173], v14 offset:45056
    ds_read_b64_tr_b16 a[174:175], v14 offset:46080
    s_waitcnt vmcnt(8) lgkmcnt(0)
    s_barrier
    s_add_u32 m0, s50, 32768
    s_mov_b32 s47, 1056768
    buffer_load_dwordx4 v13, s[8:11], s47 offen lds
    s_add_u32 m0, s50, 33792
    s_mov_b32 s47, 1067776
    buffer_load_dwordx4 v13, s[8:11], s47 offen lds
    s_add_u32 m0, s50, 34816
    s_mov_b32 s47, 1078784
    buffer_load_dwordx4 v13, s[8:11], s47 offen lds
    s_add_u32 m0, s50, 35840
    s_mov_b32 s47, 1089792
    buffer_load_dwordx4 v13, s[8:11], s47 offen lds
    ds_read_b64_tr_b16 a[176:177], v14 offset:49152
    ds_read_b64_tr_b16 a[178:179], v14 offset:50176
    ds_read_b64_tr_b16 a[180:181], v14 offset:53248
    ds_read_b64_tr_b16 a[182:183], v14 offset:54272
    ds_read_b64_tr_b16 a[184:185], v14 offset:57344
    ds_read_b64_tr_b16 a[186:187], v14 offset:58368
    ds_read_b64_tr_b16 a[188:189], v14 offset:61440
    ds_read_b64_tr_b16 a[190:191], v14 offset:62464
    s_waitcnt vmcnt(8) lgkmcnt(0)
    s_barrier
    s_add_u32 m0, s50, 49152
    s_mov_b32 s47, 1232896
    buffer_load_dwordx4 v13, s[8:11], s47 offen lds
    s_add_u32 m0, s50, 50176
    s_mov_b32 s47, 1243904
    buffer_load_dwordx4 v13, s[8:11], s47 offen lds
    s_add_u32 m0, s50, 51200
    s_mov_b32 s47, 1254912
    buffer_load_dwordx4 v13, s[8:11], s47 offen lds
    s_add_u32 m0, s50, 52224
    s_mov_b32 s47, 1265920
    buffer_load_dwordx4 v13, s[8:11], s47 offen lds
    ds_read_b64_tr_b16 a[192:193], v14 offset:0
    ds_read_b64_tr_b16 a[194:195], v14 offset:1024
    ds_read_b64_tr_b16 a[196:197], v14 offset:4096
    ds_read_b64_tr_b16 a[198:199], v14 offset:5120
    ds_read_b64_tr_b16 a[200:201], v14 offset:8192
    ds_read_b64_tr_b16 a[202:203], v14 offset:9216
    ds_read_b64_tr_b16 a[204:205], v14 offset:12288
    ds_read_b64_tr_b16 a[206:207], v14 offset:13312
    s_waitcnt vmcnt(8) lgkmcnt(0)
    s_barrier
    ds_read_b64_tr_b16 a[208:209], v14 offset:16384
    ds_read_b64_tr_b16 a[210:211], v14 offset:17408
    ds_read_b64_tr_b16 a[212:213], v14 offset:20480
    ds_read_b64_tr_b16 a[214:215], v14 offset:21504
    ds_read_b64_tr_b16 a[216:217], v14 offset:24576
    ds_read_b64_tr_b16 a[218:219], v14 offset:25600
    ds_read_b64_tr_b16 a[220:221], v14 offset:28672
    ds_read_b64_tr_b16 a[222:223], v14 offset:29696
    s_waitcnt vmcnt(4) lgkmcnt(0)
    s_barrier
    ds_read_b64_tr_b16 a[224:225], v14 offset:32768
    ds_read_b64_tr_b16 a[226:227], v14 offset:33792
    ds_read_b64_tr_b16 a[228:229], v14 offset:36864
    ds_read_b64_tr_b16 a[230:231], v14 offset:37888
    ds_read_b64_tr_b16 a[232:233], v14 offset:40960
    ds_read_b64_tr_b16 a[234:235], v14 offset:41984
    ds_read_b64_tr_b16 a[236:237], v14 offset:45056
    ds_read_b64_tr_b16 a[238:239], v14 offset:46080
    s_waitcnt vmcnt(0) lgkmcnt(0)
    s_barrier
    ds_read_b64_tr_b16 a[240:241], v14 offset:49152
    ds_read_b64_tr_b16 a[242:243], v14 offset:50176
    ds_read_b64_tr_b16 a[244:245], v14 offset:53248
    ds_read_b64_tr_b16 a[246:247], v14 offset:54272
    ds_read_b64_tr_b16 a[248:249], v14 offset:57344
    ds_read_b64_tr_b16 a[250:251], v14 offset:58368
    ds_read_b64_tr_b16 a[252:253], v14 offset:61440
    ds_read_b64_tr_b16 a[254:255], v14 offset:62464
    s_waitcnt lgkmcnt(0)
    v_bfe_u32 v5, v0, 4, 1
    v_mul_u32_u24 v8, 45056, v5
    v_bfe_u32 v5, v0, 5, 1
    v_lshl_add_u32 v8, v5, 8, v8
    v_and_b32 v5, 15, v0
    v_lshl_add_u32 v8, v5, 4, v8
    s_lshl_b32 s47, s46, 10
    v_add_u32 v8, s47, v8
    s_mov_b32 s62, 0xffff0000
    s_mov_b32 s63, 0xbdd2d3e8
    s_mov_b32 s64, 0xc0135761
    v_and_b32 v4, 63, v0
    v_lshlrev_b32 v1, 4, v4
    v_mov_b32 v2, v1
    s_lshl_b32 s61, s46, 13
    s_add_u32 s56, s61, 4194304
    s_mov_b32 s60, -1
    s_mov_b32 s55, s53
    s_mov_b32 s57, 0x40000000
    v_mov_b32 v112, s64
    s_cmp_lg_u32 s46, 0
    s_cbranch_scc1 L_ffn_ln_out
    v_mov_b32 v10, 132
L_ffn_ln:
    global_load_dword v11, v10, s[40:41] sc1
    s_add_u32 s3, s3, 1
    s_cmp_gt_u32 s3, 262144
    s_waitcnt vmcnt(0)
    s_cbranch_scc1 L_ffn_ln_out
    v_cmp_gt_u32 vcc, 64, v11
    s_cbranch_vccz L_ffn_ln_out
    s_sleep 8
    s_branch L_ffn_ln
L_ffn_ln_out:
    s_barrier
    s_lshl_b32 s49, s55, 15
    s_add_u32 s49, s49, s56
    s_add_u32 m0, s61, 0
    s_add_u32 s48, s49, 0
    buffer_load_dwordx4 v1, s[4:7], s48 offen offset:0 sc1 lds
    buffer_load_dwordx4 v1, s[4:7], s48 offen offset:1024 sc1 lds
    buffer_load_dwordx4 v1, s[4:7], s48 offen offset:2048 sc1 lds
    buffer_load_dwordx4 v1, s[4:7], s48 offen offset:3072 sc1 lds
    s_add_u32 m0, s61, 4096
    s_add_u32 s48, s49, 4096
    buffer_load_dwordx4 v1, s[4:7], s48 offen offset:0 sc1 lds
    buffer_load_dwordx4 v1, s[4:7], s48 offen offset:1024 sc1 lds
    buffer_load_dwordx4 v1, s[4:7], s48 offen offset:2048 sc1 lds
    buffer_load_dwordx4 v1, s[4:7], s48 offen offset:3072 sc1 lds
    s_xor_b32 s61, s61, 32768
    s_waitcnt vmcnt(0)
L_ffn_seg:
    s_add_u32 s55, s53, s58
    s_waitcnt vmcnt(2)
    s_barrier
    ds_read_b128 v[16:19], v2 offset:0
    ds_read_b128 v[20:23], v2 offset:1024
    ds_read_b128 v[24:27], v2 offset:2048
    s_waitcnt lgkmcnt(2)
    v_mfma_f32_32x32x16_bf16 v[32:47], a[0:3], v[16:19], 0
    ds_read_b128 v[28:31], v2 offset:3072
    v_and_b32 v132, s62, v128
    v_lshlrev_b32 v128, 16, v128
    v_and_b32 v148, s62, v144
    v_lshlrev_b32 v144, 16, v144
    v_mfma_f32_32x32x16_bf16 v[48:63], a[128:131], v[16:19], 0
    s_lshl_b32 s49, s55, 15
    s_add_u32 s49, s49, s56
    s_add_u32 m0, s61, 0
    s_add_u32 s48, s49, 0
    buffer_load_dwordx4 v1, s[4:7], s48 offen offset:0 sc1 lds
    v_and_b32 v133, s62, v129
    v_lshlrev_b32 v129, 16, v129
    v_and_b32 v149, s62, v145
    v_lshlrev_b32 v145, 16, v145
    s_waitcnt lgkmcnt(2)
    v_mfma_f32_32x32x16_bf16 v[32:47], a[4:7], v[20:23], v[32:47]
    ds_read_b128 v[16:19], v2 offset:4096
    v_and_b32 v134, s62, v130
    v_lshlrev_b32 v130, 16, v130
    v_and_b32 v150, s62, v146
    v_lshlrev_b32 v146, 16, v146
    v_mfma_f32_32x32x16_bf16 v[48:63], a[132:135], v[20:23], v[48:63]
    buffer_load_dwordx4 v1, s[4:7], s48 offen offset:1024 sc1 lds
    v_and_b32 v135, s62, v131
    v_lshlrev_b32 v131, 16, v131
    v_and_b32 v151, s62, v147
    v_lshlrev_b32 v147, 16, v147
    s_waitcnt lgkmcnt(2)
    v_mfma_f32_32x32x16_bf16 v[32:47], a[8:11], v[24:27], v[32:47]
    ds_read_b128 v[20:23], v2 offset:5120
    v_mul_f32 v96, v128, v128
    v_mul_f32 v97, v129, v129
    v_mul_f32 v98, v130, v130
    v_mul_f32 v99, v131, v131
    v_mfma_f32_32x32x16_bf16 v[48:63], a[136:139], v[24:27], v[48:63]
    buffer_load_dwordx4 v1, s[4:7], s48 offen offset:2048 sc1 lds
    v_mul_f32 v100, v132, v132
    v_mul_f32 v101, v133, v133
    v_mul_f32 v102, v134, v134
    v_mul_f32 v103, v135, v135
    s_waitcnt lgkmcnt(2)
    v_mfma_f32_32x32x16_bf16 v[32:47], a[12:15], v[28:31], v[32:47]
    ds_read_b128 v[24:27], v2 offset:6144
    v_fma_f32 v96, v96, s63, v112
    v_fma_f32 v97, v97, s63, v112
    v_fma_f32 v98, v98, s63, v112
    v_fma_f32 v99, v99, s63, v112
    v_mfma_f32_32x32x16_bf16 v[48:63], a[140:143], v[28:31], v[48:63]
    buffer_load_dwordx4 v1, s[4:7], s48 offen offset:3072 sc1 lds
    v_fma_f32 v100, v100, s63, v112
    v_fma_f32 v101, v101, s63, v112
    v_fma_f32 v102, v102, s63, v112
    v_fma_f32 v103, v103, s63, v112
    s_waitcnt lgkmcnt(2)
    v_mfma_f32_32x32x16_bf16 v[32:47], a[16:19], v[16:19], v[32:47]
    ds_read_b128 v[28:31], v2 offset:7168
    v_mul_f32 v96, v96, v128
    v_mul_f32 v97, v97, v129
    v_mul_f32 v98, v98, v130
    v_mul_f32 v99, v99, v131
    v_mfma_f32_32x32x16_bf16 v[48:63], a[144:147], v[16:19], v[48:63]
    s_add_u32 m0, s61, 4096
    s_add_u32 s48, s49, 4096
    buffer_load_dwordx4 v1, s[4:7], s48 offen offset:0 sc1 lds
    v_mul_f32 v100, v100, v132
    v_mul_f32 v101, v101, v133
    v_mul_f32 v102, v102, v134
    v_mul_f32 v103, v103, v135
    s_waitcnt lgkmcnt(2)
    v_mfma_f32_32x32x16_bf16 v[32:47], a[20:23], v[20:23], v[32:47]
    ds_read_b128 v[16:19], v2 offset:8192
    v_exp_f32 v96, v96
    v_exp_f32 v97, v97
    v_mfma_f32_32x32x16_bf16 v[48:63], a[148:151], v[20:23], v[48:63]
    buffer_load_dwordx4 v1, s[4:7], s48 offen offset:1024 sc1 lds
    v_exp_f32 v98, v98
    v_exp_f32 v99, v99
    s_waitcnt lgkmcnt(2)
    v_mfma_f32_32x32x16_bf16 v[32:47], a[24:27], v[24:27], v[32:47]
    ds_read_b128 v[20:23], v2 offset:9216
    v_exp_f32 v100, v100
    v_exp_f32 v101, v101
    v_mfma_f32_32x32x16_bf16 v[48:63], a[152:155], v[24:27], v[48:63]
    buffer_load_dwordx4 v1, s[4:7], s48 offen offset:2048 sc1 lds
    v_exp_f32 v102, v102
    v_exp_f32 v103, v103
    s_waitcnt lgkmcnt(2)
    v_mfma_f32_32x32x16_bf16 v[32:47], a[28:31], v[28:31], v[32:47]
    ds_read_b128 v[24:27], v2 offset:10240
    v_add_f32 v96, 1.0, v96
    v_add_f32 v97, 1.0, v97
    v_add_f32 v98, 1.0, v98
    v_add_f32 v99, 1.0, v99
    v_mfma_f32_32x32x16_bf16 v[48:63], a[156:159], v[28:31], v[48:63]
    buffer_load_dwordx4 v1, s[4:7], s48 offen offset:3072 sc1 lds
    v_add_f32 v100, 1.0, v100
    v_add_f32 v101, 1.0, v101
    v_add_f32 v102, 1.0, v102
    v_add_f32 v103, 1.0, v103
    s_waitcnt lgkmcnt(2)
    v_mfma_f32_32x32x16_bf16 v[32:47], a[32:35], v[16:19], v[32:47]
    ds_read_b128 v[28:31], v2 offset:11264
    v_rcp_f32 v96, v96
    v_rcp_f32 v97, v97
    v_mfma_f32_32x32x16_bf16 v[48:63], a[160:163], v[16:19], v[48:63]
    s_xor_b32 s61, s61, 32768
    v_rcp_f32 v98, v98
    v_rcp_f32 v99, v99
    s_waitcnt lgkmcnt(2)
    v_mfma_f32_32x32x16_bf16 v[32:47], a[36:39], v[20:23], v[32:47]
    ds_read_b128 v[16:19], v2 offset:12288
    v_rcp_f32 v100, v100
    v_rcp_f32 v101, v101
    v_mfma_f32_32x32x16_bf16 v[48:63], a[164:167], v[20:23], v[48:63]
    v_rcp_f32 v102, v102
    v_rcp_f32 v103, v103
    s_waitcnt lgkmcnt(2)
    v_mfma_f32_32x32x16_bf16 v[32:47], a[40:43], v[24:27], v[32:47]
    ds_read_b128 v[20:23], v2 offset:13312
    v_mul_f32 v128, v128, v96
    v_mul_f32 v129, v129, v97
    v_mul_f32 v130, v130, v98
    v_mul_f32 v131, v131, v99
    v_mfma_f32_32x32x16_bf16 v[48:63], a[168:171], v[24:27], v[48:63]
    v_mul_f32 v132, v132, v100
    v_mul_f32 v133, v133, v101
    v_mul_f32 v134, v134, v102
    v_mul_f32 v135, v135, v103
    s_waitcnt lgkmcnt(2)
    v_mfma_f32_32x32x16_bf16 v[32:47], a[44:47], v[28:31], v[32:47]
    ds_read_b128 v[24:27], v2 offset:14336
    v_cvt_pk_bf16_f32 v128, v128, v132
    v_and_b32 v132, s62, v128
    v_lshlrev_b32 v128, 16, v128
    v_cvt_pk_bf16_f32 v129, v129, v133
    v_mfma_f32_32x32x16_bf16 v[48:63], a[172:175], v[28:31], v[48:63]
    v_and_b32 v133, s62, v129
    v_lshlrev_b32 v129, 16, v129
    v_cvt_pk_bf16_f32 v130, v130, v134
    v_and_b32 v134, s62, v130
    s_waitcnt lgkmcnt(2)
    v_mfma_f32_32x32x16_bf16 v[32:47], a[48:51], v[16:19], v[32:47]
    ds_read_b128 v[28:31], v2 offset:15360
    v_lshlrev_b32 v130, 16, v130
    v_cvt_pk_bf16_f32 v131, v131, v135
    v_and_b32 v135, s62, v131
    v_lshlrev_b32 v131, 16, v131
    v_mfma_f32_32x32x16_bf16 v[48:63], a[176:179], v[16:19], v[48:63]
    v_mul_f32 v128, v128, v144
    v_mul_f32 v129, v129, v145
    v_mul_f32 v130, v130, v146
    v_mul_f32 v131, v131, v147
    s_waitcnt lgkmcnt(2)
    v_mfma_f32_32x32x16_bf16 v[32:47], a[52:55], v[20:23], v[32:47]
    ds_read_b128 v[16:19], v2 offset:16384
    v_mul_f32 v132, v132, v148
    v_mul_f32 v133, v133, v149
    v_mul_f32 v134, v134, v150
    v_mul_f32 v135, v135, v151
    v_mfma_f32_32x32x16_bf16 v[48:63], a[180:183], v[20:23], v[48:63]
    v_cvt_pk_bf16_f32 v80, v128, v132
    v_cvt_pk_bf16_f32 v81, v129, v133
    v_cvt_pk_bf16_f32 v82, v130, v134
    v_cvt_pk_bf16_f32 v83, v131, v135
    s_waitcnt lgkmcnt(2)
    v_mfma_f32_32x32x16_bf16 v[32:47], a[56:59], v[24:27], v[32:47]
    ds_read_b128 v[20:23], v2 offset:17408
    buffer_store_dwordx4 v[80:83], v8, s[4:7], s57 offen offset:0 sc1
    v_and_b32 v140, s62, v136
    v_lshlrev_b32 v136, 16, v136
    v_mfma_f32_32x32x16_bf16 v[48:63], a[184:187], v[24:27], v[48:63]
    v_and_b32 v156, s62, v152
    v_lshlrev_b32 v152, 16, v152
    v_and_b32 v141, s62, v137
    v_lshlrev_b32 v137, 16, v137
    s_waitcnt lgkmcnt(2)
    v_mfma_f32_32x32x16_bf16 v[32:47], a[60:63], v[28:31], v[32:47]
    ds_read_b128 v[24:27], v2 offset:18432
    v_and_b32 v157, s62, v153
    v_lshlrev_b32 v153, 16, v153
    v_and_b32 v142, s62, v138
    v_lshlrev_b32 v138, 16, v138
    v_mfma_f32_32x32x16_bf16 v[48:63], a[188:191], v[28:31], v[48:63]
    v_and_b32 v158, s62, v154
    v_lshlrev_b32 v154, 16, v154
    v_and_b32 v143, s62, v139
    v_lshlrev_b32 v139, 16, v139
    s_waitcnt lgkmcnt(2)
    v_mfma_f32_32x32x16_bf16 v[32:47], a[64:67], v[16:19], v[32:47]
    ds_read_b128 v[28:31], v2 offset:19456
    v_and_b32 v159, s62, v155
    v_lshlrev_b32 v155, 16, v155
    v_mul_f32 v104, v136, v136
    v_mul_f32 v105, v137, v137
    v_mfma_f32_32x32x16_bf16 v[48:63], a[192:195], v[16:19], v[48:63]
    v_mul_f32 v106, v138, v138
    v_mul_f32 v107, v139, v139
    v_mul_f32 v108, v140, v140
    v_mul_f32 v109, v141, v141
    s_waitcnt lgkmcnt(2)
    v_mfma_f32_32x32x16_bf16 v[32:47], a[68:71], v[20:23], v[32:47]
    ds_read_b128 v[16:19], v2 offset:20480
    v_mul_f32 v110, v142, v142
    v_mul_f32 v111, v143, v143
    v_fma_f32 v104, v104, s63, v112
    v_fma_f32 v105, v105, s63, v112
    v_mfma_f32_32x32x16_bf16 v[48:63], a[196:199], v[20:23], v[48:63]
    v_fma_f32 v106, v106, s63, v112
    v_fma_f32 v107, v107, s63, v112
    v_fma_f32 v108, v108, s63, v112
    v_fma_f32 v109, v109, s63, v112
    s_waitcnt lgkmcnt(2)
    v_mfma_f32_32x32x16_bf16 v[32:47], a[72:75], v[24:27], v[32:47]
    ds_read_b128 v[20:23], v2 offset:21504
    v_fma_f32 v110, v110, s63, v112
    v_fma_f32 v111, v111, s63, v112
    v_mul_f32 v104, v104, v136
    v_mul_f32 v105, v105, v137
    v_mfma_f32_32x32x16_bf16 v[48:63], a[200:203], v[24:27], v[48:63]
    v_mul_f32 v106, v106, v138
    v_mul_f32 v107, v107, v139
    v_mul_f32 v108, v108, v140
    v_mul_f32 v109, v109, v141
    s_waitcnt lgkmcnt(2)
    v_mfma_f32_32x32x16_bf16 v[32:47], a[76:79], v[28:31], v[32:47]
    ds_read_b128 v[24:27], v2 offset:22528
    v_mul_f32 v110, v110, v142
    v_mul_f32 v111, v111, v143
    v_exp_f32 v104, v104
    v_mfma_f32_32x32x16_bf16 v[48:63], a[204:207], v[28:31], v[48:63]
    v_exp_f32 v105, v105
    v_exp_f32 v106, v106
    s_waitcnt lgkmcnt(2)
    v_mfma_f32_32x32x16_bf16 v[32:47], a[80:83], v[16:19], v[32:47]
    ds_read_b128 v[28:31], v2 offset:23552
    v_exp_f32 v107, v107
    v_exp_f32 v108, v108
    v_mfma_f32_32x32x16_bf16 v[48:63], a[208:211], v[16:19], v[48:63]
    v_exp_f32 v109, v109
    v_exp_f32 v110, v110
    s_waitcnt lgkmcnt(2)
    v_mfma_f32_32x32x16_bf16 v[32:47], a[84:87], v[20:23], v[32:47]
    ds_read_b128 v[16:19], v2 offset:24576
    v_exp_f32 v111, v111
    v_add_f32 v104, 1.0, v104
    v_add_f32 v105, 1.0, v105
    v_mfma_f32_32x32x16_bf16 v[48:63], a[212:215], v[20:23], v[48:63]
    v_add_f32 v106, 1.0, v106
    v_add_f32 v107, 1.0, v107
    v_add_f32 v108, 1.0, v108
    v_add_f32 v109, 1.0, v109
    s_waitcnt lgkmcnt(2)
    v_mfma_f32_32x32x16_bf16 v[32:47], a[88:91], v[24:27], v[32:47]
    ds_read_b128 v[20:23], v2 offset:25600
    v_add_f32 v110, 1.0, v110
    v_add_f32 v111, 1.0, v111
    v_rcp_f32 v104, v104
    v_mfma_f32_32x32x16_bf16 v[48:63], a[216:219], v[24:27], v[48:63]
    v_rcp_f32 v105, v105
    v_rcp_f32 v106, v106
    s_waitcnt lgkmcnt(2)
    v_mfma_f32_32x32x16_bf16 v[32:47], a[92:95], v[28:31], v[32:47]
    ds_read_b128 v[24:27], v2 offset:26624
    v_rcp_f32 v107, v107
    v_rcp_f32 v108, v108
    v_mfma_f32_32x32x16_bf16 v[48:63], a[220:223], v[28:31], v[48:63]
    v_rcp_f32 v109, v109
    v_rcp_f32 v110, v110
    s_waitcnt lgkmcnt(2)
    v_mfma_f32_32x32x16_bf16 v[32:47], a[96:99], v[16:19], v[32:47]
    ds_read_b128 v[28:31], v2 offset:27648
    v_rcp_f32 v111, v111
    v_mul_f32 v136, v136, v104
    v_mul_f32 v137, v137, v105
    v_mfma_f32_32x32x16_bf16 v[48:63], a[224:227], v[16:19], v[48:63]
    v_mul_f32 v138, v138, v106
    v_mul_f32 v139, v139, v107
    v_mul_f32 v140, v140, v108
    v_mul_f32 v141, v141, v109
    s_waitcnt lgkmcnt(2)
    v_mfma_f32_32x32x16_bf16 v[32:47], a[100:103], v[20:23], v[32:47]
    ds_read_b128 v[16:19], v2 offset:28672
    v_mul_f32 v142, v142, v110
    v_mul_f32 v143, v143, v111
    v_cvt_pk_bf16_f32 v136, v136, v140
    v_and_b32 v140, s62, v136
    v_mfma_f32_32x32x16_bf16 v[48:63], a[228:231], v[20:23], v[48:63]
    v_lshlrev_b32 v136, 16, v136
    v_cvt_pk_bf16_f32 v137, v137, v141
    v_and_b32 v141, s62, v137
    v_lshlrev_b32 v137, 16, v137
    s_waitcnt lgkmcnt(2)
    v_mfma_f32_32x32x16_bf16 v[32:47], a[104:107], v[24:27], v[32:47]
    ds_read_b128 v[20:23], v2 offset:29696
    v_cvt_pk_bf16_f32 v138, v138, v142
    v_and_b32 v142, s62, v138
    v_lshlrev_b32 v138, 16, v138
    v_cvt_pk_bf16_f32 v139, v139, v143
    v_mfma_f32_32x32x16_bf16 v[48:63], a[232:235], v[24:27], v[48:63]
    v_and_b32 v143, s62, v139
    v_lshlrev_b32 v139, 16, v139
    v_mul_f32 v136, v136, v152
    v_mul_f32 v137, v137, v153
    s_waitcnt lgkmcnt(2)
    v_mfma_f32_32x32x16_bf16 v[32:47], a[108:111], v[28:31], v[32:47]
    ds_read_b128 v[24:27], v2 offset:30720
    v_mul_f32 v138, v138, v154
    v_mul_f32 v139, v139, v155
    v_mul_f32 v140, v140, v156
    v_mul_f32 v141, v141, v157
    v_mfma_f32_32x32x16_bf16 v[48:63], a[236:239], v[28:31], v[48:63]
    v_mul_f32 v142, v142, v158
    v_mul_f32 v143, v143, v159
    v_cvt_pk_bf16_f32 v84, v136, v140
    v_cvt_pk_bf16_f32 v85, v137, v141
    s_waitcnt lgkmcnt(2)
    v_mfma_f32_32x32x16_bf16 v[32:47], a[112:115], v[16:19], v[32:47]
    ds_read_b128 v[28:31], v2 offset:31744
    v_cvt_pk_bf16_f32 v86, v138, v142
    v_cvt_pk_bf16_f32 v87, v139, v143
    buffer_store_dwordx4 v[84:87], v8, s[4:7], s57 offen offset:512 sc1
    v_mfma_f32_32x32x16_bf16 v[48:63], a[240:243], v[16:19], v[48:63]
    s_waitcnt lgkmcnt(2)
    v_mfma_f32_32x32x16_bf16 v[32:47], a[116:119], v[20:23], v[32:47]
    v_mfma_f32_32x32x16_bf16 v[48:63], a[244:247], v[20:23], v[48:63]
    s_waitcnt lgkmcnt(1)
    v_mfma_f32_32x32x16_bf16 v[32:47], a[120:123], v[24:27], v[32:47]
    v_mfma_f32_32x32x16_bf16 v[48:63], a[248:251], v[24:27], v[48:63]
    s_waitcnt lgkmcnt(0)
    v_mfma_f32_32x32x16_bf16 v[32:47], a[124:127], v[28:31], v[32:47]
    v_mfma_f32_32x32x16_bf16 v[48:63], a[252:255], v[28:31], v[48:63]
    v_xor_b32 v2, 0x8000, v2
    s_nop 7
    s_nop 1
    s_mul_i32 s57, s53, 90112
    s_lshl_b32 s47, s54, 12
    s_add_u32 s57, s57, s47
    s_add_u32 s57, s57, 92274688
    v_cvt_pk_bf16_f32 v128, v32, v36
    v_cvt_pk_bf16_f32 v129, v33, v37
    v_cvt_pk_bf16_f32 v130, v34, v38
    v_cvt_pk_bf16_f32 v131, v35, v39
    v_cvt_pk_bf16_f32 v136, v40, v44
    v_cvt_pk_bf16_f32 v137, v41, v45
    v_cvt_pk_bf16_f32 v138, v42, v46
    v_cvt_pk_bf16_f32 v139, v43, v47
    v_cvt_pk_bf16_f32 v144, v48, v52
    v_cvt_pk_bf16_f32 v145, v49, v53
    v_cvt_pk_bf16_f32 v146, v50, v54
    v_cvt_pk_bf16_f32 v147, v51, v55
    v_cvt_pk_bf16_f32 v152, v56, v60
    v_cvt_pk_bf16_f32 v153, v57, v61
    v_cvt_pk_bf16_f32 v154, v58, v62
    v_cvt_pk_bf16_f32 v155, v59, v63
    s_mov_b32 s53, s55
    s_cmp_lt_u32 s53, 64
    s_cbranch_scc1 L_ffn_seg
    v_and_b32 v132, s62, v128
    v_lshlrev_b32 v128, 16, v128
    v_and_b32 v148, s62, v144
    v_lshlrev_b32 v144, 16, v144
    v_and_b32 v133, s62, v129
    v_lshlrev_b32 v129, 16, v129
    v_and_b32 v149, s62, v145
    v_lshlrev_b32 v145, 16, v145
    v_and_b32 v134, s62, v130
    v_lshlrev_b32 v130, 16, v130
    v_and_b32 v150, s62, v146
    v_lshlrev_b32 v146, 16, v146
    v_and_b32 v135, s62, v131
    v_lshlrev_b32 v131, 16, v131
    v_and_b32 v151, s62, v147
    v_lshlrev_b32 v147, 16, v147
    v_mul_f32 v96, v128, v128
    v_mul_f32 v97, v129, v129
    v_mul_f32 v98, v130, v130
    v_mul_f32 v99, v131, v131
    v_mul_f32 v100, v132, v132
    v_mul_f32 v101, v133, v133
    v_mul_f32 v102, v134, v134
    v_mul_f32 v103, v135, v135
    v_fma_f32 v96, v96, s63, v112
    v_fma_f32 v97, v97, s63, v112
    v_fma_f32 v98, v98, s63, v112
    v_fma_f32 v99, v99, s63, v112
    v_fma_f32 v100, v100, s63, v112
    v_fma_f32 v101, v101, s63, v112
    v_fma_f32 v102, v102, s63, v112
    v_fma_f32 v103, v103, s63, v112
    v_mul_f32 v96, v96, v128
    v_mul_f32 v97, v97, v129
    v_mul_f32 v98, v98, v130
    v_mul_f32 v99, v99, v131
    v_mul_f32 v100, v100, v132
    v_mul_f32 v101, v101, v133
    v_mul_f32 v102, v102, v134
    v_mul_f32 v103, v103, v135
    v_exp_f32 v96, v96
    v_exp_f32 v97, v97
    v_exp_f32 v98, v98
    v_exp_f32 v99, v99
    v_exp_f32 v100, v100
    v_exp_f32 v101, v101
    v_exp_f32 v102, v102
    v_exp_f32 v103, v103
    v_add_f32 v96, 1.0, v96
    v_add_f32 v97, 1.0, v97
    v_add_f32 v98, 1.0, v98
    v_add_f32 v99, 1.0, v99
    v_add_f32 v100, 1.0, v100
    v_add_f32 v101, 1.0, v101
    v_add_f32 v102, 1.0, v102
    v_add_f32 v103, 1.0, v103
    v_rcp_f32 v96, v96
    v_rcp_f32 v97, v97
    v_rcp_f32 v98, v98
    v_rcp_f32 v99, v99
    v_rcp_f32 v100, v100
    v_rcp_f32 v101, v101
    v_rcp_f32 v102, v102
    v_rcp_f32 v103, v103
    v_mul_f32 v128, v128, v96
    v_mul_f32 v129, v129, v97
    v_mul_f32 v130, v130, v98
    v_mul_f32 v131, v131, v99
    v_mul_f32 v132, v132, v100
    v_mul_f32 v133, v133, v101
    v_mul_f32 v134, v134, v102
    v_mul_f32 v135, v135, v103
    v_cvt_pk_bf16_f32 v128, v128, v132
    v_and_b32 v132, s62, v128
    v_lshlrev_b32 v128, 16, v128
    v_cvt_pk_bf16_f32 v129, v129, v133
    v_and_b32 v133, s62, v129
    v_lshlrev_b32 v129, 16, v129
    v_cvt_pk_bf16_f32 v130, v130, v134
    v_and_b32 v134, s62, v130
    v_lshlrev_b32 v130, 16, v130
    v_cvt_pk_bf16_f32 v131, v131, v135
    v_and_b32 v135, s62, v131
    v_lshlrev_b32 v131, 16, v131
    v_mul_f32 v128, v128, v144
    v_mul_f32 v129, v129, v145
    v_mul_f32 v130, v130, v146
    v_mul_f32 v131, v131, v147
    v_mul_f32 v132, v132, v148
    v_mul_f32 v133, v133, v149
    v_mul_f32 v134, v134, v150
    v_mul_f32 v135, v135, v151
    v_cvt_pk_bf16_f32 v80, v128, v132
    v_cvt_pk_bf16_f32 v81, v129, v133
    v_cvt_pk_bf16_f32 v82, v130, v134
    v_cvt_pk_bf16_f32 v83, v131, v135
    buffer_store_dwordx4 v[80:83], v8, s[4:7], s57 offen offset:0 sc1
    v_and_b32 v140, s62, v136
    v_lshlrev_b32 v136, 16, v136
    v_and_b32 v156, s62, v152
    v_lshlrev_b32 v152, 16, v152
    v_and_b32 v141, s62, v137
    v_lshlrev_b32 v137, 16, v137
    v_and_b32 v157, s62, v153
    v_lshlrev_b32 v153, 16, v153
    v_and_b32 v142, s62, v138
    v_lshlrev_b32 v138, 16, v138
    v_and_b32 v158, s62, v154
    v_lshlrev_b32 v154, 16, v154
    v_and_b32 v143, s62, v139
    v_lshlrev_b32 v139, 16, v139
    v_and_b32 v159, s62, v155
    v_lshlrev_b32 v155, 16, v155
    v_mul_f32 v104, v136, v136
    v_mul_f32 v105, v137, v137
    v_mul_f32 v106, v138, v138
    v_mul_f32 v107, v139, v139
    v_mul_f32 v108, v140, v140
    v_mul_f32 v109, v141, v141
    v_mul_f32 v110, v142, v142
    v_mul_f32 v111, v143, v143
    v_fma_f32 v104, v104, s63, v112
    v_fma_f32 v105, v105, s63, v112
    v_fma_f32 v106, v106, s63, v112
    v_fma_f32 v107, v107, s63, v112
    v_fma_f32 v108, v108, s63, v112
    v_fma_f32 v109, v109, s63, v112
    v_fma_f32 v110, v110, s63, v112
    v_fma_f32 v111, v111, s63, v112
    v_mul_f32 v104, v104, v136
    v_mul_f32 v105, v105, v137
    v_mul_f32 v106, v106, v138
    v_mul_f32 v107, v107, v139
    v_mul_f32 v108, v108, v140
    v_mul_f32 v109, v109, v141
    v_mul_f32 v110, v110, v142
    v_mul_f32 v111, v111, v143
    v_exp_f32 v104, v104
    v_exp_f32 v105, v105
    v_exp_f32 v106, v106
    v_exp_f32 v107, v107
    v_exp_f32 v108, v108
    v_exp_f32 v109, v109
    v_exp_f32 v110, v110
    v_exp_f32 v111, v111
    v_add_f32 v104, 1.0, v104
    v_add_f32 v105, 1.0, v105
    v_add_f32 v106, 1.0, v106
    v_add_f32 v107, 1.0, v107
    v_add_f32 v108, 1.0, v108
    v_add_f32 v109, 1.0, v109
    v_add_f32 v110, 1.0, v110
    v_add_f32 v111, 1.0, v111
    v_rcp_f32 v104, v104
    v_rcp_f32 v105, v105
    v_rcp_f32 v106, v106
    v_rcp_f32 v107, v107
    v_rcp_f32 v108, v108
    v_rcp_f32 v109, v109
    v_rcp_f32 v110, v110
    v_rcp_f32 v111, v111
    v_mul_f32 v136, v136, v104
    v_mul_f32 v137, v137, v105
    v_mul_f32 v138, v138, v106
    v_mul_f32 v139, v139, v107
    v_mul_f32 v140, v140, v108
    v_mul_f32 v141, v141, v109
    v_mul_f32 v142, v142, v110
    v_mul_f32 v143, v143, v111
    v_cvt_pk_bf16_f32 v136, v136, v140
    v_and_b32 v140, s62, v136
    v_lshlrev_b32 v136, 16, v136
    v_cvt_pk_bf16_f32 v137, v137, v141
    v_and_b32 v141, s62, v137
    v_lshlrev_b32 v137, 16, v137
    v_cvt_pk_bf16_f32 v138, v138, v142
    v_and_b32 v142, s62, v138
    v_lshlrev_b32 v138, 16, v138
    v_cvt_pk_bf16_f32 v139, v139, v143
    v_and_b32 v143, s62, v139
    v_lshlrev_b32 v139, 16, v139
    v_mul_f32 v136, v136, v152
    v_mul_f32 v137, v137, v153
    v_mul_f32 v138, v138, v154
    v_mul_f32 v139, v139, v155
    v_mul_f32 v140, v140, v156
    v_mul_f32 v141, v141, v157
    v_mul_f32 v142, v142, v158
    v_mul_f32 v143, v143, v159
    v_cvt_pk_bf16_f32 v84, v136, v140
    v_cvt_pk_bf16_f32 v85, v137, v141
    v_cvt_pk_bf16_f32 v86, v138, v142
    v_cvt_pk_bf16_f32 v87, v139, v143
    buffer_store_dwordx4 v[84:87], v8, s[4:7], s57 offen offset:512 sc1
    s_waitcnt vmcnt(0)
    s_barrier
    s_cmp_lg_u32 s46, 0
    s_cbranch_scc1 L_ffn_done
    v_mov_b32 v10, 136
    v_mov_b32 v11, 1
    s_mov_b64 exec, 1
    global_atomic_add v10, v11, s[40:41]
    s_mov_b64 exec, -1
L_ffn_done:
    s_cmp_lg_u32 s44, 1
    s_cbranch_scc1 L_p3
L_leave:
    s_cmp_lg_u32 s46, 0
    s_cbranch_scc1 L_lv_init_out
    v_mov_b32 v10, 8
L_lv_init:
    global_load_dword v11, v10, s[40:41] sc1
    s_add_u32 s3, s3, 1
    s_cmp_gt_u32 s3, 262144
    s_waitcnt vmcnt(0)
    s_cbranch_scc1 L_lv_init_out
    v_cmp_gt_u32 vcc, 224, v11
    s_cbranch_vccz L_lv_init_out
    s_sleep 32
    s_branch L_lv_init
L_lv_init_out:
    s_barrier
    s_cmp_lg_u32 s46, 0
    s_cbranch_scc1 L_lv_team_out
    v_mov_b32 v10, 4
L_lv_team:
    global_load_dword v11, v10, s[40:41] sc1
    s_add_u32 s3, s3, 1
    s_cmp_gt_u32 s3, 262144
    s_waitcnt vmcnt(0)
    s_cbranch_scc1 L_lv_team_out
    v_cmp_gt_u32 vcc, 32, v11
    s_cbranch_vccz L_lv_team_out
    s_sleep 32
    s_branch L_lv_team
L_lv_team_out:
    s_barrier
    s_waitcnt vmcnt(0)
    s_endpgm
L_p3:
    s_lshr_b32 s54, s45, 4
    s_and_b32 s52, s45, 15
    s_lshl_b32 s52, s52, 6
    v_and_b32 v4, 63, v0
    v_lshrrev_b32 v5, 4, v4
    v_bfe_u32 v6, v4, 2, 2
    v_and_b32 v7, 1, v6
    v_lshlrev_b32 v1, 4, v7
    v_lshl_add_u32 v1, v5, 2, v1
    v_lshrrev_b32 v7, 1, v6
    v_add_u32 v1, v1, v7
    v_lshlrev_b32 v1, 10, v1
    v_and_b32 v7, 1, v5
    v_lshlrev_b32 v7, 1, v7
    v_and_b32 v8, 3, v4
    v_xor_b32 v8, v8, v7
    v_lshl_add_u32 v1, v8, 4, v1
    v_add_u32 v1, s52, v1
    v_lshrrev_b32 v8, 2, v4
    v_lshlrev_b32 v2, 6, v8
    v_lshl_add_u32 v2, v7, 4, v2
    v_and_b32 v8, 3, v4
    v_lshl_add_u32 v2, v8, 3, v2
    s_lshl_b32 s50, s46, 15
    v_add_u32 v2, s50, v2
    v_xor_b32 v3, 32, v2
    s_lshl_b32 s48, s46, 20
    s_mul_i32 s49, s46, 360448
    s_and_b32 s65, s45, 1
    s_lshl_b32 s65, s65, 1
    s_add_u32 s65, s65, s54
    s_mov_b32 s8, s26
    s_mov_b32 s9, s27
    s_mov_b32 s10, 4194304
    s_mov_b32 s11, 0x20000
    s_add_u32 s66, s65, 0
    s_and_b32 s66, s66, 3
    s_lshl_b32 s66, s66, 18
    s_add_u32 s66, s66, s48
    s_add_u32 m0, s50, 0
    s_add_u32 s47, s66, 0
    buffer_load_dwordx4 v1, s[8:11], s47 offen lds
    s_add_u32 m0, s50, 1024
    s_add_u32 s47, s66, 2048
    buffer_load_dwordx4 v1, s[8:11], s47 offen lds
    s_add_u32 m0, s50, 2048
    s_add_u32 s47, s66, 32768
    buffer_load_dwordx4 v1, s[8:11], s47 offen lds
    s_add_u32 m0, s50, 3072
    s_add_u32 s47, s66, 34816
    buffer_load_dwordx4 v1, s[8:11], s47 offen lds
    s_add_u32 m0, s50, 4096
    s_add_u32 s47, s66, 65536
    buffer_load_dwordx4 v1, s[8:11], s47 offen lds
    s_add_u32 m0, s50, 5120
    s_add_u32 s47, s66, 67584
    buffer_load_dwordx4 v1, s[8:11], s47 offen lds
    s_add_u32 m0, s50, 6144
    s_add_u32 s47, s66, 98304
    buffer_load_dwordx4 v1, s[8:11], s47 offen lds
    s_add_u32 m0, s50, 7168
    s_add_u32 s47, s66, 100352
    buffer_load_dwordx4 v1, s[8:11], s47 offen lds
    s_add_u32 m0, s50, 8192
    s_add_u32 s47, s66, 131072
    buffer_load_dwordx4 v1, s[8:11], s47 offen lds
    s_add_u32 m0, s50, 9216
    s_add_u32 s47, s66, 133120
    buffer_load_dwordx4 v1, s[8:11], s47 offen lds
    s_add_u32 m0, s50, 10240
    s_add_u32 s47, s66, 163840
    buffer_load_dwordx4 v1, s[8:11], s47 offen lds
    s_add_u32 m0, s50, 11264
    s_add_u32 s47, s66, 165888
    buffer_load_dwordx4 v1, s[8:11], s47 offen lds
    s_add_u32 m0, s50, 12288
    s_add_u32 s47, s66, 196608
    buffer_load_dwordx4 v1, s[8:11], s47 offen lds
    s_add_u32 m0, s50, 13312
    s_add_u32 s47, s66, 198656
    buffer_load_dwordx4 v1, s[8:11], s47 offen lds
    s_add_u32 m0, s50, 14336
    s_add_u32 s47, s66, 229376
    buffer_load_dwordx4 v1, s[8:11], s47 offen lds
    s_add_u32 m0, s50, 15360
    s_add_u32 s47, s66, 231424
    buffer_load_dwordx4 v1, s[8:11], s47 offen lds
    s_add_u32 s66, s65, 1
    s_and_b32 s66, s66, 3
    s_lshl_b32 s66, s66, 18
    s_add_u32 s66, s66, s48
    s_add_u32 m0, s50, 16384
    s_add_u32 s47, s66, 0
    buffer_load_dwordx4 v1, s[8:11], s47 offen lds
    s_add_u32 m0, s50, 17408
    s_add_u32 s47, s66, 2048
    buffer_load_dwordx4 v1, s[8:11], s47 offen lds
    s_add_u32 m0, s50, 18432
    s_add_u32 s47, s66, 32768
    buffer_load_dwordx4 v1, s[8:11], s47 offen lds
    s_add_u32 m0, s50, 19456
    s_add_u32 s47, s66, 34816
    buffer_load_dwordx4 v1, s[8:11], s47 offen lds
    s_add_u32 m0, s50, 20480
    s_add_u32 s47, s66, 65536
    buffer_load_dwordx4 v1, s[8:11], s47 offen lds
    s_add_u32 m0, s50, 21504
    s_add_u32 s47, s66, 67584
    buffer_load_dwordx4 v1, s[8:11], s47 offen lds
    s_add_u32 m0, s50, 22528
    s_add_u32 s47, s66, 98304
    buffer_load_dwordx4 v1, s[8:11], s47 offen lds
    s_add_u32 m0, s50, 23552
    s_add_u32 s47, s66, 100352
    buffer_load_dwordx4 v1, s[8:11], s47 offen lds
    s_waitcnt vmcnt(22) lgkmcnt(8)
    s_add_u32 m0, s50, 24576
    s_add_u32 s47, s66, 131072
    buffer_load_dwordx4 v1, s[8:11], s47 offen lds
    s_add_u32 m0, s50, 25600
    s_add_u32 s47, s66, 133120
    buffer_load_dwordx4 v1, s[8:11], s47 offen lds
    ds_read_b64_tr_b16 a[0:1], v2 offset:0
    ds_read_b64_tr_b16 a[2:3], v2 offset:1024
    ds_read_b64_tr_b16 a[4:5], v3 offset:0
    ds_read_b64_tr_b16 a[6:7], v3 offset:1024
    s_waitcnt vmcnt(22) lgkmcnt(8)
    s_add_u32 m0, s50, 26624
    s_add_u32 s47, s66, 163840
    buffer_load_dwordx4 v1, s[8:11], s47 offen lds
    s_add_u32 m0, s50, 27648
    s_add_u32 s47, s66, 165888
    buffer_load_dwordx4 v1, s[8:11], s47 offen lds
    ds_read_b64_tr_b16 a[8:9], v2 offset:2048
    ds_read_b64_tr_b16 a[10:11], v2 offset:3072
    ds_read_b64_tr_b16 a[12:13], v3 offset:2048
    ds_read_b64_tr_b16 a[14:15], v3 offset:3072
    s_waitcnt vmcnt(22) lgkmcnt(8)
    s_add_u32 m0, s50, 28672
    s_add_u32 s47, s66, 196608
    buffer_load_dwordx4 v1, s[8:11], s47 offen lds
    s_add_u32 m0, s50, 29696
    s_add_u32 s47, s66, 198656
    buffer_load_dwordx4 v1, s[8:11], s47 offen lds
    ds_read_b64_tr_b16 a[16:17], v2 offset:4096
    ds_read_b64_tr_b16 a[18:19], v2 offset:5120
    ds_read_b64_tr_b16 a[20:21], v3 offset:4096
    ds_read_b64_tr_b16 a[22:23], v3 offset:5120
    s_waitcnt vmcnt(22) lgkmcnt(8)
    s_add_u32 m0, s50, 30720
    s_add_u32 s47, s66, 229376
    buffer_load_dwordx4 v1, s[8:11], s47 offen lds
    s_add_u32 m0, s50, 31744
    s_add_u32 s47, s66, 231424
    buffer_load_dwordx4 v1, s[8:11], s47 offen lds
    ds_read_b64_tr_b16 a[24:25], v2 offset:6144
    ds_read_b64_tr_b16 a[26:27], v2 offset:7168
    ds_read_b64_tr_b16 a[28:29], v3 offset:6144
    ds_read_b64_tr_b16 a[30:31], v3 offset:7168
    s_waitcnt vmcnt(22) lgkmcnt(8)
    s_add_u32 s66, s65, 2
    s_and_b32 s66, s66, 3
    s_lshl_b32 s66, s66, 18
    s_add_u32 s66, s66, s48
    s_add_u32 m0, s50, 0
    s_add_u32 s47, s66, 0
    buffer_load_dwordx4 v1, s[8:11], s47 offen lds
    s_add_u32 m0, s50, 1024
    s_add_u32 s47, s66, 2048
    buffer_load_dwordx4 v1, s[8:11], s47 offen lds
    ds_read_b64_tr_b16 a[32:33], v2 offset:8192
    ds_read_b64_tr_b16 a[34:35], v2 offset:9216
    ds_read_b64_tr_b16 a[36:37], v3 offset:8192
    ds_read_b64_tr_b16 a[38:39], v3 offset:9216
    s_waitcnt vmcnt(22) lgkmcnt(8)
    s_add_u32 m0, s50, 2048
    s_add_u32 s47, s66, 32768
    buffer_load_dwordx4 v1, s[8:11], s47 offen lds
    s_add_u32 m0, s50, 3072
    s_add_u32 s47, s66, 34816
    buffer_load_dwordx4 v1, s[8:11], s47 offen lds
    ds_read_b64_tr_b16 a[40:41], v2 offset:10240
    ds_read_b64_tr_b16 a[42:43], v2 offset:11264
    ds_read_b64_tr_b16 a[44:45], v3 offset:10240
    ds_read_b64_tr_b16 a[46:47], v3 offset:11264
    s_waitcnt vmcnt(22) lgkmcnt(8)
    s_add_u32 m0, s50, 4096
    s_add_u32 s47, s66, 65536
    buffer_load_dwordx4 v1, s[8:11], s47 offen lds
    s_add_u32 m0, s50, 5120
    s_add_u32 s47, s66, 67584
    buffer_load_dwordx4 v1, s[8:11], s47 offen lds
    ds_read_b64_tr_b16 a[48:49], v2 offset:12288
    ds_read_b64_tr_b16 a[50:51], v2 offset:13312
    ds_read_b64_tr_b16 a[52:53], v3 offset:12288
    ds_read_b64_tr_b16 a[54:55], v3 offset:13312
    s_waitcnt vmcnt(22) lgkmcnt(8)
    s_add_u32 m0, s50, 6144
    s_add_u32 s47, s66, 98304
    buffer_load_dwordx4 v1, s[8:11], s47 offen lds
    s_add_u32 m0, s50, 7168
    s_add_u32 s47, s66, 100352
    buffer_load_dwordx4 v1, s[8:11], s47 offen lds
    ds_read_b64_tr_b16 a[56:57], v2 offset:14336
    ds_read_b64_tr_b16 a[58:59], v2 offset:15360
    ds_read_b64_tr_b16 a[60:61], v3 offset:14336
    ds_read_b64_tr_b16 a[62:63], v3 offset:15360
    s_waitcnt vmcnt(22) lgkmcnt(8)
    s_add_u32 m0, s50, 8192
    s_add_u32 s47, s66, 131072
    buffer_load_dwordx4 v1, s[8:11], s47 offen lds
    s_add_u32 m0, s50, 9216
    s_add_u32 s47, s66, 133120
    buffer_load_dwordx4 v1, s[8:11], s47 offen lds
    ds_read_b64_tr_b16 a[64:65], v2 offset:16384
    ds_read_b64_tr_b16 a[66:67], v2 offset:17408
    ds_read_b64_tr_b16 a[68:69], v3 offset:16384
    ds_read_b64_tr_b16 a[70:71], v3 offset:17408
    s_waitcnt vmcnt(22) lgkmcnt(8)
    s_add_u32 m0, s50, 10240
    s_add_u32 s47, s66, 163840
    buffer_load_dwordx4 v1, s[8:11], s47 offen lds
    s_add_u32 m0, s50, 11264
    s_add_u32 s47, s66, 165888
    buffer_load_dwordx4 v1, s[8:11], s47 offen lds
    ds_read_b64_tr_b16 a[72:73], v2 offset:18432
    ds_read_b64_tr_b16 a[74:75], v2 offset:19456
    ds_read_b64_tr_b16 a[76:77], v3 offset:18432
    ds_read_b64_tr_b16 a[78:79], v3 offset:19456
    s_waitcnt vmcnt(22) lgkmcnt(8)
    s_add_u32 m0, s50, 12288
    s_add_u32 s47, s66, 196608
    buffer_load_dwordx4 v1, s[8:11], s47 offen lds
    s_add_u32 m0, s50, 13312
    s_add_u32 s47, s66, 198656
    buffer_load_dwordx4 v1, s[8:11], s47 offen lds
    ds_read_b64_tr_b16 a[80:81], v2 offset:20480
    ds_read_b64_tr_b16 a[82:83], v2 offset:21504
    ds_read_b64_tr_b16 a[84:85], v3 offset:20480
    ds_read_b64_tr_b16 a[86:87], v3 offset:21504
    s_waitcnt vmcnt(22) lgkmcnt(8)
    s_add_u32 m0, s50, 14336
    s_add_u32 s47, s66, 229376
    buffer_load_dwordx4 v1, s[8:11], s47 offen lds
    s_add_u32 m0, s50, 15360
    s_add_u32 s47, s66, 231424
    buffer_load_dwordx4 v1, s[8:11], s47 offen lds
    ds_read_b64_tr_b16 a[88:89], v2 offset:22528
    ds_read_b64_tr_b16 a[90:91], v2 offset:23552
    ds_read_b64_tr_b16 a[92:93], v3 offset:22528
    ds_read_b64_tr_b16 a[94:95], v3 offset:23552
    s_waitcnt vmcnt(22) lgkmcnt(8)
    s_add_u32 s66, s65, 3
    s_and_b32 s66, s66, 3
    s_lshl_b32 s66, s66, 18
    s_add_u32 s66, s66, s48
    s_add_u32 m0, s50, 16384
    s_add_u32 s47, s66, 0
    buffer_load_dwordx4 v1, s[8:11], s47 offen lds
    s_add_u32 m0, s50, 17408
    s_add_u32 s47, s66, 2048
    buffer_load_dwordx4 v1, s[8:11], s47 offen lds
    ds_read_b64_tr_b16 a[96:97], v2 offset:24576
    ds_read_b64_tr_b16 a[98:99], v2 offset:25600
    ds_read_b64_tr_b16 a[100:101], v3 offset:24576
    ds_read_b64_tr_b16 a[102:103], v3 offset:25600
    s_waitcnt vmcnt(22) lgkmcnt(8)
    s_add_u32 m0, s50, 18432
    s_add_u32 s47, s66, 32768
    buffer_load_dwordx4 v1, s[8:11], s47 offen lds
    s_add_u32 m0, s50, 19456
    s_add_u32 s47, s66, 34816
    buffer_load_dwordx4 v1, s[8:11], s47 offen lds
    ds_read_b64_tr_b16 a[104:105], v2 offset:26624
    ds_read_b64_tr_b16 a[106:107], v2 offset:27648
    ds_read_b64_tr_b16 a[108:109], v3 offset:26624
    ds_read_b64_tr_b16 a[110:111], v3 offset:27648
    s_waitcnt vmcnt(22) lgkmcnt(8)
    s_add_u32 m0, s50, 20480
    s_add_u32 s47, s66, 65536
    buffer_load_dwordx4 v1, s[8:11], s47 offen lds
    s_add_u32 m0, s50, 21504
    s_add_u32 s47, s66, 67584
    buffer_load_dwordx4 v1, s[8:11], s47 offen lds
    ds_read_b64_tr_b16 a[112:113], v2 offset:28672
    ds_read_b64_tr_b16 a[114:115], v2 offset:29696
    ds_read_b64_tr_b16 a[116:117], v3 offset:28672
    ds_read_b64_tr_b16 a[118:119], v3 offset:29696
    s_waitcnt vmcnt(22) lgkmcnt(8)
    s_add_u32 m0, s50, 22528
    s_add_u32 s47, s66, 98304
    buffer_load_dwordx4 v1, s[8:11], s47 offen lds
    s_add_u32 m0, s50, 23552
    s_add_u32 s47, s66, 100352
    buffer_load_dwordx4 v1, s[8:11], s47 offen lds
    ds_read_b64_tr_b16 a[120:121], v2 offset:30720
    ds_read_b64_tr_b16 a[122:123], v2 offset:31744
    ds_read_b64_tr_b16 a[124:125], v3 offset:30720
    ds_read_b64_tr_b16 a[126:127], v3 offset:31744
    s_waitcnt vmcnt(22) lgkmcnt(8)
    s_add_u32 m0, s50, 24576
    s_add_u32 s47, s66, 131072
    buffer_load_dwordx4 v1, s[8:11], s47 offen lds
    s_add_u32 m0, s50, 25600
    s_add_u32 s47, s66, 133120
    buffer_load_dwordx4 v1, s[8:11], s47 offen lds
    ds_read_b64_tr_b16 a[128:129], v2 offset:0
    ds_read_b64_tr_b16 a[130:131], v2 offset:1024
    ds_read_b64_tr_b16 a[132:133], v3 offset:0
    ds_read_b64_tr_b16 a[134:135], v3 offset:1024
    s_waitcnt vmcnt(22) lgkmcnt(8)
    s_add_u32 m0, s50, 26624
    s_add_u32 s47, s66, 163840
    buffer_load_dwordx4 v1, s[8:11], s47 offen lds
    s_add_u32 m0, s50, 27648
    s_add_u32 s47, s66, 165888
    buffer_load_dwordx4 v1, s[8:11], s47 offen lds
    ds_read_b64_tr_b16 a[136:137], v2 offset:2048
    ds_read_b64_tr_b16 a[138:139], v2 offset:3072
    ds_read_b64_tr_b16 a[140:141], v3 offset:2048
    ds_read_b64_tr_b16 a[142:143], v3 offset:3072
    s_waitcnt vmcnt(22) lgkmcnt(8)
    s_add_u32 m0, s50, 28672
    s_add_u32 s47, s66, 196608
    buffer_load_dwordx4 v1, s[8:11], s47 offen lds
    s_add_u32 m0, s50, 29696
    s_add_u32 s47, s66, 198656
    buffer_load_dwordx4 v1, s[8:11], s47 offen lds
    ds_read_b64_tr_b16 a[144:145], v2 offset:4096
    ds_read_b64_tr_b16 a[146:147], v2 offset:5120
    ds_read_b64_tr_b16 a[148:149], v3 offset:4096
    ds_read_b64_tr_b16 a[150:151], v3 offset:5120
    s_waitcnt vmcnt(22) lgkmcnt(8)
    s_add_u32 m0, s50, 30720
    s_add_u32 s47, s66, 229376
    buffer_load_dwordx4 v1, s[8:11], s47 offen lds
    s_add_u32 m0, s50, 31744
    s_add_u32 s47, s66, 231424
    buffer_load_dwordx4 v1, s[8:11], s47 offen lds
    ds_read_b64_tr_b16 a[152:153], v2 offset:6144
    ds_read_b64_tr_b16 a[154:155], v2 offset:7168
    ds_read_b64_tr_b16 a[156:157], v3 offset:6144
    ds_read_b64_tr_b16 a[158:159], v3 offset:7168
    s_waitcnt vmcnt(22) lgkmcnt(8)
    s_mov_b32 s8, s36
    s_mov_b32 s9, s37
    s_mov_b32 s10, 1409024
    s_mov_b32 s11, 0x20000
    s_add_u32 m0, s50, 0
    s_add_u32 s47, s49, 0
    buffer_load_dwordx4 v1, s[8:11], s47 offen lds
    s_add_u32 m0, s50, 1024
    s_add_u32 s47, s49, 2048
    buffer_load_dwordx4 v1, s[8:11], s47 offen lds
    ds_read_b64_tr_b16 a[160:161], v2 offset:8192
    ds_read_b64_tr_b16 a[162:163], v2 offset:9216
    ds_read_b64_tr_b16 a[164:165], v3 offset:8192
    ds_read_b64_tr_b16 a[166:167], v3 offset:9216
    s_waitcnt vmcnt(22) lgkmcnt(8)
    s_add_u32 m0, s50, 2048
    s_add_u32 s47, s49, 32768
    buffer_load_dwordx4 v1, s[8:11], s47 offen lds
    s_add_u32 m0, s50, 3072
    s_add_u32 s47, s49, 34816
    buffer_load_dwordx4 v1, s[8:11], s47 offen lds
    ds_read_b64_tr_b16 a[168:169], v2 offset:10240
    ds_read_b64_tr_b16 a[170:171], v2 offset:11264
    ds_read_b64_tr_b16 a[172:173], v3 offset:10240
    ds_read_b64_tr_b16 a[174:175], v3 offset:11264
    s_waitcnt vmcnt(22) lgkmcnt(8)
    s_add_u32 m0, s50, 4096
    s_add_u32 s47, s49, 65536
    buffer_load_dwordx4 v1, s[8:11], s47 offen lds
    s_add_u32 m0, s50, 5120
    s_add_u32 s47, s49, 67584
    buffer_load_dwordx4 v1, s[8:11], s47 offen lds
    ds_read_b64_tr_b16 a[176:177], v2 offset:12288
    ds_read_b64_tr_b16 a[178:179], v2 offset:13312
    ds_read_b64_tr_b16 a[180:181], v3 offset:12288
    ds_read_b64_tr_b16 a[182:183], v3 offset:13312
    s_waitcnt vmcnt(22) lgkmcnt(8)
    s_add_u32 m0, s50, 6144
    s_add_u32 s47, s49, 98304
    buffer_load_dwordx4 v1, s[8:11], s47 offen lds
    s_add_u32 m0, s50, 7168
    s_add_u32 s47, s49, 100352
    buffer_load_dwordx4 v1, s[8:11], s47 offen lds
    ds_read_b64_tr_b16 a[184:185], v2 offset:14336
    ds_read_b64_tr_b16 a[186:187], v2 offset:15360
    ds_read_b64_tr_b16 a[188:189], v3 offset:14336
    ds_read_b64_tr_b16 a[190:191], v3 offset:15360
    s_waitcnt vmcnt(22) lgkmcnt(8)
    s_add_u32 m0, s50, 8192
    s_add_u32 s47, s49, 131072
    buffer_load_dwordx4 v1, s[8:11], s47 offen lds
    s_add_u32 m0, s50, 9216
    s_add_u32 s47, s49, 133120
    buffer_load_dwordx4 v1, s[8:11], s47 offen lds
    ds_read_b64_tr_b16 a[192:193], v2 offset:16384
    ds_read_b64_tr_b16 a[194:195], v2 offset:17408
    ds_read_b64_tr_b16 a[196:197], v3 offset:16384
    ds_read_b64_tr_b16 a[198:199], v3 offset:17408
    s_waitcnt vmcnt(22) lgkmcnt(8)
    s_add_u32 m0, s50, 10240
    s_add_u32 s47, s49, 163840
    buffer_load_dwordx4 v1, s[8:11], s47 offen lds
    s_add_u32 m0, s50, 11264
    s_add_u32 s47, s49, 165888
    buffer_load_dwordx4 v1, s[8:11], s47 offen lds
    ds_read_b64_tr_b16 a[200:201], v2 offset:18432
    ds_read_b64_tr_b16 a[202:203], v2 offset:19456
    ds_read_b64_tr_b16 a[204:205], v3 offset:18432
    ds_read_b64_tr_b16 a[206:207], v3 offset:19456
    s_waitcnt vmcnt(22) lgkmcnt(8)
    s_add_u32 m0, s50, 12288
    s_add_u32 s47, s49, 196608
    buffer_load_dwordx4 v1, s[8:11], s47 offen lds
    s_add_u32 m0, s50, 13312
    s_add_u32 s47, s49, 198656
    buffer_load_dwordx4 v1, s[8:11], s47 offen lds
    ds_read_b64_tr_b16 a[208:209], v2 offset:20480
    ds_read_b64_tr_b16 a[210:211], v2 offset:21504
    ds_read_b64_tr_b16 a[212:213], v3 offset:20480
    ds_read_b64_tr_b16 a[214:215], v3 offset:21504
    s_waitcnt vmcnt(22) lgkmcnt(8)
    s_add_u32 m0, s50, 14336
    s_add_u32 s47, s49, 229376
    buffer_load_dwordx4 v1, s[8:11], s47 offen lds
    s_add_u32 m0, s50, 15360
    s_add_u32 s47, s49, 231424
    buffer_load_dwordx4 v1, s[8:11], s47 offen lds
    ds_read_b64_tr_b16 a[216:217], v2 offset:22528
    ds_read_b64_tr_b16 a[218:219], v2 offset:23552
    ds_read_b64_tr_b16 a[220:221], v3 offset:22528
    ds_read_b64_tr_b16 a[222:223], v3 offset:23552
    s_waitcnt vmcnt(22) lgkmcnt(8)
    s_add_u32 m0, s50, 16384
    s_add_u32 s47, s49, 262144
    buffer_load_dwordx4 v1, s[8:11], s47 offen lds
    s_add_u32 m0, s50, 17408
    s_add_u32 s47, s49, 264192
    buffer_load_dwordx4 v1, s[8:11], s47 offen lds
    ds_read_b64_tr_b16 a[224:225], v2 offset:24576
    ds_read_b64_tr_b16 a[226:227], v2 offset:25600
    ds_read_b64_tr_b16 a[228:229], v3 offset:24576
    ds_read_b64_tr_b16 a[230:231], v3 offset:25600
    s_waitcnt vmcnt(22) lgkmcnt(8)
    s_add_u32 m0, s50, 18432
    s_add_u32 s47, s49, 294912
    buffer_load_dwordx4 v1, s[8:11], s47 offen lds
    s_add_u32 m0, s50, 19456
    s_add_u32 s47, s49, 296960
    buffer_load_dwordx4 v1, s[8:11], s47 offen lds
    ds_read_b64_tr_b16 a[232:233], v2 offset:26624
    ds_read_b64_tr_b16 a[234:235], v2 offset:27648
    ds_read_b64_tr_b16 a[236:237], v3 offset:26624
    ds_read_b64_tr_b16 a[238:239], v3 offset:27648
    s_waitcnt vmcnt(22) lgkmcnt(8)
    s_add_u32 m0, s50, 20480
    s_add_u32 s47, s49, 327680
    buffer_load_dwordx4 v1, s[8:11], s47 offen lds
    s_add_u32 m0, s50, 21504
    s_add_u32 s47, s49, 329728
    buffer_load_dwordx4 v1, s[8:11], s47 offen lds
    ds_read_b64_tr_b16 a[240:241], v2 offset:28672
    ds_read_b64_tr_b16 a[242:243], v2 offset:29696
    ds_read_b64_tr_b16 a[244:245], v3 offset:28672
    ds_read_b64_tr_b16 a[246:247], v3 offset:29696
    s_waitcnt vmcnt(22) lgkmcnt(8)
    ds_read_b64_tr_b16 a[248:249], v2 offset:30720
    ds_read_b64_tr_b16 a[250:251], v2 offset:31744
    ds_read_b64_tr_b16 a[252:253], v3 offset:30720
    ds_read_b64_tr_b16 a[254:255], v3 offset:31744
    s_waitcnt vmcnt(20) lgkmcnt(8)
    ds_read_b64_tr_b16 v[168:169], v2 offset:0
    ds_read_b64_tr_b16 v[170:171], v2 offset:1024
    ds_read_b64_tr_b16 v[172:173], v3 offset:0
    ds_read_b64_tr_b16 v[174:175], v3 offset:1024
    s_waitcnt vmcnt(18) lgkmcnt(8)
    ds_read_b64_tr_b16 v[176:177], v2 offset:2048
    ds_read_b64_tr_b16 v[178:179], v2 offset:3072
    ds_read_b64_tr_b16 v[180:181], v3 offset:2048
    ds_read_b64_tr_b16 v[182:183], v3 offset:3072
    s_waitcnt vmcnt(16) lgkmcnt(8)
    ds_read_b64_tr_b16 v[184:185], v2 offset:4096
    ds_read_b64_tr_b16 v[186:187], v2 offset:5120
    ds_read_b64_tr_b16 v[188:189], v3 offset:4096
    ds_read_b64_tr_b16 v[190:191], v3 offset:5120
    s_waitcnt vmcnt(14) lgkmcnt(8)
    ds_read_b64_tr_b16 v[192:193], v2 offset:6144
    ds_read_b64_tr_b16 v[194:195], v2 offset:7168
    ds_read_b64_tr_b16 v[196:197], v3 offset:6144
    ds_read_b64_tr_b16 v[198:199], v3 offset:7168
    s_waitcnt vmcnt(12) lgkmcnt(8)
    ds_read_b64_tr_b16 v[200:201], v2 offset:8192
    ds_read_b64_tr_b16 v[202:203], v2 offset:9216
    ds_read_b64_tr_b16 v[204:205], v3 offset:8192
    ds_read_b64_tr_b16 v[206:207], v3 offset:9216
    s_waitcnt vmcnt(10) lgkmcnt(8)
    ds_read_b64_tr_b16 v[208:209], v2 offset:10240
    ds_read_b64_tr_b16 v[210:211], v2 offset:11264
    ds_read_b64_tr_b16 v[212:213], v3 offset:10240
    ds_read_b64_tr_b16 v[214:215], v3 offset:11264
    s_waitcnt vmcnt(8) lgkmcnt(8)
    ds_read_b64_tr_b16 v[216:217], v2 offset:12288
    ds_read_b64_tr_b16 v[218:219], v2 offset:13312
    ds_read_b64_tr_b16 v[220:221], v3 offset:12288
    ds_read_b64_tr_b16 v[222:223], v3 offset:13312
    s_waitcnt vmcnt(6) lgkmcnt(8)
    ds_read_b64_tr_b16 v[224:225], v2 offset:14336
    ds_read_b64_tr_b16 v[226:227], v2 offset:15360
    ds_read_b64_tr_b16 v[228:229], v3 offset:14336
    ds_read_b64_tr_b16 v[230:231], v3 offset:15360
    s_waitcnt vmcnt(4) lgkmcnt(8)
    ds_read_b64_tr_b16 v[232:233], v2 offset:16384
    ds_read_b64_tr_b16 v[234:235], v2 offset:17408
    ds_read_b64_tr_b16 v[236:237], v3 offset:16384
    ds_read_b64_tr_b16 v[238:239], v3 offset:17408
    s_waitcnt vmcnt(2) lgkmcnt(8)
    ds_read_b64_tr_b16 v[240:241], v2 offset:18432
    ds_read_b64_tr_b16 v[242:243], v2 offset:19456
    ds_read_b64_tr_b16 v[244:245], v3 offset:18432
    ds_read_b64_tr_b16 v[246:247], v3 offset:19456
    s_waitcnt vmcnt(0) lgkmcnt(8)
    ds_read_b64_tr_b16 v[248:249], v2 offset:20480
    ds_read_b64_tr_b16 v[250:251], v2 offset:21504
    ds_read_b64_tr_b16 v[252:253], v3 offset:20480
    ds_read_b64_tr_b16 v[254:255], v3 offset:21504
    s_waitcnt lgkmcnt(0)
    s_barrier
    v_and_b32 v20, 63, v0
    v_lshrrev_b32 v21, 4, v20
    v_and_b32 v22, 15, v20
    v_lshlrev_b32 v1, 4, v20
    v_bfe_u32 v23, v22, 1, 1
    v_lshlrev_b32 v2, 3, v23
    v_lshrrev_b32 v23, 2, v22
    v_lshl_add_u32 v2, v23, 1, v2
    v_and_b32 v24, 1, v22
    v_add_u32 v2, v2, v24
    v_lshl_add_u32 v2, v21, 4, v2
    v_lshlrev_b32 v2, 4, v2
    v_lshl_add_u32 v7, v23, 1, v24
    v_lshlrev_b32 v7, 4, v7
    v_mul_u32_u24 v24, 144, v21
    v_add_u32 v7, v7, v24
    v_add_u32 v7, 8192, v7
    v_mul_u32_u24 v6, 144, v23
    v_lshl_add_u32 v6, v21, 5, v6
    v_and_b32 v24, 3, v22
    v_lshl_add_u32 v6, v24, 2, v6
    s_mul_i32 s47, s46, 576
    s_add_u32 s47, s47, 8192
    v_add_u32 v6, s47, v6
    v_lshlrev_b32 v8, 3, v0
    v_add_u32 v8, 12288, v8
    s_lshr_b32 s47, s46, 1
    s_lshl_b32 s47, s47, 10
    s_add_u32 s47, s47, 12288
    v_lshlrev_b32 v9, 3, v20
    v_add_u32 v9, s47, v9
    s_lshl_b32 s47, s46, 11
    v_and_b32 v24, 7, v22
    v_xor_b32 v24, v24, v21
    v_lshlrev_b32 v3, 7, v22
    v_lshl_add_u32 v3, v24, 4, v3
    v_add_u32 v3, s47, v3
    v_xor_b32 v12, 64, v3
    v_lshlrev_b32 v4, 3, v0
    v_lshrrev_b32 v24, 4, v0
    v_and_b32 v25, 7, v24
    v_lshlrev_b32 v25, 4, v25
    v_xor_b32 v4, v4, v25
    v_lshlrev_b32 v5, 10, v24
    v_lshl_add_u32 v5, v22, 2, v5
    s_lshl_b32 s47, s54, 14
    s_add_u32 s47, s47, s52
    v_add_u32 v5, s47, v5
    v_and_b32 v13, 7, v20
    s_lshl_b32 s47, s46, 3
    v_add_u32 v13, s47, v13
    v_lshlrev_b32 v13, 2, v13
    s_and_b32 s47, s46, 1
    s_lshl_b32 s47, s47, 4
    v_add_u32 v22, s47, v22
    v_lshlrev_b32 v21, 1, v21
    v_sub_u32 v22, v22, v21
    v_cmp_le_i32 s[72:73], 0, v22
    v_cmp_le_i32 s[74:75], 1, v22
    v_cmp_le_i32 s[76:77], 8, v22
    v_cmp_le_i32 s[78:79], 9, v22
    v_cmp_le_i32 s[80:81], 16, v22
    v_cmp_le_i32 s[82:83], 17, v22
    v_cmp_le_i32 s[84:85], 24, v22
    v_cmp_le_i32 s[86:87], 25, v22
    s_mov_b32 s68, s38
    s_mov_b32 s69, s39
    s_mov_b32 s70, 2097152
    s_mov_b32 s71, 0x20000
    s_mov_b32 s63, 0x3db504f3
    s_mov_b32 s62, 0xffff0000
    s_mov_b32 s64, 0xbfb8aa3b
    s_sub_u32 s53, s44, 2
    s_lshl_b32 s61, s53, 1
    v_mov_b32 v49, 0
    v_mov_b32 v50, 0
    s_mov_b32 s8, s16
    s_mov_b32 s9, s17
    s_mov_b32 s10, 2097152
    s_mov_b32 s11, 0x20000
    s_cmp_lg_u32 s46, 0
    s_cbranch_scc1 L_p3_init_out
    v_mov_b32 v10, 8
L_p3_init:
    global_load_dword v11, v10, s[40:41] sc1
    s_add_u32 s3, s3, 1
    s_cmp_gt_u32 s3, 262144
    s_waitcnt vmcnt(0)
    s_cbranch_scc1 L_p3_init_out
    v_cmp_gt_u32 vcc, 224, v11
    s_cbranch_vccz L_p3_init_out
    s_sleep 8
    s_branch L_p3_init
L_p3_init_out:
    s_barrier
    s_cmp_lg_u32 s46, 0
    s_cbranch_scc1 L_p3_adone_out
    v_mov_b32 v10, 136
L_p3_adone:
    global_load_dword v11, v10, s[40:41] sc1
    s_add_u32 s3, s3, 1
    s_cmp_gt_u32 s3, 262144
    s_waitcnt vmcnt(0)
    s_cbranch_scc1 L_p3_adone_out
    v_cmp_gt_u32 vcc, 193, v11
    s_cbranch_vccz L_p3_adone_out
    s_sleep 32
    s_branch L_p3_adone
L_p3_adone_out:
    s_barrier
    s_lshl_b32 s47, s53, 5
    s_add_u32 s47, s47, s45
    s_lshl_b32 s47, s47, 2
    s_add_u32 s47, s47, s46
    s_lshl_b32 s48, s46, 12
    s_add_u32 m0, s48, 16384
    s_lshl_b32 s58, s47, 12
    s_add_u32 s58, s58, 8388608
    buffer_load_dwordx4 v1, s[4:7], s58 offen offset:0 sc1 lds
    buffer_load_dwordx4 v1, s[4:7], s58 offen offset:1024 sc1 lds
    buffer_load_dwordx4 v1, s[4:7], s58 offen offset:2048 sc1 lds
    buffer_load_dwordx4 v1, s[4:7], s58 offen offset:3072 sc1 lds
    s_lshl_b32 s48, s46, 11
    s_add_u32 m0, s48, 32768
    s_lshl_b32 s57, s47, 11
    s_add_u32 s57, s57, 41943040
    buffer_load_dwordx4 v1, s[4:7], s57 offen offset:0 sc1 lds
    buffer_load_dwordx4 v1, s[4:7], s57 offen offset:1024 sc1 lds
    s_lshl_b32 s47, s53, 1
    s_add_u32 s47, s47, s54
    s_mul_i32 s57, s47, 45056
    s_mul_i32 s48, s46, 11264
    s_add_u32 s57, s57, s48
    s_add_u32 s57, s57, 92270592
    s_cmp_eq_u32 s46, 3
    s_cselect_b32 s49, 0x40000000, 0
    s_add_u32 m0, s48, 40960
    s_add_u32 s57, s57, 4096
    buffer_load_dwordx4 v1, s[4:7], s57 offen offset:0 sc1 lds
    buffer_load_dwordx4 v1, s[4:7], s57 offen offset:1024 sc1 lds
    buffer_load_dwordx4 v1, s[4:7], s57 offen offset:2048 sc1 lds
    buffer_load_dwordx4 v1, s[4:7], s57 offen offset:3072 sc1 lds
    s_add_u32 m0, s48, 45056
    s_add_u32 s57, s57, 4096
    buffer_load_dwordx4 v1, s[4:7], s57 offen offset:0 sc1 lds
    buffer_load_dwordx4 v1, s[4:7], s57 offen offset:1024 sc1 lds
    buffer_load_dwordx4 v1, s[4:7], s57 offen offset:2048 sc1 lds
    buffer_load_dwordx4 v1, s[4:7], s57 offen offset:3072 sc1 lds
    s_add_u32 m0, s48, 49152
    s_add_u32 s57, s57, 4096
    buffer_load_dwordx4 v1, s[4:7], s57 offen offset:0 sc1 lds
    buffer_load_dwordx4 v1, s[4:7], s57 offen offset:1024 sc1 lds
    s_add_u32 s57, s57, s49
    buffer_load_dwordx4 v1, s[4:7], s57 offen offset:2048 sc1 lds
    s_and_b32 s47, s46, 1
    s_lshl_b32 s47, s47, 12
    s_add_u32 s47, s47, 32768
    v_add_u32 v88, s47, v1
    s_lshr_b32 s47, s46, 1
    s_lshl_b32 s47, s47, 12
    s_add_u32 s47, s47, 24576
    v_add_u32 v89, s47, v1
    s_add_u32 s47, s48, 40960
    v_add_u32 v90, s47, v1
    s_waitcnt vmcnt(0)
    s_barrier
L_p3_seg:
    s_lshl_b32 s56, s53, 15
    buffer_load_dword v16, v5, s[8:11], s56 offen
    s_lshl_b32 s47, s53, 5
    s_add_u32 s47, s47, s45
    s_lshl_b32 s59, s47, 2
    s_add_u32 s59, s59, s46
    s_lshl_b32 s59, s59, 10
    s_add_u32 s59, s59, 59768832
    buffer_load_dwordx4 v[156:159], v1, s[4:7], s59 offen sc1
    ds_read_b128 v[28:31], v90 offset:0
    ds_read_b128 v[32:35], v90 offset:1024
    ds_read_b128 v[36:39], v90 offset:2048
    ds_read_b128 v[40:43], v90 offset:3072
    ds_read_b128 v[44:47], v90 offset:4096
    ds_read_b128 v[48:51], v90 offset:5120
    ds_read_b128 v[52:55], v90 offset:6144
    ds_read_b128 v[56:59], v90 offset:7168
    ds_read_b128 v[60:63], v90 offset:8192
    ds_read_b128 v[64:67], v90 offset:9216
    ds_read_b128 v[68:71], v90 offset:10240
    s_waitcnt lgkmcnt(10)
    v_mfma_f32_16x16x32_bf16 v[20:23], v[168:171], v[28:31], 0
    v_mfma_f32_16x16x32_bf16 v[24:27], v[172:175], v[28:31], 0
    s_waitcnt lgkmcnt(9)
    v_mfma_f32_16x16x32_bf16 v[20:23], v[176:179], v[32:35], v[20:23]
    v_mfma_f32_16x16x32_bf16 v[24:27], v[180:183], v[32:35], v[24:27]
    s_waitcnt lgkmcnt(8)
    v_mfma_f32_16x16x32_bf16 v[20:23], v[184:187], v[36:39], v[20:23]
    v_mfma_f32_16x16x32_bf16 v[24:27], v[188:191], v[36:39], v[24:27]
    s_waitcnt lgkmcnt(7)
    v_mfma_f32_16x16x32_bf16 v[20:23], v[192:195], v[40:43], v[20:23]
    ds_read_b128 v[92:95], v88 offset:0
    v_mfma_f32_16x16x32_bf16 v[24:27], v[196:199], v[40:43], v[24:27]
    ds_read_b128 v[96:99], v88 offset:1024
    s_waitcnt lgkmcnt(8)
    v_mfma_f32_16x16x32_bf16 v[20:23], v[200:203], v[44:47], v[20:23]
    ds_read_b128 v[100:103], v88 offset:2048
    v_mfma_f32_16x16x32_bf16 v[24:27], v[204:207], v[44:47], v[24:27]
    ds_read_b128 v[104:107], v88 offset:3072
    s_waitcnt lgkmcnt(9)
    v_mfma_f32_16x16x32_bf16 v[20:23], v[208:211], v[48:51], v[20:23]
    ds_read_b128 v[108:111], v2 offset:16384
    v_mfma_f32_16x16x32_bf16 v[24:27], v[212:215], v[48:51], v[24:27]
    ds_read_b128 v[112:115], v2 offset:17408
    s_waitcnt lgkmcnt(10)
    v_mfma_f32_16x16x32_bf16 v[20:23], v[216:219], v[52:55], v[20:23]
    ds_read_b128 v[116:119], v2 offset:18432
    v_mfma_f32_16x16x32_bf16 v[24:27], v[220:223], v[52:55], v[24:27]
    ds_read_b128 v[120:123], v2 offset:19456
    s_waitcnt lgkmcnt(11)
    v_mfma_f32_16x16x32_bf16 v[20:23], v[224:227], v[56:59], v[20:23]
    ds_read_b128 v[124:127], v2 offset:20480
    v_mfma_f32_16x16x32_bf16 v[24:27], v[228:231], v[56:59], v[24:27]
    ds_read_b128 v[128:131], v2 offset:21504
    s_waitcnt lgkmcnt(12)
    v_mfma_f32_16x16x32_bf16 v[20:23], v[232:235], v[60:63], v[20:23]
    ds_read_b128 v[132:135], v2 offset:22528
    v_mfma_f32_16x16x32_bf16 v[24:27], v[236:239], v[60:63], v[24:27]
    ds_read_b128 v[136:139], v2 offset:23552
    s_waitcnt lgkmcnt(13)
    v_mfma_f32_16x16x32_bf16 v[20:23], v[240:243], v[64:67], v[20:23]
    ds_read_b128 v[140:143], v89 offset:0
    v_mfma_f32_16x16x32_bf16 v[24:27], v[244:247], v[64:67], v[24:27]
    ds_read_b128 v[144:147], v89 offset:1024
    s_waitcnt lgkmcnt(14)
    v_mfma_f32_16x16x32_bf16 v[20:23], v[248:251], v[68:71], v[20:23]
    ds_read_b128 v[148:151], v89 offset:2048
    v_mfma_f32_16x16x32_bf16 v[24:27], v[252:255], v[68:71], v[24:27]
    ds_read_b128 v[152:155], v89 offset:3072
    s_nop 7
    ds_write_b128 v3, v[20:23] offset:0
    ds_write_b128 v12, v[24:27] offset:0
    s_waitcnt lgkmcnt(0)
    s_barrier
    ds_read_b64 v[20:21], v4 offset:0
    ds_read_b64 v[22:23], v4 offset:2048
    ds_read_b64 v[24:25], v4 offset:4096
    ds_read_b64 v[26:27], v4 offset:6144
    s_waitcnt lgkmcnt(0)
    v_pk_add_f32 v[20:21], v[20:21], v[22:23]
    v_pk_add_f32 v[24:25], v[24:25], v[26:27]
    v_pk_add_f32 v[20:21], v[20:21], v[24:25]
    v_cvt_pk_bf16_f32 v14, v20, v21
    v_and_b32 v15, s62, v14
    v_lshlrev_b32 v14, 16, v14
    s_add_u32 s55, s53, 6
    s_cmp_ge_u32 s55, 64
    s_waitcnt vmcnt(0)
    s_cbranch_scc1 L_p3_last
    s_lshl_b32 s47, s55, 5
    s_add_u32 s47, s47, s45
    s_lshl_b32 s47, s47, 2
    s_add_u32 s47, s47, s46
    s_lshl_b32 s48, s46, 12
    s_add_u32 m0, s48, 16384
    s_lshl_b32 s58, s47, 12
    s_add_u32 s58, s58, 8388608
    buffer_load_dwordx4 v1, s[4:7], s58 offen offset:0 sc1 lds
    buffer_load_dwordx4 v1, s[4:7], s58 offen offset:1024 sc1 lds
    buffer_load_dwordx4 v1, s[4:7], s58 offen offset:2048 sc1 lds
    buffer_load_dwordx4 v1, s[4:7], s58 offen offset:3072 sc1 lds
    s_lshl_b32 s48, s46, 11
    s_add_u32 m0, s48, 32768
    s_lshl_b32 s57, s47, 11
    s_add_u32 s57, s57, 41943040
    buffer_load_dwordx4 v1, s[4:7], s57 offen offset:0 sc1 lds
    buffer_load_dwordx4 v1, s[4:7], s57 offen offset:1024 sc1 lds
    s_lshl_b32 s47, s55, 1
    s_add_u32 s47, s47, s54
    s_mul_i32 s57, s47, 45056
    s_mul_i32 s48, s46, 11264
    s_add_u32 s57, s57, s48
    s_add_u32 s57, s57, 92270592
    s_cmp_eq_u32 s46, 3
    s_cselect_b32 s49, 0x40000000, 0
    s_add_u32 m0, s48, 40960
    s_add_u32 s57, s57, 4096
    buffer_load_dwordx4 v1, s[4:7], s57 offen offset:0 sc1 lds
    buffer_load_dwordx4 v1, s[4:7], s57 offen offset:1024 sc1 lds
    buffer_load_dwordx4 v1, s[4:7], s57 offen offset:2048 sc1 lds
    buffer_load_dwordx4 v1, s[4:7], s57 offen offset:3072 sc1 lds
    s_add_u32 m0, s48, 45056
    s_add_u32 s57, s57, 4096
    buffer_load_dwordx4 v1, s[4:7], s57 offen offset:0 sc1 lds
    buffer_load_dwordx4 v1, s[4:7], s57 offen offset:1024 sc1 lds
    buffer_load_dwordx4 v1, s[4:7], s57 offen offset:2048 sc1 lds
    buffer_load_dwordx4 v1, s[4:7], s57 offen offset:3072 sc1 lds
    s_add_u32 m0, s48, 49152
    s_add_u32 s57, s57, 4096
    buffer_load_dwordx4 v1, s[4:7], s57 offen offset:0 sc1 lds
    buffer_load_dwordx4 v1, s[4:7], s57 offen offset:1024 sc1 lds
    s_add_u32 s57, s57, s49
    buffer_load_dwordx4 v1, s[4:7], s57 offen offset:2048 sc1 lds
L_p3_last:
    v_mul_f32 v20, s64, v14
    v_mul_f32 v21, s64, v15
    v_exp_f32 v20, v20
    v_exp_f32 v21, v21
    s_nop 0
    v_add_f32 v20, 1.0, v20
    v_add_f32 v21, 1.0, v21
    v_rcp_f32 v20, v20
    v_rcp_f32 v21, v21
    s_nop 0
    v_pk_mul_f32 v[14:15], v[14:15], v[20:21]
    v_cvt_pk_bf16_f32 v14, v14, v15
    v_and_b32 v15, s62, v14
    v_lshlrev_b32 v14, 16, v14
    v_and_b32 v17, s62, v16
    v_lshlrev_b32 v16, 16, v16
    v_mov_b32 v49, 0
    v_mov_b32 v50, 0
    v_mov_b32 v10, 0
    v_mfma_f32_16x16x32_bf16 v[28:31], v[108:111], v[92:95], 0
    v_mfma_f32_16x16x32_bf16 v[32:35], v[124:127], v[92:95], 0
    v_mfma_f32_16x16x32_bf16 v[28:31], v[112:115], v[96:99], v[28:31]
    v_mfma_f32_16x16x32_bf16 v[32:35], v[128:131], v[96:99], v[32:35]
    v_mfma_f32_16x16x32_bf16 v[28:31], v[116:119], v[100:103], v[28:31]
    v_mfma_f32_16x16x32_bf16 v[32:35], v[132:135], v[100:103], v[32:35]
    v_mfma_f32_16x16x32_bf16 v[28:31], v[120:123], v[104:107], v[28:31]
    v_mfma_f32_16x16x32_bf16 v[32:35], v[136:139], v[104:107], v[32:35]
    v_mov_b32 v41, 0xce6e0000
    s_nop 7
    v_cvt_pk_bf16_f32 v28, v28, v29
    v_and_b32 v29, s62, v28
    v_lshlrev_b32 v28, 16, v28
    v_mul_f32 v28, s63, v28
    v_mul_f32 v29, s63, v29
    v_cvt_pk_bf16_f32 v28, v28, v29
    v_and_b32 v29, s62, v28
    v_lshlrev_b32 v28, 16, v28
    v_cvt_pk_bf16_f32 v30, v30, v31
    v_and_b32 v31, s62, v30
    v_lshlrev_b32 v30, 16, v30
    v_mul_f32 v30, s63, v30
    v_mul_f32 v31, s63, v31
    v_cvt_pk_bf16_f32 v30, v30, v31
    v_and_b32 v31, s62, v30
    v_lshlrev_b32 v30, 16, v30
    v_cvt_pk_bf16_f32 v32, v32, v33
    v_and_b32 v33, s62, v32
    v_lshlrev_b32 v32, 16, v32
    v_mul_f32 v32, s63, v32
    v_mul_f32 v33, s63, v33
    v_cvt_pk_bf16_f32 v32, v32, v33
    v_and_b32 v33, s62, v32
    v_lshlrev_b32 v32, 16, v32
    v_cvt_pk_bf16_f32 v34, v34, v35
    v_and_b32 v35, s62, v34
    v_lshlrev_b32 v34, 16, v34
    v_mul_f32 v34, s63, v34
    v_mul_f32 v35, s63, v35
    v_cvt_pk_bf16_f32 v34, v34, v35
    v_and_b32 v35, s62, v34
    v_lshlrev_b32 v34, 16, v34
    v_cndmask_b32 v28, v41, v28, s[72:73]
    v_cndmask_b32 v29, v41, v29, s[74:75]
    v_cndmask_b32 v30, v41, v30, s[76:77]
    v_cndmask_b32 v31, v41, v31, s[78:79]
    v_cndmask_b32 v32, v41, v32, s[80:81]
    v_cndmask_b32 v33, v41, v33, s[82:83]
    v_cndmask_b32 v34, v41, v34, s[84:85]
    v_cndmask_b32 v35, v41, v35, s[86:87]
    v_max3_f32 v40, v28, v29, v30
    v_max3_f32 v40, v40, v31, v32
    v_max3_f32 v40, v40, v33, v34
    v_max_f32 v40, v40, v35
L_p3_pub:
    s_add_u32 s3, s3, 1
    s_cmp_gt_u32 s3, 262144
    s_cbranch_scc1 L_p3_pub_out
    v_max3_u32 v11, v156, v157, v158
    v_max_u32 v11, v11, v159
    v_cmp_eq_u32 vcc, s12, v11
    s_cbranch_vccz L_p3_pub_out
    s_cmp_ge_u32 s53, 62
    s_cbranch_scc1 L_p3_again
    s_sleep 12
L_p3_again:
    buffer_load_dwordx4 v[156:159], v1, s[4:7], s59 offen sc1
    s_waitcnt vmcnt(0)
    s_branch L_p3_pub
L_p3_pub_out:
    ds_write2_b32 v6, v156, v157 offset0:0 offset1:4
    ds_write_b64 v8, v[158:159]
    s_waitcnt lgkmcnt(0)
    s_barrier
    ds_read_b128 v[68:71], v7 offset:0
    ds_read_b128 v[72:75], v7 offset:576
    ds_read_b128 v[76:79], v7 offset:1152
    ds_read_b128 v[80:83], v7 offset:1728
    ds_read_b64 v[84:85], v9 offset:0
    ds_read_b64 v[86:87], v9 offset:512
    s_waitcnt lgkmcnt(5)
    v_mfma_f32_16x16x32_bf16 v[36:39], v[68:71], v[92:95], 0
    s_waitcnt lgkmcnt(4)
    v_mfma_f32_16x16x32_bf16 v[36:39], v[72:75], v[96:99], v[36:39]
    s_waitcnt lgkmcnt(3)
    v_mfma_f32_16x16x32_bf16 v[36:39], v[76:79], v[100:103], v[36:39]
    s_waitcnt lgkmcnt(2)
    v_mfma_f32_16x16x32_bf16 v[36:39], v[80:83], v[104:107], v[36:39]
    s_lshl_b32 s47, s61, 1
    s_and_b32 s48, s46, 1
    s_add_u32 s47, s47, s48
    s_lshl_b32 s47, s47, 5
    s_add_u32 s47, s47, s45
    s_lshl_b32 s47, s47, 2
    s_and_b32 s48, s46, 2
    s_add_u32 s47, s47, s48
    s_lshl_b32 s47, s47, 10
    s_add_u32 s47, s47, 75497472
    v_cvt_pk_bf16_f32 v36, v36, v37
    v_and_b32 v37, s62, v36
    v_lshlrev_b32 v36, 16, v36
    v_mul_f32 v36, s63, v36
    v_mul_f32 v37, s63, v37
    v_cvt_pk_bf16_f32 v36, v36, v37
    v_and_b32 v37, s62, v36
    v_lshlrev_b32 v36, 16, v36
    v_max3_f32 v40, v40, v36, v37
    v_mov_b32 v41, v40
    s_nop 1
    v_permlane16_swap_b32 v40, v41
    v_max_f32 v40, v40, v41
    v_mov_b32 v41, v40
    s_nop 1
    v_permlane32_swap_b32 v40, v41
    v_max_f32 v40, v40, v41
    v_mul_f32 v40, s64, v40
    v_fma_f32 v28, -v28, s64, v40
    v_fma_f32 v29, -v29, s64, v40
    v_fma_f32 v30, -v30, s64, v40
    v_fma_f32 v31, -v31, s64, v40
    v_fma_f32 v32, -v32, s64, v40
    v_fma_f32 v33, -v33, s64, v40
    v_fma_f32 v34, -v34, s64, v40
    v_fma_f32 v35, -v35, s64, v40
    v_fma_f32 v36, -v36, s64, v40
    v_fma_f32 v37, -v37, s64, v40
    v_exp_f32 v28, v28
    v_exp_f32 v29, v29
    v_exp_f32 v30, v30
    v_exp_f32 v31, v31
    v_exp_f32 v32, v32
    v_exp_f32 v33, v33
    v_exp_f32 v34, v34
    v_exp_f32 v35, v35
    v_exp_f32 v36, v36
    v_exp_f32 v37, v37
    v_pk_add_f32 v[40:41], v[28:29], v[30:31]
    v_pk_add_f32 v[42:43], v[32:33], v[34:35]
    v_pk_add_f32 v[40:41], v[40:41], v[36:37]
    v_pk_add_f32 v[40:41], v[40:41], v[42:43]
    v_add_f32 v40, v40, v41
    v_mov_b32 v41, v40
    s_nop 1
    v_permlane16_swap_b32 v40, v41
    v_add_f32 v40, v40, v41
    v_mov_b32 v41, v40
    s_nop 1
    v_permlane32_swap_b32 v40, v41
    v_add_f32 v40, v40, v41
    v_rcp_f32 v40, v40
    s_waitcnt lgkmcnt(0)
    v_pk_mul_f32 v[28:29], v[28:29], v[40:41] op_sel_hi:[1,0]
    v_pk_mul_f32 v[30:31], v[30:31], v[40:41] op_sel_hi:[1,0]
    v_pk_mul_f32 v[32:33], v[32:33], v[40:41] op_sel_hi:[1,0]
    v_pk_mul_f32 v[34:35], v[34:35], v[40:41] op_sel_hi:[1,0]
    v_pk_mul_f32 v[36:37], v[36:37], v[40:41] op_sel_hi:[1,0]
    v_cvt_pk_bf16_f32 v44, v28, v29
    v_cvt_pk_bf16_f32 v45, v32, v33
    v_cvt_pk_bf16_f32 v46, v30, v31
    v_cvt_pk_bf16_f32 v47, v34, v35
    v_cvt_pk_bf16_f32 v48, v36, v37
    v_cvt_pk_bf16_f32 v51, v36, v37
    v_mfma_f32_16x16x32_bf16 v[52:55], v[140:143], v[44:47], 0
    v_mfma_f32_16x16x32_bf16 v[56:59], v[144:147], v[44:47], 0
    v_mfma_f32_16x16x16_bf16 v[52:55], v[84:85], v[48:49], v[52:55]
    v_mfma_f32_16x16x16_bf16 v[56:59], v[84:85], v[50:51], v[56:59]
    v_mfma_f32_16x16x32_bf16 v[60:63], v[148:151], v[44:47], 0
    v_mfma_f32_16x16x32_bf16 v[64:67], v[152:155], v[44:47], 0
    v_mfma_f32_16x16x16_bf16 v[60:63], v[86:87], v[48:49], v[60:63]
    v_mfma_f32_16x16x16_bf16 v[64:67], v[86:87], v[50:51], v[64:67]
    v_cvt_pk_bf16_f32 v68, v52, v56
    v_cvt_pk_bf16_f32 v69, v53, v57
    v_cvt_pk_bf16_f32 v70, v54, v58
    v_cvt_pk_bf16_f32 v71, v55, v59
    buffer_store_dwordx4 v[68:71], v1, s[4:7], s47 offen offset:0 nt
    s_nop 2
    v_cvt_pk_bf16_f32 v72, v60, v64
    v_cvt_pk_bf16_f32 v73, v61, v65
    v_cvt_pk_bf16_f32 v74, v62, v66
    v_cvt_pk_bf16_f32 v75, v63, v67
    buffer_store_dwordx4 v[72:75], v1, s[4:7], s47 offen offset:1024 nt
    s_lshl_b32 s49, s53, 7
    s_add_u32 s49, s49, 1064960
    s_lshl_b32 s48, s45, 2
    s_add_u32 s48, s48, s49
    s_lshl_b32 s47, s61, 1
    s_add_u32 s47, s47, s54
    s_lshl_b32 s47, s47, 2
    s_add_u32 s47, s47, s46
    s_lshl_b32 s47, s47, 15
    s_add_u32 s60, s47, 75497472
    s_waitcnt vmcnt(0)
    s_barrier
    s_cmp_lg_u32 s46, 0
    s_cbranch_scc1 L_p3_of
    v_mov_b32 v10, 0
    v_mov_b32 v11, 1
    s_mov_b64 exec, 1
    buffer_store_dword v11, v10, s[4:7], s48 offen
    s_mov_b64 exec, -1
L_p3_of:
L_p3_ow:
    buffer_load_dword v11, v13, s[4:7], s49 offen sc1
    s_add_u32 s3, s3, 1
    s_cmp_gt_u32 s3, 262144
    s_cbranch_scc1 L_p3_ow_out
    s_waitcnt vmcnt(0)
    v_cmp_ne_u32 vcc, 1, v11
    s_cbranch_vccz L_p3_ow_out
    s_branch L_p3_ow
L_p3_ow_out:
    s_waitcnt vmcnt(0)
    s_add_u32 s66, s65, 0
    s_and_b32 s66, s66, 3
    s_lshl_b32 s66, s66, 13
    s_add_u32 s66, s66, s60
    buffer_load_dwordx4 v[92:95], v1, s[4:7], s66 offen offset:0 sc1
    buffer_load_dwordx4 v[96:99], v1, s[4:7], s66 offen offset:1024 sc1
    buffer_load_dwordx4 v[100:103], v1, s[4:7], s66 offen offset:2048 sc1
    buffer_load_dwordx4 v[104:107], v1, s[4:7], s66 offen offset:3072 sc1
    s_add_u32 s66, s66, 4096
    buffer_load_dwordx4 v[108:111], v1, s[4:7], s66 offen offset:0 sc1
    buffer_load_dwordx4 v[112:115], v1, s[4:7], s66 offen offset:1024 sc1
    buffer_load_dwordx4 v[116:119], v1, s[4:7], s66 offen offset:2048 sc1
    buffer_load_dwordx4 v[120:123], v1, s[4:7], s66 offen offset:3072 sc1
    s_add_u32 s66, s65, 1
    s_and_b32 s66, s66, 3
    s_lshl_b32 s66, s66, 13
    s_add_u32 s66, s66, s60
    buffer_load_dwordx4 v[124:127], v1, s[4:7], s66 offen offset:0 sc1
    buffer_load_dwordx4 v[128:131], v1, s[4:7], s66 offen offset:1024 sc1
    buffer_load_dwordx4 v[132:135], v1, s[4:7], s66 offen offset:2048 sc1
    buffer_load_dwordx4 v[136:139], v1, s[4:7], s66 offen offset:3072 sc1
    s_add_u32 s66, s66, 4096
    buffer_load_dwordx4 v[140:143], v1, s[4:7], s66 offen offset:0 sc1
    buffer_load_dwordx4 v[144:147], v1, s[4:7], s66 offen offset:1024 sc1
    buffer_load_dwordx4 v[148:151], v1, s[4:7], s66 offen offset:2048 sc1
    buffer_load_dwordx4 v[152:155], v1, s[4:7], s66 offen offset:3072 sc1
    s_waitcnt vmcnt(15)
    v_mfma_f32_16x16x32_bf16 v[20:23], a[0:3], v[92:95], 0
    v_mfma_f32_16x16x32_bf16 v[24:27], a[4:7], v[92:95], 0
    s_add_u32 s66, s65, 2
    s_and_b32 s66, s66, 3
    s_lshl_b32 s66, s66, 13
    s_add_u32 s66, s66, s60
    buffer_load_dwordx4 v[92:95], v1, s[4:7], s66 offen offset:0 sc1
    s_waitcnt vmcnt(15)
    v_mfma_f32_16x16x32_bf16 v[20:23], a[8:11], v[96:99], v[20:23]
    v_mfma_f32_16x16x32_bf16 v[24:27], a[12:15], v[96:99], v[24:27]
    buffer_load_dwordx4 v[96:99], v1, s[4:7], s66 offen offset:1024 sc1
    s_waitcnt vmcnt(15)
    v_mfma_f32_16x16x32_bf16 v[20:23], a[16:19], v[100:103], v[20:23]
    v_mfma_f32_16x16x32_bf16 v[24:27], a[20:23], v[100:103], v[24:27]
    buffer_load_dwordx4 v[100:103], v1, s[4:7], s66 offen offset:2048 sc1
    s_waitcnt vmcnt(15)
    v_mfma_f32_16x16x32_bf16 v[20:23], a[24:27], v[104:107], v[20:23]
    v_mfma_f32_16x16x32_bf16 v[24:27], a[28:31], v[104:107], v[24:27]
    buffer_load_dwordx4 v[104:107], v1, s[4:7], s66 offen offset:3072 sc1
    s_add_u32 s66, s66, 4096
    s_waitcnt vmcnt(15)
    v_mfma_f32_16x16x32_bf16 v[20:23], a[32:35], v[108:111], v[20:23]
    v_mfma_f32_16x16x32_bf16 v[24:27], a[36:39], v[108:111], v[24:27]
    buffer_load_dwordx4 v[108:111], v1, s[4:7], s66 offen offset:0 sc1
    s_waitcnt vmcnt(15)
    v_mfma_f32_16x16x32_bf16 v[20:23], a[40:43], v[112:115], v[20:23]
    v_mfma_f32_16x16x32_bf16 v[24:27], a[44:47], v[112:115], v[24:27]
    buffer_load_dwordx4 v[112:115], v1, s[4:7], s66 offen offset:1024 sc1
    s_waitcnt vmcnt(15)
    v_mfma_f32_16x16x32_bf16 v[20:23], a[48:51], v[116:119], v[20:23]
    v_mfma_f32_16x16x32_bf16 v[24:27], a[52:55], v[116:119], v[24:27]
    buffer_load_dwordx4 v[116:119], v1, s[4:7], s66 offen offset:2048 sc1
    s_waitcnt vmcnt(15)
    v_mfma_f32_16x16x32_bf16 v[20:23], a[56:59], v[120:123], v[20:23]
    v_mfma_f32_16x16x32_bf16 v[24:27], a[60:63], v[120:123], v[24:27]
    buffer_load_dwordx4 v[120:123], v1, s[4:7], s66 offen offset:3072 sc1
    s_waitcnt vmcnt(15)
    v_mfma_f32_16x16x32_bf16 v[20:23], a[64:67], v[124:127], v[20:23]
    v_mfma_f32_16x16x32_bf16 v[24:27], a[68:71], v[124:127], v[24:27]
    s_add_u32 s66, s65, 3
    s_and_b32 s66, s66, 3
    s_lshl_b32 s66, s66, 13
    s_add_u32 s66, s66, s60
    buffer_load_dwordx4 v[124:127], v1, s[4:7], s66 offen offset:0 sc1
    s_waitcnt vmcnt(15)
    v_mfma_f32_16x16x32_bf16 v[20:23], a[72:75], v[128:131], v[20:23]
    v_mfma_f32_16x16x32_bf16 v[24:27], a[76:79], v[128:131], v[24:27]
    buffer_load_dwordx4 v[128:131], v1, s[4:7], s66 offen offset:1024 sc1
    s_waitcnt vmcnt(15)
    v_mfma_f32_16x16x32_bf16 v[20:23], a[80:83], v[132:135], v[20:23]
    v_mfma_f32_16x16x32_bf16 v[24:27], a[84:87], v[132:135], v[24:27]
    buffer_load_dwordx4 v[132:135], v1, s[4:7], s66 offen offset:2048 sc1
    s_waitcnt vmcnt(15)
    v_mfma_f32_16x16x32_bf16 v[20:23], a[88:91], v[136:139], v[20:23]
    v_mfma_f32_16x16x32_bf16 v[24:27], a[92:95], v[136:139], v[24:27]
    buffer_load_dwordx4 v[136:139], v1, s[4:7], s66 offen offset:3072 sc1
    s_add_u32 s66, s66, 4096
    s_waitcnt vmcnt(15)
    v_mfma_f32_16x16x32_bf16 v[20:23], a[96:99], v[140:143], v[20:23]
    v_mfma_f32_16x16x32_bf16 v[24:27], a[100:103], v[140:143], v[24:27]
    buffer_load_dwordx4 v[140:143], v1, s[4:7], s66 offen offset:0 sc1
    s_waitcnt vmcnt(15)
    v_mfma_f32_16x16x32_bf16 v[20:23], a[104:107], v[144:147], v[20:23]
    v_mfma_f32_16x16x32_bf16 v[24:27], a[108:111], v[144:147], v[24:27]
    buffer_load_dwordx4 v[144:147], v1, s[4:7], s66 offen offset:1024 sc1
    s_waitcnt vmcnt(15)
    v_mfma_f32_16x16x32_bf16 v[20:23], a[112:115], v[148:151], v[20:23]
    v_mfma_f32_16x16x32_bf16 v[24:27], a[116:119], v[148:151], v[24:27]
    buffer_load_dwordx4 v[148:151], v1, s[4:7], s66 offen offset:2048 sc1
    s_waitcnt vmcnt(15)
    v_mfma_f32_16x16x32_bf16 v[20:23], a[120:123], v[152:155], v[20:23]
    v_mfma_f32_16x16x32_bf16 v[24:27], a[124:127], v[152:155], v[24:27]
    buffer_load_dwordx4 v[152:155], v1, s[4:7], s66 offen offset:3072 sc1
    s_waitcnt vmcnt(15)
    v_mfma_f32_16x16x32_bf16 v[20:23], a[128:131], v[92:95], v[20:23]
    v_mfma_f32_16x16x32_bf16 v[24:27], a[132:135], v[92:95], v[24:27]
    s_waitcnt vmcnt(14)
    v_mfma_f32_16x16x32_bf16 v[20:23], a[136:139], v[96:99], v[20:23]
    v_mfma_f32_16x16x32_bf16 v[24:27], a[140:143], v[96:99], v[24:27]
    s_waitcnt vmcnt(13)
    v_mfma_f32_16x16x32_bf16 v[20:23], a[144:147], v[100:103], v[20:23]
    v_mfma_f32_16x16x32_bf16 v[24:27], a[148:151], v[100:103], v[24:27]
    s_waitcnt vmcnt(12)
    v_mfma_f32_16x16x32_bf16 v[20:23], a[152:155], v[104:107], v[20:23]
    v_mfma_f32_16x16x32_bf16 v[24:27], a[156:159], v[104:107], v[24:27]
    s_waitcnt vmcnt(11)
    v_mfma_f32_16x16x32_bf16 v[20:23], a[160:163], v[108:111], v[20:23]
    v_mfma_f32_16x16x32_bf16 v[24:27], a[164:167], v[108:111], v[24:27]
    s_waitcnt vmcnt(10)
    v_mfma_f32_16x16x32_bf16 v[20:23], a[168:171], v[112:115], v[20:23]
    v_mfma_f32_16x16x32_bf16 v[24:27], a[172:175], v[112:115], v[24:27]
    s_waitcnt vmcnt(9)
    v_mfma_f32_16x16x32_bf16 v[20:23], a[176:179], v[116:119], v[20:23]
    v_mfma_f32_16x16x32_bf16 v[24:27], a[180:183], v[116:119], v[24:27]
    s_waitcnt vmcnt(8)
    v_mfma_f32_16x16x32_bf16 v[20:23], a[184:187], v[120:123], v[20:23]
    v_mfma_f32_16x16x32_bf16 v[24:27], a[188:191], v[120:123], v[24:27]
    s_waitcnt vmcnt(7)
    v_mfma_f32_16x16x32_bf16 v[20:23], a[192:195], v[124:127], v[20:23]
    v_mfma_f32_16x16x32_bf16 v[24:27], a[196:199], v[124:127], v[24:27]
    s_waitcnt vmcnt(6)
    v_mfma_f32_16x16x32_bf16 v[20:23], a[200:203], v[128:131], v[20:23]
    v_mfma_f32_16x16x32_bf16 v[24:27], a[204:207], v[128:131], v[24:27]
    s_waitcnt vmcnt(5)
    v_mfma_f32_16x16x32_bf16 v[20:23], a[208:211], v[132:135], v[20:23]
    v_mfma_f32_16x16x32_bf16 v[24:27], a[212:215], v[132:135], v[24:27]
    s_waitcnt vmcnt(4)
    v_mfma_f32_16x16x32_bf16 v[20:23], a[216:219], v[136:139], v[20:23]
    v_mfma_f32_16x16x32_bf16 v[24:27], a[220:223], v[136:139], v[24:27]
    s_waitcnt vmcnt(3)
    v_mfma_f32_16x16x32_bf16 v[20:23], a[224:227], v[140:143], v[20:23]
    v_mfma_f32_16x16x32_bf16 v[24:27], a[228:231], v[140:143], v[24:27]
    s_waitcnt vmcnt(2)
    v_mfma_f32_16x16x32_bf16 v[20:23], a[232:235], v[144:147], v[20:23]
    v_mfma_f32_16x16x32_bf16 v[24:27], a[236:239], v[144:147], v[24:27]
    s_waitcnt vmcnt(1)
    v_mfma_f32_16x16x32_bf16 v[20:23], a[240:243], v[148:151], v[20:23]
    v_mfma_f32_16x16x32_bf16 v[24:27], a[244:247], v[148:151], v[24:27]
    s_waitcnt vmcnt(0)
    v_mfma_f32_16x16x32_bf16 v[20:23], a[248:251], v[152:155], v[20:23]
    v_mfma_f32_16x16x32_bf16 v[24:27], a[252:255], v[152:155], v[24:27]
    s_nop 7
    ds_write_b128 v3, v[20:23] offset:0
    ds_write_b128 v12, v[24:27] offset:0
    s_waitcnt lgkmcnt(0)
    s_barrier
    ds_read_b64 v[20:21], v4 offset:0
    ds_read_b64 v[22:23], v4 offset:2048
    ds_read_b64 v[24:25], v4 offset:4096
    ds_read_b64 v[26:27], v4 offset:6144
    s_waitcnt lgkmcnt(0)
    v_pk_add_f32 v[20:21], v[20:21], v[22:23]
    v_pk_add_f32 v[24:25], v[24:25], v[26:27]
    v_pk_add_f32 v[20:21], v[20:21], v[24:25]
    v_cvt_pk_bf16_f32 v28, v20, v21
    v_and_b32 v29, s62, v28
    v_lshlrev_b32 v28, 16, v28
    v_pk_mul_f32 v[28:29], v[28:29], v[14:15]
    v_cvt_pk_bf16_f32 v28, v28, v29
    v_and_b32 v29, s62, v28
    v_lshlrev_b32 v28, 16, v28
    v_pk_add_f32 v[28:29], v[28:29], v[16:17]
    v_cvt_pk_bf16_f32 v28, v28, v29
    buffer_store_dword v28, v5, s[68:71], s56 offen nt
    s_xor_b32 s61, s61, 1
    s_add_u32 s53, s53, 6
    s_cmp_lt_u32 s53, 64
    s_barrier
    s_cbranch_scc1 L_p3_seg
    s_waitcnt vmcnt(0)
    s_endpgm
L_exit:
    s_endpgm
L_chain:
    v_and_b32 v56, 63, v0
    v_lshrrev_b32 v57, 4, v56
    v_and_b32 v58, 15, v56
    s_and_b32 s47, s46, 1
    s_lshr_b32 s48, s46, 1
    s_lshl_b32 s48, s48, 6
    s_add_u32 s48, s48, s47
    s_lshl_b32 s48, s48, 14
    s_lshl_b32 s49, s45, 8
    s_add_u32 s48, s48, s49
    s_lshl_b32 s47, s47, 3
    v_lshlrev_b32 v59, 1, v57
    v_xor_b32 v59, v59, v58
    v_xor_b32 v20, s47, v59
    v_lshlrev_b32 v20, 4, v20
    v_lshlrev_b32 v21, 4, v59
    v_lshrrev_b32 v58, 1, v57
    v_and_b32 v59, 1, v57
    v_lshl_add_u32 v20, v58, 16, v20
    v_lshl_add_u32 v20, v59, 17, v20
    v_add_u32 v20, s48, v20
    v_lshl_add_u32 v21, v58, 12, v21
    v_lshl_add_u32 v21, v59, 14, v21
    s_lshl_b32 s48, s45, 17
    s_lshl_b32 s49, s46, 8
    s_add_u32 s48, s48, s49
    v_add_u32 v21, s48, v21
    v_xor_b32 v22, 0x80, v21
    v_bfe_u32 v58, v56, 2, 2
    v_and_b32 v59, 1, v57
    v_lshl_add_u32 v59, v59, 2, v58
    v_lshlrev_b32 v59, 5, v59
    v_lshl_add_u32 v59, v58, 8, v59
    v_and_b32 v58, 3, v56
    v_lshl_add_u32 v59, v58, 3, v59
    s_lshl_b32 s47, s46, 6
    v_xor_b32 v10, s47, v59
    s_mov_b32 s47, 38912
    v_mul_lo_u32 v58, s47, v57
    v_add_u32 v10, v10, v58
    v_xor_b32 v11, 32, v10
    s_mul_i32 s50, s46, 38912
    v_lshl_add_u32 v12, v57, 10, v59
    v_add_u32 v12, s50, v12
    v_xor_b32 v13, 32, v12
    v_xor_b32 v14, 64, v12
    v_xor_b32 v15, 96, v12
    v_xor_b32 v16, 128, v12
    v_xor_b32 v17, 160, v12
    v_xor_b32 v18, 192, v12
    v_xor_b32 v19, 224, v12
    s_mov_b32 s8, s26
    s_mov_b32 s9, s27
    s_mov_b32 s10, 4194304
    s_mov_b32 s11, 0x20000
    s_add_u32 m0, s50, 16384
    s_mov_b32 s47, 0
    buffer_load_dwordx4 v21, s[8:11], s47 offen  lds
    s_add_u32 m0, s50, 17408
    s_mov_b32 s47, 2048
    buffer_load_dwordx4 v22, s[8:11], s47 offen  lds
    s_add_u32 m0, s50, 18432
    s_mov_b32 s47, 8192
    buffer_load_dwordx4 v21, s[8:11], s47 offen  lds
    s_add_u32 m0, s50, 19456
    s_mov_b32 s47, 10240
    buffer_load_dwordx4 v22, s[8:11], s47 offen  lds
    s_add_u32 m0, s50, 20480
    s_mov_b32 s47, 1024
    buffer_load_dwordx4 v21, s[8:11], s47 offen  lds
    s_add_u32 m0, s50, 21504
    s_mov_b32 s47, 3072
    buffer_load_dwordx4 v22, s[8:11], s47 offen  lds
    s_add_u32 m0, s50, 22528
    s_mov_b32 s47, 9216
    buffer_load_dwordx4 v21, s[8:11], s47 offen  lds
    s_add_u32 m0, s50, 23552
    s_mov_b32 s47, 11264
    buffer_load_dwordx4 v22, s[8:11], s47 offen  lds
    s_add_u32 m0, s50, 24576
    s_mov_b32 s47, 32768
    buffer_load_dwordx4 v21, s[8:11], s47 offen  lds
    s_add_u32 m0, s50, 25600
    s_mov_b32 s47, 34816
    buffer_load_dwordx4 v22, s[8:11], s47 offen  lds
    s_add_u32 m0, s50, 26624
    s_mov_b32 s47, 40960
    buffer_load_dwordx4 v21, s[8:11], s47 offen  lds
    s_add_u32 m0, s50, 27648
    s_mov_b32 s47, 43008
    buffer_load_dwordx4 v22, s[8:11], s47 offen  lds
    v_and_b32 v56, 63, v0
    v_lshlrev_b32 v3, 4, v56
    s_mul_i32 s47, s46, 38912
    v_add_u32 v2, s47, v3
    v_add_u32 v3, 155648, v3
    v_lshrrev_b32 v57, 4, v56
    v_and_b32 v58, 15, v56
    s_lshl_b32 s47, s46, 3
    v_lshrrev_b32 v59, 3, v56
    v_add_u32 v59, s47, v59
    v_lshlrev_b32 v4, 13, v59
    v_lshl_add_u32 v59, v59, 1, s45
    v_and_b32 v59, 31, v59
    v_lshl_add_u32 v4, v59, 7, v4
    v_and_b32 v59, 7, v56
    v_lshl_add_u32 v4, v59, 3, v4
    v_lshrrev_b32 v59, 3, v58
    v_lshlrev_b32 v5, 29, v59
    v_bfe_u32 v59, v58, 1, 1
    v_lshl_add_u32 v5, v59, 11, v5
    v_bfe_u32 v59, v58, 2, 1
    v_lshl_add_u32 v5, v59, 7, v5
    v_and_b32 v59, 1, v58
    v_lshl_add_u32 v5, v59, 3, v5
    v_and_b32 v59, 1, v57
    v_lshl_add_u32 v5, v59, 4, v5
    v_lshrrev_b32 v59, 1, v57
    v_lshl_add_u32 v5, v59, 30, v5
    s_and_b32 s47, s45, 3
    s_lshl_b32 s47, s47, 5
    s_lshr_b32 s48, s45, 2
    s_lshl_b32 s48, s48, 8
    s_add_u32 s47, s47, s48
    s_and_b32 s49, s46, 1
    s_lshl_b32 s49, s49, 12
    s_add_u32 s47, s47, s49
    v_add_u32 v5, s47, v5
    s_mov_b32 s51, 0
    s_lshl_b32 s47, s45, 13
    s_add_u32 s54, s47, 1941504
    s_mov_b32 s52, 2097152
    s_mov_b32 s53, 2101248
    s_mov_b32 s57, 3145728
    s_mov_b32 s58, 3149824
    s_lshl_b32 s47, s45, 14
    s_add_u32 s60, s47, 8232960
    s_lshl_b32 s47, s45, 2
    s_add_u32 s47, s47, s46
    s_lshl_b32 s47, s47, 10
    s_add_u32 s61, s47, 59613184
    s_lshl_b32 s47, s45, 8
    s_add_u32 s64, s47, 1048576
    s_mov_b32 s66, 0xcccccccc
    s_mov_b32 s67, 0xcccccccc
    s_mov_b32 s63, 0x3e0293ee
    s_mov_b32 s62, 0x3e0293ee
    v_mov_b64 v[60:61], -1
    v_mov_b64 v[62:63], -1
    s_lshl_b32 s48, s46, 11
    s_add_u32 s48, s48, s54
    s_add_u32 s54, s54, s49
    buffer_store_dwordx4 v[60:63], v3, s[4:7], s48 offen offset:0
    buffer_store_dwordx4 v[60:63], v3, s[4:7], s48 offen offset:1024
    s_mov_b32 s72, 3153920
    s_mov_b32 s8, s18
    s_mov_b32 s9, s19
    s_mov_b32 s10, 8192
    s_mov_b32 s11, 0x20000
    s_lshr_b32 s47, s45, 3
    s_lshl_b32 s47, s47, 8
    s_and_b32 s48, s45, 1
    s_lshl_b32 s48, s48, 4
    s_add_u32 s47, s47, s48
    s_lshr_b32 s48, s49, 5
    s_add_u32 s47, s47, s48
    s_and_b32 s48, s45, 6
    s_lshl_b32 s48, s48, 10
    s_add_u32 s47, s47, s48
    v_and_b32 v59, 1, v57
    v_lshlrev_b32 v59, 10, v59
    v_and_b32 v52, 3, v58
    v_lshl_add_u32 v59, v52, 2, v59
    v_bfe_u32 v52, v58, 2, 1
    v_lshl_add_u32 v59, v52, 6, v59
    buffer_load_ushort v52, v59, s[8:11], s47 offen
    buffer_load_ushort v53, v59, s[8:11], s47 offen offset:32
    buffer_load_ushort v54, v59, s[8:11], s47 offen offset:2
    buffer_load_ushort v55, v59, s[8:11], s47 offen offset:34
    s_mov_b32 s8, s26
    s_mov_b32 s9, s27
    s_mov_b32 s10, 4194304
    s_mov_b32 s11, 0x20000
    s_waitcnt vmcnt(14) lgkmcnt(0)
    s_barrier
    s_add_u32 m0, s50, 28672
    s_mov_b32 s47, 33792
    buffer_load_dwordx4 v21, s[8:11], s47 offen  lds
    s_add_u32 m0, s50, 29696
    s_mov_b32 s47, 35840
    buffer_load_dwordx4 v22, s[8:11], s47 offen  lds
    s_add_u32 m0, s50, 30720
    s_mov_b32 s47, 41984
    buffer_load_dwordx4 v21, s[8:11], s47 offen  lds
    s_add_u32 m0, s50, 31744
    s_mov_b32 s47, 44032
    buffer_load_dwordx4 v22, s[8:11], s47 offen  lds
    ds_read_b64_tr_b16 v[184:185], v12 offset:16384
    ds_read_b64_tr_b16 v[200:201], v13 offset:16384
    ds_read_b64_tr_b16 v[216:217], v14 offset:16384
    ds_read_b64_tr_b16 v[232:233], v15 offset:16384
    ds_read_b64_tr_b16 v[248:249], v16 offset:16384
    ds_read_b64_tr_b16 v[72:73], v17 offset:16384
    ds_read_b64_tr_b16 v[88:89], v18 offset:16384
    ds_read_b64_tr_b16 v[32:33], v19 offset:16384
    s_waitcnt vmcnt(14) lgkmcnt(0)
    s_barrier
    s_add_u32 m0, s50, 16384
    s_mov_b32 s47, 65536
    buffer_load_dwordx4 v21, s[8:11], s47 offen  lds
    s_add_u32 m0, s50, 17408
    s_mov_b32 s47, 67584
    buffer_load_dwordx4 v22, s[8:11], s47 offen  lds
    s_add_u32 m0, s50, 18432
    s_mov_b32 s47, 73728
    buffer_load_dwordx4 v21, s[8:11], s47 offen  lds
    s_add_u32 m0, s50, 19456
    s_mov_b32 s47, 75776
    buffer_load_dwordx4 v22, s[8:11], s47 offen  lds
    ds_read_b64_tr_b16 v[186:187], v12 offset:20480
    ds_read_b64_tr_b16 v[202:203], v13 offset:20480
    ds_read_b64_tr_b16 v[218:219], v14 offset:20480
    ds_read_b64_tr_b16 v[234:235], v15 offset:20480
    ds_read_b64_tr_b16 v[250:251], v16 offset:20480
    ds_read_b64_tr_b16 v[74:75], v17 offset:20480
    ds_read_b64_tr_b16 v[90:91], v18 offset:20480
    ds_read_b64_tr_b16 v[34:35], v19 offset:20480
    s_waitcnt vmcnt(14) lgkmcnt(0)
    s_barrier
    s_getpc_b64 s[68:69]
L_c_pc:
    s_add_u32 s68, s68, L_c_w0-L_c_pc
    s_addc_u32 s69, s69, 0
    v_lshlrev_b32 v56, 7, v0
    v_min_u32 v56, L_c_end-L_c_w0-4, v56
    global_load_dword v57, v56, s[68:69]
    s_add_u32 m0, s50, 20480
    s_mov_b32 s47, 66560
    buffer_load_dwordx4 v21, s[8:11], s47 offen  lds
    s_add_u32 m0, s50, 21504
    s_mov_b32 s47, 68608
    buffer_load_dwordx4 v22, s[8:11], s47 offen  lds
    s_add_u32 m0, s50, 22528
    s_mov_b32 s47, 74752
    buffer_load_dwordx4 v21, s[8:11], s47 offen  lds
    s_add_u32 m0, s50, 23552
    s_mov_b32 s47, 76800
    buffer_load_dwordx4 v22, s[8:11], s47 offen  lds
    ds_read_b64_tr_b16 v[188:189], v12 offset:24576
    ds_read_b64_tr_b16 v[204:205], v13 offset:24576
    ds_read_b64_tr_b16 v[220:221], v14 offset:24576
    ds_read_b64_tr_b16 v[236:237], v15 offset:24576
    ds_read_b64_tr_b16 v[252:253], v16 offset:24576
    ds_read_b64_tr_b16 v[76:77], v17 offset:24576
    ds_read_b64_tr_b16 v[92:93], v18 offset:24576
    ds_read_b64_tr_b16 v[36:37], v19 offset:24576
    s_waitcnt vmcnt(8) lgkmcnt(0)
    s_barrier
    s_mov_b32 s47, 3145728
    v_lshl_or_b32 v52, v53, 16, v52
    v_lshl_or_b32 v53, v55, 16, v54
    v_cmp_ne_u32 vcc, s12, v52
    s_nop 1
    v_cndmask_b32 v52, -1, v52, vcc
    v_cmp_ne_u32 vcc, s12, v53
    s_nop 1
    v_cndmask_b32 v53, -1, v53, vcc
    buffer_store_dwordx2 v[52:53], v5, s[4:7], s47 offen
    s_add_u32 m0, s50, 24576
    s_mov_b32 s47, 98304
    buffer_load_dwordx4 v21, s[8:11], s47 offen  lds
    s_add_u32 m0, s50, 25600
    s_mov_b32 s47, 100352
    buffer_load_dwordx4 v22, s[8:11], s47 offen  lds
    s_add_u32 m0, s50, 26624
    s_mov_b32 s47, 106496
    buffer_load_dwordx4 v21, s[8:11], s47 offen  lds
    s_add_u32 m0, s50, 27648
    s_mov_b32 s47, 108544
    buffer_load_dwordx4 v22, s[8:11], s47 offen  lds
    ds_read_b64_tr_b16 v[190:191], v12 offset:28672
    ds_read_b64_tr_b16 v[206:207], v13 offset:28672
    ds_read_b64_tr_b16 v[222:223], v14 offset:28672
    ds_read_b64_tr_b16 v[238:239], v15 offset:28672
    ds_read_b64_tr_b16 v[254:255], v16 offset:28672
    ds_read_b64_tr_b16 v[78:79], v17 offset:28672
    ds_read_b64_tr_b16 v[94:95], v18 offset:28672
    ds_read_b64_tr_b16 v[38:39], v19 offset:28672
    s_waitcnt vmcnt(8) lgkmcnt(0)
    s_barrier
    s_add_u32 m0, s50, 28672
    s_mov_b32 s47, 99328
    buffer_load_dwordx4 v21, s[8:11], s47 offen  lds
    s_add_u32 m0, s50, 29696
    s_mov_b32 s47, 101376
    buffer_load_dwordx4 v22, s[8:11], s47 offen  lds
    s_add_u32 m0, s50, 30720
    s_mov_b32 s47, 107520
    buffer_load_dwordx4 v21, s[8:11], s47 offen  lds
    s_add_u32 m0, s50, 31744
    s_mov_b32 s47, 109568
    buffer_load_dwordx4 v22, s[8:11], s47 offen  lds
    ds_read_b64_tr_b16 v[192:193], v12 offset:16384
    ds_read_b64_tr_b16 v[208:209], v13 offset:16384
    ds_read_b64_tr_b16 v[224:225], v14 offset:16384
    ds_read_b64_tr_b16 v[240:241], v15 offset:16384
    ds_read_b64_tr_b16 v[64:65], v16 offset:16384
    ds_read_b64_tr_b16 v[80:81], v17 offset:16384
    ds_read_b64_tr_b16 v[24:25], v18 offset:16384
    ds_read_b64_tr_b16 v[144:145], v19 offset:16384
    s_waitcnt vmcnt(8) lgkmcnt(0)
    s_barrier
    s_mov_b32 s8, s20
    s_mov_b32 s9, s21
    s_mov_b32 s10, 4194304
    s_mov_b32 s11, 0x20000
    s_add_u32 m0, s50, 16384
    s_mov_b32 s47, 0
    buffer_load_dwordx4 v20, s[8:11], s47 offen  lds
    s_add_u32 m0, s50, 17408
    s_mov_b32 s47, 8192
    buffer_load_dwordx4 v20, s[8:11], s47 offen  lds
    s_add_u32 m0, s50, 18432
    s_mov_b32 s47, 2097152
    buffer_load_dwordx4 v20, s[8:11], s47 offen  lds
    s_add_u32 m0, s50, 19456
    s_mov_b32 s47, 2105344
    buffer_load_dwordx4 v20, s[8:11], s47 offen  lds
    ds_read_b64_tr_b16 v[194:195], v12 offset:20480
    ds_read_b64_tr_b16 v[210:211], v13 offset:20480
    ds_read_b64_tr_b16 v[226:227], v14 offset:20480
    ds_read_b64_tr_b16 v[242:243], v15 offset:20480
    ds_read_b64_tr_b16 v[66:67], v16 offset:20480
    ds_read_b64_tr_b16 v[82:83], v17 offset:20480
    ds_read_b64_tr_b16 v[26:27], v18 offset:20480
    ds_read_b64_tr_b16 v[146:147], v19 offset:20480
    s_waitcnt vmcnt(8) lgkmcnt(0)
    s_barrier
    s_add_u32 m0, s50, 20480
    s_mov_b32 s47, 32768
    buffer_load_dwordx4 v20, s[8:11], s47 offen  lds
    s_add_u32 m0, s50, 21504
    s_mov_b32 s47, 40960
    buffer_load_dwordx4 v20, s[8:11], s47 offen  lds
    s_add_u32 m0, s50, 22528
    s_mov_b32 s47, 2129920
    buffer_load_dwordx4 v20, s[8:11], s47 offen  lds
    s_add_u32 m0, s50, 23552
    s_mov_b32 s47, 2138112
    buffer_load_dwordx4 v20, s[8:11], s47 offen  lds
    ds_read_b64_tr_b16 v[196:197], v12 offset:24576
    ds_read_b64_tr_b16 v[212:213], v13 offset:24576
    ds_read_b64_tr_b16 v[228:229], v14 offset:24576
    ds_read_b64_tr_b16 v[244:245], v15 offset:24576
    ds_read_b64_tr_b16 v[68:69], v16 offset:24576
    ds_read_b64_tr_b16 v[84:85], v17 offset:24576
    ds_read_b64_tr_b16 v[28:29], v18 offset:24576
    ds_read_b64_tr_b16 v[148:149], v19 offset:24576
    s_waitcnt vmcnt(8) lgkmcnt(0)
    s_barrier
    s_cmp_lg_u32 s46, 0
    s_cbranch_scc1 L_c_arrived4
    v_mov_b32 v56, 4
    v_mov_b32 v57, 1
    s_mov_b64 exec, 1
    global_atomic_add v56, v57, s[40:41]
    s_mov_b64 exec, -1
L_c_arrived4:
    s_add_u32 m0, s50, 24576
    s_mov_b32 s47, 262144
    buffer_load_dwordx4 v20, s[8:11], s47 offen  lds
    s_add_u32 m0, s50, 25600
    s_mov_b32 s47, 270336
    buffer_load_dwordx4 v20, s[8:11], s47 offen  lds
    s_add_u32 m0, s50, 26624
    s_mov_b32 s47, 2359296
    buffer_load_dwordx4 v20, s[8:11], s47 offen  lds
    s_add_u32 m0, s50, 27648
    s_mov_b32 s47, 2367488
    buffer_load_dwordx4 v20, s[8:11], s47 offen  lds
    ds_read_b64_tr_b16 v[198:199], v12 offset:28672
    ds_read_b64_tr_b16 v[214:215], v13 offset:28672
    ds_read_b64_tr_b16 v[230:231], v14 offset:28672
    ds_read_b64_tr_b16 v[246:247], v15 offset:28672
    ds_read_b64_tr_b16 v[70:71], v16 offset:28672
    ds_read_b64_tr_b16 v[86:87], v17 offset:28672
    ds_read_b64_tr_b16 v[30:31], v18 offset:28672
    ds_read_b64_tr_b16 v[150:151], v19 offset:28672
    s_waitcnt vmcnt(8) lgkmcnt(0)
    s_barrier
    ds_write_b128 v2, v[64:67] offset:12288
    ds_write_b128 v2, v[68:71] offset:13312
    ds_write_b128 v2, v[72:75] offset:14336
    ds_write_b128 v2, v[76:79] offset:15360
    ds_write_b128 v2, v[80:83] offset:32768
    ds_write_b128 v2, v[84:87] offset:33792
    ds_write_b128 v2, v[88:91] offset:34816
    ds_write_b128 v2, v[92:95] offset:35840
    ds_write_b128 v2, v[144:147] offset:36864
    ds_write_b128 v2, v[148:151] offset:37888
    s_cmp_eq_u32 s46, 0
    s_cbranch_scc1 L_c0_pad0
    s_cmp_eq_u32 s46, 1
    s_cbranch_scc1 L_c1_pad0
    s_cmp_eq_u32 s46, 2
    s_cbranch_scc1 L_c2_pad0
    s_branch L_c3_pad0
L_c_warm0:
    s_add_u32 m0, s50, 28672
    s_mov_b32 s47, 294912
    buffer_load_dwordx4 v20, s[8:11], s47 offen  lds
    s_add_u32 m0, s50, 29696
    s_mov_b32 s47, 303104
    buffer_load_dwordx4 v20, s[8:11], s47 offen  lds
    s_add_u32 m0, s50, 30720
    s_mov_b32 s47, 2392064
    buffer_load_dwordx4 v20, s[8:11], s47 offen  lds
    s_add_u32 m0, s50, 31744
    s_mov_b32 s47, 2400256
    buffer_load_dwordx4 v20, s[8:11], s47 offen  lds
    ds_read_b64_tr_b16 v[128:129], v10 offset:16384
    ds_read_b64_tr_b16 v[130:131], v10 offset:17408
    ds_read_b64_tr_b16 v[132:133], v10 offset:18432
    ds_read_b64_tr_b16 v[134:135], v10 offset:19456
    ds_read_b64_tr_b16 v[136:137], v11 offset:16384
    ds_read_b64_tr_b16 v[138:139], v11 offset:17408
    ds_read_b64_tr_b16 v[140:141], v11 offset:18432
    ds_read_b64_tr_b16 v[142:143], v11 offset:19456
    s_waitcnt vmcnt(8) lgkmcnt(0)
    s_barrier
    s_add_u32 m0, s50, 16384
    s_mov_b32 s47, 524288
    buffer_load_dwordx4 v20, s[8:11], s47 offen  lds
    s_add_u32 m0, s50, 17408
    s_mov_b32 s47, 532480
    buffer_load_dwordx4 v20, s[8:11], s47 offen  lds
    s_add_u32 m0, s50, 18432
    s_mov_b32 s47, 2621440
    buffer_load_dwordx4 v20, s[8:11], s47 offen  lds
    s_add_u32 m0, s50, 19456
    s_mov_b32 s47, 2629632
    buffer_load_dwordx4 v20, s[8:11], s47 offen  lds
    ds_read_b64_tr_b16 a[0:1], v10 offset:20480
    ds_read_b64_tr_b16 a[2:3], v10 offset:21504
    ds_read_b64_tr_b16 a[4:5], v10 offset:22528
    ds_read_b64_tr_b16 a[6:7], v10 offset:23552
    ds_read_b64_tr_b16 a[8:9], v11 offset:20480
    ds_read_b64_tr_b16 a[10:11], v11 offset:21504
    ds_read_b64_tr_b16 a[12:13], v11 offset:22528
    ds_read_b64_tr_b16 a[14:15], v11 offset:23552
    s_waitcnt vmcnt(8) lgkmcnt(0)
    s_barrier
    s_cmp_eq_u32 s46, 0
    s_cbranch_scc1 L_c0_pad4
    s_cmp_eq_u32 s46, 1
    s_cbranch_scc1 L_c1_pad4
    s_cmp_eq_u32 s46, 2
    s_cbranch_scc1 L_c2_pad4
    s_branch L_c3_pad4
L_c_warm1:
    s_add_u32 m0, s50, 20480
    s_mov_b32 s47, 557056
    buffer_load_dwordx4 v20, s[8:11], s47 offen  lds
    s_add_u32 m0, s50, 21504
    s_mov_b32 s47, 565248
    buffer_load_dwordx4 v20, s[8:11], s47 offen  lds
    s_add_u32 m0, s50, 22528
    s_mov_b32 s47, 2654208
    buffer_load_dwordx4 v20, s[8:11], s47 offen  lds
    s_add_u32 m0, s50, 23552
    s_mov_b32 s47, 2662400
    buffer_load_dwordx4 v20, s[8:11], s47 offen  lds
    ds_read_b64_tr_b16 a[16:17], v10 offset:24576
    ds_read_b64_tr_b16 a[18:19], v10 offset:25600
    ds_read_b64_tr_b16 a[20:21], v10 offset:26624
    ds_read_b64_tr_b16 a[22:23], v10 offset:27648
    ds_read_b64_tr_b16 a[24:25], v11 offset:24576
    ds_read_b64_tr_b16 a[26:27], v11 offset:25600
    ds_read_b64_tr_b16 a[28:29], v11 offset:26624
    ds_read_b64_tr_b16 a[30:31], v11 offset:27648
    s_waitcnt vmcnt(8) lgkmcnt(0)
    s_barrier
    s_add_u32 m0, s50, 24576
    s_mov_b32 s47, 786432
    buffer_load_dwordx4 v20, s[8:11], s47 offen  lds
    s_add_u32 m0, s50, 25600
    s_mov_b32 s47, 794624
    buffer_load_dwordx4 v20, s[8:11], s47 offen  lds
    s_add_u32 m0, s50, 26624
    s_mov_b32 s47, 2883584
    buffer_load_dwordx4 v20, s[8:11], s47 offen  lds
    s_add_u32 m0, s50, 27648
    s_mov_b32 s47, 2891776
    buffer_load_dwordx4 v20, s[8:11], s47 offen  lds
    ds_read_b64_tr_b16 a[32:33], v10 offset:28672
    ds_read_b64_tr_b16 a[34:35], v10 offset:29696
    ds_read_b64_tr_b16 a[36:37], v10 offset:30720
    ds_read_b64_tr_b16 a[38:39], v10 offset:31744
    ds_read_b64_tr_b16 a[40:41], v11 offset:28672
    ds_read_b64_tr_b16 a[42:43], v11 offset:29696
    ds_read_b64_tr_b16 a[44:45], v11 offset:30720
    ds_read_b64_tr_b16 a[46:47], v11 offset:31744
    s_waitcnt vmcnt(8) lgkmcnt(0)
    s_barrier
    s_add_u32 m0, s50, 28672
    s_mov_b32 s47, 819200
    buffer_load_dwordx4 v20, s[8:11], s47 offen  lds
    s_add_u32 m0, s50, 29696
    s_mov_b32 s47, 827392
    buffer_load_dwordx4 v20, s[8:11], s47 offen  lds
    s_add_u32 m0, s50, 30720
    s_mov_b32 s47, 2916352
    buffer_load_dwordx4 v20, s[8:11], s47 offen  lds
    s_add_u32 m0, s50, 31744
    s_mov_b32 s47, 2924544
    buffer_load_dwordx4 v20, s[8:11], s47 offen  lds
    ds_read_b64_tr_b16 a[48:49], v10 offset:16384
    ds_read_b64_tr_b16 a[50:51], v10 offset:17408
    ds_read_b64_tr_b16 a[52:53], v10 offset:18432
    ds_read_b64_tr_b16 a[54:55], v10 offset:19456
    ds_read_b64_tr_b16 a[56:57], v11 offset:16384
    ds_read_b64_tr_b16 a[58:59], v11 offset:17408
    ds_read_b64_tr_b16 a[60:61], v11 offset:18432
    ds_read_b64_tr_b16 a[62:63], v11 offset:19456
    s_waitcnt vmcnt(8) lgkmcnt(0)
    s_barrier
    s_mov_b32 s8, s22
    s_mov_b32 s9, s23
    s_mov_b32 s10, 4194304
    s_mov_b32 s11, 0x20000
    s_add_u32 m0, s50, 16384
    s_mov_b32 s47, 0
    buffer_load_dwordx4 v20, s[8:11], s47 offen  lds
    s_add_u32 m0, s50, 17408
    s_mov_b32 s47, 8192
    buffer_load_dwordx4 v20, s[8:11], s47 offen  lds
    s_add_u32 m0, s50, 18432
    s_mov_b32 s47, 2097152
    buffer_load_dwordx4 v20, s[8:11], s47 offen  lds
    s_add_u32 m0, s50, 19456
    s_mov_b32 s47, 2105344
    buffer_load_dwordx4 v20, s[8:11], s47 offen  lds
    ds_read_b64_tr_b16 a[64:65], v10 offset:20480
    ds_read_b64_tr_b16 a[66:67], v10 offset:21504
    ds_read_b64_tr_b16 a[68:69], v10 offset:22528
    ds_read_b64_tr_b16 a[70:71], v10 offset:23552
    ds_read_b64_tr_b16 a[72:73], v11 offset:20480
    ds_read_b64_tr_b16 a[74:75], v11 offset:21504
    ds_read_b64_tr_b16 a[76:77], v11 offset:22528
    ds_read_b64_tr_b16 a[78:79], v11 offset:23552
    s_waitcnt vmcnt(8) lgkmcnt(0)
    s_barrier
    s_add_u32 m0, s50, 20480
    s_mov_b32 s47, 32768
    buffer_load_dwordx4 v20, s[8:11], s47 offen  lds
    s_add_u32 m0, s50, 21504
    s_mov_b32 s47, 40960
    buffer_load_dwordx4 v20, s[8:11], s47 offen  lds
    s_add_u32 m0, s50, 22528
    s_mov_b32 s47, 2129920
    buffer_load_dwordx4 v20, s[8:11], s47 offen  lds
    s_add_u32 m0, s50, 23552
    s_mov_b32 s47, 2138112
    buffer_load_dwordx4 v20, s[8:11], s47 offen  lds
    ds_read_b64_tr_b16 a[80:81], v10 offset:24576
    ds_read_b64_tr_b16 a[82:83], v10 offset:25600
    ds_read_b64_tr_b16 a[84:85], v10 offset:26624
    ds_read_b64_tr_b16 a[86:87], v10 offset:27648
    ds_read_b64_tr_b16 a[88:89], v11 offset:24576
    ds_read_b64_tr_b16 a[90:91], v11 offset:25600
    ds_read_b64_tr_b16 a[92:93], v11 offset:26624
    ds_read_b64_tr_b16 a[94:95], v11 offset:27648
    s_waitcnt vmcnt(8) lgkmcnt(0)
    s_barrier
    s_add_u32 m0, s50, 24576
    s_mov_b32 s47, 262144
    buffer_load_dwordx4 v20, s[8:11], s47 offen  lds
    s_add_u32 m0, s50, 25600
    s_mov_b32 s47, 270336
    buffer_load_dwordx4 v20, s[8:11], s47 offen  lds
    s_add_u32 m0, s50, 26624
    s_mov_b32 s47, 2359296
    buffer_load_dwordx4 v20, s[8:11], s47 offen  lds
    s_add_u32 m0, s50, 27648
    s_mov_b32 s47, 2367488
    buffer_load_dwordx4 v20, s[8:11], s47 offen  lds
    ds_read_b64_tr_b16 v[40:41], v10 offset:28672
    ds_read_b64_tr_b16 v[42:43], v10 offset:29696
    ds_read_b64_tr_b16 v[44:45], v10 offset:30720
    ds_read_b64_tr_b16 v[46:47], v10 offset:31744
    ds_read_b64_tr_b16 v[48:49], v11 offset:28672
    ds_read_b64_tr_b16 v[50:51], v11 offset:29696
    ds_read_b64_tr_b16 v[52:53], v11 offset:30720
    ds_read_b64_tr_b16 v[54:55], v11 offset:31744
    s_waitcnt lgkmcnt(0)
    ds_write_b128 v2, v[40:43] offset:8192
    ds_write_b128 v2, v[44:47] offset:9216
    ds_write_b128 v2, v[48:51] offset:10240
    ds_write_b128 v2, v[52:55] offset:11264
    s_waitcnt vmcnt(8) lgkmcnt(0)
    s_barrier
    s_add_u32 m0, s50, 28672
    s_mov_b32 s47, 294912
    buffer_load_dwordx4 v20, s[8:11], s47 offen  lds
    s_add_u32 m0, s50, 29696
    s_mov_b32 s47, 303104
    buffer_load_dwordx4 v20, s[8:11], s47 offen  lds
    s_add_u32 m0, s50, 30720
    s_mov_b32 s47, 2392064
    buffer_load_dwordx4 v20, s[8:11], s47 offen  lds
    s_add_u32 m0, s50, 31744
    s_mov_b32 s47, 2400256
    buffer_load_dwordx4 v20, s[8:11], s47 offen  lds
    ds_read_b64_tr_b16 a[96:97], v10 offset:16384
    ds_read_b64_tr_b16 a[98:99], v10 offset:17408
    ds_read_b64_tr_b16 a[100:101], v10 offset:18432
    ds_read_b64_tr_b16 a[102:103], v10 offset:19456
    ds_read_b64_tr_b16 a[104:105], v11 offset:16384
    ds_read_b64_tr_b16 a[106:107], v11 offset:17408
    ds_read_b64_tr_b16 a[108:109], v11 offset:18432
    ds_read_b64_tr_b16 a[110:111], v11 offset:19456
    s_waitcnt vmcnt(8) lgkmcnt(0)
    s_barrier
    s_add_u32 m0, s50, 16384
    s_mov_b32 s47, 524288
    buffer_load_dwordx4 v20, s[8:11], s47 offen  lds
    s_add_u32 m0, s50, 17408
    s_mov_b32 s47, 532480
    buffer_load_dwordx4 v20, s[8:11], s47 offen  lds
    s_add_u32 m0, s50, 18432
    s_mov_b32 s47, 2621440
    buffer_load_dwordx4 v20, s[8:11], s47 offen  lds
    s_add_u32 m0, s50, 19456
    s_mov_b32 s47, 2629632
    buffer_load_dwordx4 v20, s[8:11], s47 offen  lds
    ds_read_b64_tr_b16 a[112:113], v10 offset:20480
    ds_read_b64_tr_b16 a[114:115], v10 offset:21504
    ds_read_b64_tr_b16 a[116:117], v10 offset:22528
    ds_read_b64_tr_b16 a[118:119], v10 offset:23552
    ds_read_b64_tr_b16 a[120:121], v11 offset:20480
    ds_read_b64_tr_b16 a[122:123], v11 offset:21504
    ds_read_b64_tr_b16 a[124:125], v11 offset:22528
    ds_read_b64_tr_b16 a[126:127], v11 offset:23552
    s_waitcnt vmcnt(8) lgkmcnt(0)
    s_barrier
    s_add_u32 m0, s50, 20480
    s_mov_b32 s47, 557056
    buffer_load_dwordx4 v20, s[8:11], s47 offen  lds
    s_add_u32 m0, s50, 21504
    s_mov_b32 s47, 565248
    buffer_load_dwordx4 v20, s[8:11], s47 offen  lds
    s_add_u32 m0, s50, 22528
    s_mov_b32 s47, 2654208
    buffer_load_dwordx4 v20, s[8:11], s47 offen  lds
    s_add_u32 m0, s50, 23552
    s_mov_b32 s47, 2662400
    buffer_load_dwordx4 v20, s[8:11], s47 offen  lds
    ds_read_b64_tr_b16 a[128:129], v10 offset:24576
    ds_read_b64_tr_b16 a[130:131], v10 offset:25600
    ds_read_b64_tr_b16 a[132:133], v10 offset:26624
    ds_read_b64_tr_b16 a[134:135], v10 offset:27648
    ds_read_b64_tr_b16 a[136:137], v11 offset:24576
    ds_read_b64_tr_b16 a[138:139], v11 offset:25600
    ds_read_b64_tr_b16 a[140:141], v11 offset:26624
    ds_read_b64_tr_b16 a[142:143], v11 offset:27648
    s_waitcnt vmcnt(8) lgkmcnt(0)
    s_barrier
    v_mov_b32 v62, 4
    s_mov_b32 s49, 224
    global_load_dwordx2 v[60:61], v62, s[40:41] sc1
    s_add_u32 m0, s50, 24576
    s_mov_b32 s47, 786432
    buffer_load_dwordx4 v20, s[8:11], s47 offen  lds
    s_add_u32 m0, s50, 25600
    s_mov_b32 s47, 794624
    buffer_load_dwordx4 v20, s[8:11], s47 offen  lds
    s_add_u32 m0, s50, 26624
    s_mov_b32 s47, 2883584
    buffer_load_dwordx4 v20, s[8:11], s47 offen  lds
    s_add_u32 m0, s50, 27648
    s_mov_b32 s47, 2891776
    buffer_load_dwordx4 v20, s[8:11], s47 offen  lds
    ds_read_b64_tr_b16 v[40:41], v10 offset:28672
    ds_read_b64_tr_b16 v[42:43], v10 offset:29696
    ds_read_b64_tr_b16 v[44:45], v10 offset:30720
    ds_read_b64_tr_b16 v[46:47], v10 offset:31744
    ds_read_b64_tr_b16 v[48:49], v11 offset:28672
    ds_read_b64_tr_b16 v[50:51], v11 offset:29696
    ds_read_b64_tr_b16 v[52:53], v11 offset:30720
    ds_read_b64_tr_b16 v[54:55], v11 offset:31744
    s_waitcnt lgkmcnt(0)
    ds_write_b128 v2, v[40:43] offset:4096
    ds_write_b128 v2, v[44:47] offset:5120
    ds_write_b128 v2, v[48:51] offset:6144
    ds_write_b128 v2, v[52:55] offset:7168
    s_waitcnt vmcnt(8) lgkmcnt(0)
    s_barrier
    s_add_u32 m0, s50, 28672
    s_mov_b32 s47, 819200
    buffer_load_dwordx4 v20, s[8:11], s47 offen  lds
    s_add_u32 m0, s50, 29696
    s_mov_b32 s47, 827392
    buffer_load_dwordx4 v20, s[8:11], s47 offen  lds
    s_add_u32 m0, s50, 30720
    s_mov_b32 s47, 2916352
    buffer_load_dwordx4 v20, s[8:11], s47 offen  lds
    s_add_u32 m0, s50, 31744
    s_mov_b32 s47, 2924544
    buffer_load_dwordx4 v20, s[8:11], s47 offen  lds
    ds_read_b64_tr_b16 a[144:145], v10 offset:16384
    ds_read_b64_tr_b16 a[146:147], v10 offset:17408
    ds_read_b64_tr_b16 a[148:149], v10 offset:18432
    ds_read_b64_tr_b16 a[150:151], v10 offset:19456
    ds_read_b64_tr_b16 a[152:153], v11 offset:16384
    ds_read_b64_tr_b16 a[154:155], v11 offset:17408
    ds_read_b64_tr_b16 a[156:157], v11 offset:18432
    ds_read_b64_tr_b16 a[158:159], v11 offset:19456
    s_waitcnt vmcnt(8) lgkmcnt(0)
    s_barrier
    s_mov_b32 s8, s24
    s_mov_b32 s9, s25
    s_mov_b32 s10, 4194304
    s_mov_b32 s11, 0x20000
    s_add_u32 m0, s50, 16384
    s_mov_b32 s47, 0
    buffer_load_dwordx4 v20, s[8:11], s47 offen  lds
    s_add_u32 m0, s50, 17408
    s_mov_b32 s47, 8192
    buffer_load_dwordx4 v20, s[8:11], s47 offen  lds
    s_add_u32 m0, s50, 18432
    s_mov_b32 s47, 2097152
    buffer_load_dwordx4 v20, s[8:11], s47 offen  lds
    s_add_u32 m0, s50, 19456
    s_mov_b32 s47, 2105344
    buffer_load_dwordx4 v20, s[8:11], s47 offen  lds
    ds_read_b64_tr_b16 a[160:161], v10 offset:20480
    ds_read_b64_tr_b16 a[162:163], v10 offset:21504
    ds_read_b64_tr_b16 a[164:165], v10 offset:22528
    ds_read_b64_tr_b16 a[166:167], v10 offset:23552
    ds_read_b64_tr_b16 a[168:169], v11 offset:20480
    ds_read_b64_tr_b16 a[170:171], v11 offset:21504
    ds_read_b64_tr_b16 a[172:173], v11 offset:22528
    ds_read_b64_tr_b16 a[174:175], v11 offset:23552
    s_waitcnt vmcnt(8) lgkmcnt(0)
    s_barrier
    v_lshlrev_b32 v56, 6, v0
    buffer_load_dword v57, v56, s[4:7], s57 offen sc1
    s_add_u32 m0, s50, 20480
    s_mov_b32 s47, 32768
    buffer_load_dwordx4 v20, s[8:11], s47 offen  lds
    s_add_u32 m0, s50, 21504
    s_mov_b32 s47, 40960
    buffer_load_dwordx4 v20, s[8:11], s47 offen  lds
    s_add_u32 m0, s50, 22528
    s_mov_b32 s47, 2129920
    buffer_load_dwordx4 v20, s[8:11], s47 offen  lds
    s_add_u32 m0, s50, 23552
    s_mov_b32 s47, 2138112
    buffer_load_dwordx4 v20, s[8:11], s47 offen  lds
    ds_read_b64_tr_b16 a[176:177], v10 offset:24576
    ds_read_b64_tr_b16 a[178:179], v10 offset:25600
    ds_read_b64_tr_b16 a[180:181], v10 offset:26624
    ds_read_b64_tr_b16 a[182:183], v10 offset:27648
    ds_read_b64_tr_b16 a[184:185], v11 offset:24576
    ds_read_b64_tr_b16 a[186:187], v11 offset:25600
    ds_read_b64_tr_b16 a[188:189], v11 offset:26624
    ds_read_b64_tr_b16 a[190:191], v11 offset:27648
    s_waitcnt vmcnt(8) lgkmcnt(0)
    s_barrier
    s_add_u32 m0, s50, 24576
    s_mov_b32 s47, 262144
    buffer_load_dwordx4 v20, s[8:11], s47 offen  lds
    s_add_u32 m0, s50, 25600
    s_mov_b32 s47, 270336
    buffer_load_dwordx4 v20, s[8:11], s47 offen  lds
    s_add_u32 m0, s50, 26624
    s_mov_b32 s47, 2359296
    buffer_load_dwordx4 v20, s[8:11], s47 offen  lds
    s_add_u32 m0, s50, 27648
    s_mov_b32 s47, 2367488
    buffer_load_dwordx4 v20, s[8:11], s47 offen  lds
    ds_read_b64_tr_b16 v[96:97], v10 offset:28672
    ds_read_b64_tr_b16 v[98:99], v10 offset:29696
    ds_read_b64_tr_b16 v[100:101], v10 offset:30720
    ds_read_b64_tr_b16 v[102:103], v10 offset:31744
    ds_read_b64_tr_b16 v[104:105], v11 offset:28672
    ds_read_b64_tr_b16 v[106:107], v11 offset:29696
    ds_read_b64_tr_b16 v[108:109], v11 offset:30720
    ds_read_b64_tr_b16 v[110:111], v11 offset:31744
    s_waitcnt vmcnt(8) lgkmcnt(0)
    s_barrier
    s_add_u32 m0, s50, 28672
    s_mov_b32 s47, 294912
    buffer_load_dwordx4 v20, s[8:11], s47 offen  lds
    s_add_u32 m0, s50, 29696
    s_mov_b32 s47, 303104
    buffer_load_dwordx4 v20, s[8:11], s47 offen  lds
    s_add_u32 m0, s50, 30720
    s_mov_b32 s47, 2392064
    buffer_load_dwordx4 v20, s[8:11], s47 offen  lds
    s_add_u32 m0, s50, 31744
    s_mov_b32 s47, 2400256
    buffer_load_dwordx4 v20, s[8:11], s47 offen  lds
    ds_read_b64_tr_b16 a[192:193], v10 offset:16384
    ds_read_b64_tr_b16 a[194:195], v10 offset:17408
    ds_read_b64_tr_b16 a[196:197], v10 offset:18432
    ds_read_b64_tr_b16 a[198:199], v10 offset:19456
    ds_read_b64_tr_b16 a[200:201], v11 offset:16384
    ds_read_b64_tr_b16 a[202:203], v11 offset:17408
    ds_read_b64_tr_b16 a[204:205], v11 offset:18432
    ds_read_b64_tr_b16 a[206:207], v11 offset:19456
    s_waitcnt vmcnt(8) lgkmcnt(0)
    s_barrier
L_c_cnt:
    v_cmp_gt_u32 vcc, 32, v60
    v_cmp_gt_u32 s[68:69], s49, v61
    s_add_u32 s3, s3, 1
    s_cmp_gt_u32 s3, 262144
    s_cbranch_scc1 L_c_cntok
    s_or_b64 vcc, vcc, s[68:69]
    s_cbranch_scc0 L_c_cntok
    global_load_dwordx2 v[60:61], v62, s[40:41] sc1
    s_waitcnt vmcnt(0)
    s_branch L_c_cnt
L_c_cntok:
    v_and_b32 v62, 1, v0
    v_lshlrev_b32 v62, 2, v62
    s_mov_b32 s56, 0
    buffer_load_dword v63, v62, s[4:7], s64 offen sc1
    s_add_u32 m0, s50, 16384
    s_mov_b32 s47, 524288
    buffer_load_dwordx4 v20, s[8:11], s47 offen  lds
    s_add_u32 m0, s50, 17408
    s_mov_b32 s47, 532480
    buffer_load_dwordx4 v20, s[8:11], s47 offen  lds
    s_add_u32 m0, s50, 18432
    s_mov_b32 s47, 2621440
    buffer_load_dwordx4 v20, s[8:11], s47 offen  lds
    s_add_u32 m0, s50, 19456
    s_mov_b32 s47, 2629632
    buffer_load_dwordx4 v20, s[8:11], s47 offen  lds
    ds_read_b64_tr_b16 v[40:41], v10 offset:20480
    ds_read_b64_tr_b16 v[42:43], v10 offset:21504
    ds_read_b64_tr_b16 v[44:45], v10 offset:22528
    ds_read_b64_tr_b16 v[46:47], v10 offset:23552
    ds_read_b64_tr_b16 v[48:49], v11 offset:20480
    ds_read_b64_tr_b16 v[50:51], v11 offset:21504
    ds_read_b64_tr_b16 v[52:53], v11 offset:22528
    ds_read_b64_tr_b16 v[54:55], v11 offset:23552
    s_waitcnt lgkmcnt(0)
    ds_write_b128 v2, v[40:43] offset:0
    ds_write_b128 v2, v[44:47] offset:1024
    ds_write_b128 v2, v[48:51] offset:2048
    ds_write_b128 v2, v[52:55] offset:3072
    s_waitcnt vmcnt(8) lgkmcnt(0)
    s_barrier
    s_add_u32 m0, s50, 20480
    s_mov_b32 s47, 557056
    buffer_load_dwordx4 v20, s[8:11], s47 offen  lds
    s_add_u32 m0, s50, 21504
    s_mov_b32 s47, 565248
    buffer_load_dwordx4 v20, s[8:11], s47 offen  lds
    s_add_u32 m0, s50, 22528
    s_mov_b32 s47, 2654208
    buffer_load_dwordx4 v20, s[8:11], s47 offen  lds
    s_add_u32 m0, s50, 23552
    s_mov_b32 s47, 2662400
    buffer_load_dwordx4 v20, s[8:11], s47 offen  lds
    ds_read_b64_tr_b16 a[208:209], v10 offset:24576
    ds_read_b64_tr_b16 a[210:211], v10 offset:25600
    ds_read_b64_tr_b16 a[212:213], v10 offset:26624
    ds_read_b64_tr_b16 a[214:215], v10 offset:27648
    ds_read_b64_tr_b16 a[216:217], v11 offset:24576
    ds_read_b64_tr_b16 a[218:219], v11 offset:25600
    ds_read_b64_tr_b16 a[220:221], v11 offset:26624
    ds_read_b64_tr_b16 a[222:223], v11 offset:27648
    s_waitcnt vmcnt(8) lgkmcnt(0)
    s_barrier
    s_add_u32 m0, s50, 24576
    s_mov_b32 s47, 786432
    buffer_load_dwordx4 v20, s[8:11], s47 offen  lds
    s_add_u32 m0, s50, 25600
    s_mov_b32 s47, 794624
    buffer_load_dwordx4 v20, s[8:11], s47 offen  lds
    s_add_u32 m0, s50, 26624
    s_mov_b32 s47, 2883584
    buffer_load_dwordx4 v20, s[8:11], s47 offen  lds
    s_add_u32 m0, s50, 27648
    s_mov_b32 s47, 2891776
    buffer_load_dwordx4 v20, s[8:11], s47 offen  lds
    ds_read_b64_tr_b16 a[224:225], v10 offset:28672
    ds_read_b64_tr_b16 a[226:227], v10 offset:29696
    ds_read_b64_tr_b16 a[228:229], v10 offset:30720
    ds_read_b64_tr_b16 a[230:231], v10 offset:31744
    ds_read_b64_tr_b16 a[232:233], v11 offset:28672
    ds_read_b64_tr_b16 a[234:235], v11 offset:29696
    ds_read_b64_tr_b16 a[236:237], v11 offset:30720
    ds_read_b64_tr_b16 a[238:239], v11 offset:31744
    s_waitcnt vmcnt(8) lgkmcnt(0)
    s_barrier
    s_add_u32 m0, s50, 28672
    s_mov_b32 s47, 819200
    buffer_load_dwordx4 v20, s[8:11], s47 offen  lds
    s_add_u32 m0, s50, 29696
    s_mov_b32 s47, 827392
    buffer_load_dwordx4 v20, s[8:11], s47 offen  lds
    s_add_u32 m0, s50, 30720
    s_mov_b32 s47, 2916352
    buffer_load_dwordx4 v20, s[8:11], s47 offen  lds
    s_add_u32 m0, s50, 31744
    s_mov_b32 s47, 2924544
    buffer_load_dwordx4 v20, s[8:11], s47 offen  lds
    ds_read_b64_tr_b16 a[240:241], v10 offset:16384
    ds_read_b64_tr_b16 a[242:243], v10 offset:17408
    ds_read_b64_tr_b16 a[244:245], v10 offset:18432
    ds_read_b64_tr_b16 a[246:247], v10 offset:19456
    ds_read_b64_tr_b16 a[248:249], v11 offset:16384
    ds_read_b64_tr_b16 a[250:251], v11 offset:17408
    ds_read_b64_tr_b16 a[252:253], v11 offset:18432
    ds_read_b64_tr_b16 a[254:255], v11 offset:19456
    s_waitcnt vmcnt(8) lgkmcnt(0)
    s_barrier
    ds_write_b128 v2, v[24:27] offset:16384
    ds_write_b128 v2, v[28:31] offset:17408
    ds_write_b128 v2, v[32:35] offset:18432
    ds_write_b128 v2, v[36:39] offset:19456
    v_cmp_ne_u32 vcc, 1, v63
    s_cbranch_vccnz L_c_notyet
    s_mov_b32 s56, 1
    s_lshl_b32 s47, s46, 11
    s_add_u32 s47, s47, s60
    s_add_u32 s48, s47, 8192
    buffer_load_dwordx4 v[144:147], v3, s[4:7], s47 offen offset:0 sc1
    buffer_load_dwordx4 v[12:15], v3, s[4:7], s48 offen offset:0 sc1
    buffer_load_dwordx4 v[148:151], v3, s[4:7], s47 offen offset:1024 sc1
    buffer_load_dwordx4 v[16:19], v3, s[4:7], s48 offen offset:1024 sc1
L_c_notyet:
    ds_read_b64_tr_b16 v[152:153], v10 offset:20480
    ds_read_b64_tr_b16 v[154:155], v10 offset:21504
    ds_read_b64_tr_b16 v[156:157], v10 offset:22528
    ds_read_b64_tr_b16 v[158:159], v10 offset:23552
    ds_read_b64_tr_b16 v[160:161], v11 offset:20480
    ds_read_b64_tr_b16 v[162:163], v11 offset:21504
    ds_read_b64_tr_b16 v[164:165], v11 offset:22528
    ds_read_b64_tr_b16 v[166:167], v11 offset:23552
    s_waitcnt vmcnt(4) lgkmcnt(0)
    s_barrier
    ds_write_b128 v2, v[96:99] offset:20480
    ds_write_b128 v2, v[100:103] offset:21504
    ds_write_b128 v2, v[104:107] offset:22528
    ds_write_b128 v2, v[108:111] offset:23552
    buffer_load_dword v63, v62, s[4:7], s64 offen sc1
    v_and_b32 v56, 63, v0
    v_lshrrev_b32 v57, 4, v56
    v_and_b32 v58, 15, v56
    v_mov_b32 v1, 0x44444444
    v_mov_b32 v59, 0x4e1eeeee
    v_cndmask_b32 v1, v1, v59, s[66:67]
    s_lshl_b32 s47, s46, 10
    s_add_u32 s47, s47, 155648
    v_lshrrev_b32 v59, 2, v58
    v_lshlrev_b32 v6, 7, v59
    v_lshl_add_u32 v6, v57, 5, v6
    v_and_b32 v59, 1, v59
    v_lshlrev_b32 v59, 6, v59
    v_xor_b32 v6, v6, v59
    v_and_b32 v59, 3, v58
    v_lshl_add_u32 v6, v59, 2, v6
    v_add_u32 v6, s47, v6
    v_lshlrev_b32 v7, 7, v57
    v_add_u32 v7, 155648, v7
    v_and_b32 v59, 1, v58
    v_lshl_add_u32 v7, v59, 4, v7
    v_add_u32 v8, 512, v7
    v_lshrrev_b32 v59, 2, v58
    v_lshl_add_u32 v7, v59, 5, v7
    v_lshrrev_b32 v59, 3, v58
    v_lshl_add_u32 v8, v59, 5, v8
    v_lshrrev_b32 v59, 1, v58
    v_xor_b32 v59, v59, v58
    v_and_b32 v59, 2, v59
    v_lshl_add_u32 v8, v59, 5, v8
    v_and_b32 v59, 1, v57
    v_lshlrev_b32 v59, 6, v59
    v_xor_b32 v7, v7, v59
    v_xor_b32 v8, v8, v59
    s_lshl_b32 s47, s46, 9
    s_add_u32 s47, s47, 159744
    v_lshrrev_b32 v59, 3, v58
    v_lshlrev_b32 v9, 8, v59
    v_lshl_add_u32 v9, v57, 6, v9
    v_bfe_u32 v59, v58, 2, 1
    v_lshl_add_u32 v9, v59, 5, v9
    v_and_b32 v59, 3, v58
    v_lshl_add_u32 v9, v59, 2, v9
    v_add_u32 v9, s47, v9
    s_mov_b32 s70, 0x3f803f80
    s_mov_b32 s71, 0x3f803f80
    v_mov_b64 v[20:21], 0
    v_mov_b64 v[22:23], 0
    v_mov_b64 v[24:25], 0
    v_mov_b64 v[26:27], 0
    v_mov_b64 v[28:29], 0
    v_mov_b64 v[30:31], 0
    v_mov_b64 v[32:33], 0
    v_mov_b64 v[34:35], 0
    v_mov_b64 v[36:37], 0
    v_mov_b64 v[38:39], 0
    v_mov_b64 v[40:41], 0
    v_mov_b64 v[42:43], 0
    v_mov_b64 v[44:45], 0
    v_mov_b64 v[46:47], 0
    v_mov_b64 v[48:49], 0
    v_mov_b64 v[50:51], 0
    v_mov_b64 v[52:53], 0
    v_mov_b64 v[54:55], 0
    v_lshrrev_b32 v59, 3, v56
    v_lshlrev_b32 v31, 8, v59
    v_and_b32 v59, 7, v56
    v_lshl_add_u32 v31, v59, 4, v31
    ds_read_b64_tr_b16 v[168:169], v10 offset:24576
    ds_read_b64_tr_b16 v[170:171], v10 offset:25600
    ds_read_b64_tr_b16 v[172:173], v10 offset:26624
    ds_read_b64_tr_b16 v[174:175], v10 offset:27648
    ds_read_b64_tr_b16 v[176:177], v11 offset:24576
    ds_read_b64_tr_b16 v[178:179], v11 offset:25600
    ds_read_b64_tr_b16 v[180:181], v11 offset:26624
    ds_read_b64_tr_b16 v[182:183], v11 offset:27648
    s_waitcnt vmcnt(0) lgkmcnt(0)
    s_barrier
    ds_write_b128 v2, v[128:131] offset:24576
    ds_write_b128 v2, v[132:135] offset:25600
    ds_write_b128 v2, v[136:139] offset:26624
    ds_write_b128 v2, v[140:143] offset:27648
    s_cmp_eq_u32 s56, 1
    s_cbranch_scc1 L_c_kvok
L_c_fl:
    v_cmp_ne_u32 vcc, 1, v63
    s_add_u32 s3, s3, 1
    s_cmp_gt_u32 s3, 262144
    s_cbranch_scc1 L_c_flok
    s_cbranch_vccz L_c_flok
    buffer_load_dword v63, v62, s[4:7], s64 offen sc1
    s_waitcnt vmcnt(0)
    s_branch L_c_fl
L_c_flok:
    s_lshl_b32 s47, s46, 11
    s_add_u32 s47, s47, s60
    s_add_u32 s48, s47, 8192
    buffer_load_dwordx4 v[144:147], v3, s[4:7], s47 offen offset:0 sc1
    buffer_load_dwordx4 v[12:15], v3, s[4:7], s48 offen offset:0 sc1
    buffer_load_dwordx4 v[148:151], v3, s[4:7], s47 offen offset:1024 sc1
    buffer_load_dwordx4 v[16:19], v3, s[4:7], s48 offen offset:1024 sc1
L_c_kvok:
    ds_read_b64_tr_b16 v[112:113], v10 offset:28672
    ds_read_b64_tr_b16 v[114:115], v10 offset:29696
    ds_read_b64_tr_b16 v[116:117], v10 offset:30720
    ds_read_b64_tr_b16 v[118:119], v10 offset:31744
    ds_read_b64_tr_b16 v[120:121], v11 offset:28672
    ds_read_b64_tr_b16 v[122:123], v11 offset:29696
    ds_read_b64_tr_b16 v[124:125], v11 offset:30720
    ds_read_b64_tr_b16 v[126:127], v11 offset:31744
    s_waitcnt lgkmcnt(0)
    s_barrier
    ds_write_b128 v2, v[112:115] offset:28672
    ds_write_b128 v2, v[116:119] offset:29696
    ds_write_b128 v2, v[120:123] offset:30720
    ds_write_b128 v2, v[124:127] offset:31744
    s_cmp_eq_u32 s46, 1
    s_cbranch_scc1 L_c_w1
    s_cmp_eq_u32 s46, 2
    s_cbranch_scc1 L_c_w2
    s_cmp_eq_u32 s46, 3
    s_cbranch_scc1 L_c_w3
L_c_w0:
    v_lshlrev_b32 v11, 2, v0
    v_mov_b64 v[56:57], 0
    v_mov_b64 v[58:59], 0
    v_mov_b64 v[60:61], 0
    v_mov_b64 v[62:63], 0
    s_waitcnt vmcnt(0)
    ds_write_b128 v3, v[144:147] offset:6144
    ds_write_b128 v3, v[148:151] offset:7168
    v_mov_b64 v[24:25], v[12:13]
    v_mov_b64 v[28:29], v[14:15]
    v_mov_b64 v[32:33], v[16:17]
    v_mov_b64 v[36:37], v[18:19]
    s_waitcnt lgkmcnt(0)
    s_barrier
    ds_read_b128 v[96:99], v3 offset:6144
    ds_read_b128 v[100:103], v3 offset:7168
    ds_read_b128 v[104:107], v3 offset:4096
    ds_read_b128 v[108:111], v3 offset:5120
    ds_read_b128 v[112:115], v3 offset:0
    ds_read_b128 v[116:119], v3 offset:1024
    ds_read_b128 v[120:123], v3 offset:2048
    ds_read_b128 v[124:127], v3 offset:3072
    ds_read_b128 v[128:131], v2 offset:24576
    ds_read_b128 v[132:135], v2 offset:25600
    ds_read_b128 v[136:139], v2 offset:26624
    ds_read_b128 v[140:143], v2 offset:27648
    s_add_u32 s60, s60, 524288
    s_add_u32 s100, s60, 0
    s_add_u32 s101, s60, 8192
    s_waitcnt lgkmcnt(0)
    s_branch L_c0_top
L_c0_pad0:
    s_branch L_c0_pad1
.p2align 5
L_c0_top:
    s_barrier
L_c0_again:
    buffer_load_dwordx4 v[64:67], v31, s[4:7], s57 offen offset:0 sc1
    s_mov_b32 m0, 159744
    s_nop 15
    s_nop 1
    buffer_load_dwordx4 v[68:71], v31, s[4:7], s57 offen offset:2048 sc1
    s_nop 15
    s_nop 1
    buffer_load_dwordx4 v[72:75], v31, s[4:7], s57 offen offset:128 sc1
    s_nop 15
    s_nop 1
    buffer_load_dwordx4 v[76:79], v31, s[4:7], s57 offen offset:2176 sc1
    buffer_load_dwordx4 v31, s[4:7], s58 offen offset:0 sc1 lds
L_c0_c0:
    s_waitcnt vmcnt(4) lgkmcnt(0)
    v_cmp_eq_u32_e64 vcc, s12, v64
    v_smfmac_f32_16x16x64_bf16 v[40:43], v[64:67], v[128:135], v1
    v_smfmac_f32_16x16x64_bf16 v[44:47], v[64:67], v[136:143], v1
    s_cbranch_vccnz L_c0_no0
L_c0_go0:
    v_smfmac_f32_16x16x64_bf16 v[56:59], v[64:67], a[192:199], v1
    ds_read_b128 v[128:131], v2 offset:0
    v_smfmac_f32_16x16x64_bf16 v[60:63], v[64:67], a[200:207], v1
    ds_read_b128 v[132:135], v2 offset:1024
    v_smfmac_f32_16x16x64_bf16 v[52:55], v[64:67], a[104:111], v1
    ds_read_b128 v[136:139], v2 offset:2048
    v_smfmac_f32_16x16x64_bf16 v[48:51], v[64:67], a[96:103], v1
    s_waitcnt vmcnt(3)
    ds_read_b128 v[140:143], v2 offset:3072
    v_smfmac_f32_16x16x64_bf16 v[48:51], v[68:71], a[112:119], v1
    s_barrier
    v_smfmac_f32_16x16x64_bf16 v[40:43], v[68:71], a[0:7], v1
    buffer_load_dwordx4 v[144:147], v3, s[4:7], s100 offen offset:0 sc1
    v_smfmac_f32_16x16x64_bf16 v[44:47], v[68:71], a[8:15], v1
    v_smfmac_f32_16x16x64_bf16 v[52:55], v[68:71], a[120:127], v1
    s_waitcnt lgkmcnt(0)
    v_smfmac_f32_16x16x64_bf16 v[56:59], v[68:71], v[128:135], v1
    ds_read_b128 v[128:131], v2 offset:4096
    v_smfmac_f32_16x16x64_bf16 v[60:63], v[68:71], v[136:143], v1
    s_waitcnt vmcnt(3)
    ds_read_b128 v[132:135], v2 offset:5120
    buffer_load_dwordx4 v[148:151], v3, s[4:7], s100 offen offset:1024 sc1
    v_smfmac_f32_16x16x64_bf16 v[60:63], v[72:75], a[216:223], v1
    ds_read_b128 v[136:139], v2 offset:6144
    v_smfmac_f32_16x16x64_bf16 v[56:59], v[72:75], a[208:215], v1
    ds_read_b128 v[140:143], v2 offset:7168
    v_smfmac_f32_16x16x64_bf16 v[52:55], v[72:75], a[136:143], v1
    v_smfmac_f32_16x16x64_bf16 v[40:43], v[72:75], a[16:23], v1
    buffer_load_dwordx4 v[12:15], v3, s[4:7], s101 offen offset:0 sc1
    v_smfmac_f32_16x16x64_bf16 v[44:47], v[72:75], a[24:31], v1
    v_smfmac_f32_16x16x64_bf16 v[48:51], v[72:75], a[128:135], v1
    s_waitcnt lgkmcnt(0)
    s_waitcnt vmcnt(4)
    v_smfmac_f32_16x16x64_bf16 v[48:51], v[76:79], v[128:135], v1
    s_waitcnt vmcnt(3)
    s_barrier
    v_smfmac_f32_16x16x64_bf16 v[56:59], v[76:79], a[224:231], v1
    ds_read_b128 v[80:83], v3 offset:4096
    v_smfmac_f32_16x16x64_bf16 v[60:63], v[76:79], a[232:239], v1
    ds_read_b128 v[84:87], v3 offset:5120
    v_smfmac_f32_16x16x64_bf16 v[52:55], v[76:79], v[136:143], v1
    ds_read_b128 v[128:131], v2 offset:8192
    buffer_load_dwordx4 v[16:19], v3, s[4:7], s101 offen offset:1024 sc1
    v_smfmac_f32_16x16x64_bf16 v[44:47], v[76:79], a[40:47], v1
    ds_read_b128 v[88:91], v3 offset:6144
    v_smfmac_f32_16x16x64_bf16 v[40:43], v[76:79], a[32:39], v1
    s_waitcnt lgkmcnt(3)
    ds_read_b128 v[92:95], v3 offset:7168
L_c0_j20:
    v_smfmac_f32_16x16x64_bf16 v[40:43], v[80:83], a[48:55], v1
    s_waitcnt lgkmcnt(3)
    ds_read_b128 v[132:135], v2 offset:9216
    v_smfmac_f32_16x16x64_bf16 v[40:43], v[84:87], a[64:71], v1
    ds_read_b128 v[136:139], v2 offset:10240
    v_smfmac_f32_16x16x64_bf16 v[44:47], v[80:83], a[56:63], v1
    ds_read_b128 v[140:143], v2 offset:11264
    v_smfmac_f32_16x16x64_bf16 v[44:47], v[84:87], a[72:79], v1
    s_waitcnt lgkmcnt(3)
    v_smfmac_f32_16x16x64_bf16 v[40:43], v[88:91], a[80:87], v1
    s_waitcnt lgkmcnt(2)
    buffer_load_dword v10, v11, s[4:7], s64 offen sc1
    v_smfmac_f32_16x16x64_bf16 v[40:43], v[92:95], v[128:135], v1
    ds_read_b128 v[128:131], v2 offset:20480
    v_smfmac_f32_16x16x64_bf16 v[44:47], v[88:91], a[88:95], v1
    s_waitcnt lgkmcnt(1)
    ds_read_b128 v[132:135], v2 offset:21504
    v_smfmac_f32_16x16x64_bf16 v[44:47], v[92:95], v[136:143], v1
    ds_read_b128 v[136:139], v2 offset:22528
    v_add_f32_e64 v40, v40, v42
    v_smfmac_f32_16x16x64_bf16 v[48:51], v[80:83], a[144:151], v1
    ds_read_b128 v[140:143], v2 offset:23552
    v_add_f32 v41, v41, v43
    v_smfmac_f32_16x16x64_bf16 v[48:51], v[84:87], a[160:167], v1
    v_add_f32 v44, v44, v46
    v_add_f32_e64 v45, v45, v47
    v_smfmac_f32_16x16x64_bf16 v[48:51], v[88:91], a[176:183], v1
    s_waitcnt lgkmcnt(2)
    v_cvt_pk_bf16_f32 v42, v40, v44
    v_smfmac_f32_16x16x64_bf16 v[48:51], v[92:95], v[128:135], v1
    ds_write_b32 v6, v42
    v_cvt_pk_bf16_f32 v43, v41, v45
    v_smfmac_f32_16x16x64_bf16 v[52:55], v[80:83], a[152:159], v1
    ds_write_b32 v6, v43 offset:16
    v_cmp_u_f32 vcc, v40, v41
    v_smfmac_f32_16x16x64_bf16 v[52:55], v[84:87], a[168:175], v1
    ds_read_b128 v[128:131], v2 offset:28672
    v_add_f32 v48, v48, v50
    v_smfmac_f32_16x16x64_bf16 v[52:55], v[88:91], a[184:191], v1
    s_waitcnt lgkmcnt(3)
    ds_read_b128 v[132:135], v2 offset:29696
    v_add_f32 v49, v49, v51
    v_smfmac_f32_16x16x64_bf16 v[52:55], v[92:95], v[136:143], v1
    s_cbranch_vccnz L_c0_nan
L_c0_nanok:
    ds_read_b128 v[136:139], v2 offset:30720
    v_smfmac_f32_16x16x64_bf16 v[56:59], v[80:83], a[240:247], v1
    s_waitcnt lgkmcnt(3)
    s_barrier
    v_smfmac_f32_16x16x64_bf16 v[56:59], v[84:87], v[152:159], v1
    ds_read_b128 v[64:67], v7 offset:0
    v_add_f32 v52, v52, v54
    v_smfmac_f32_16x16x64_bf16 v[56:59], v[88:91], v[168:175], v1
    s_waitcnt lgkmcnt(2)
    ds_read_b128 v[140:143], v2 offset:31744
    v_add_f32_e64 v53, v53, v55
    v_smfmac_f32_16x16x64_bf16 v[56:59], v[92:95], v[128:135], v1
    ds_read_b128 v[68:71], v7 offset:1024
    v_cvt_pk_bf16_f32 v52, v48, v52
    v_smfmac_f32_16x16x64_bf16 v[60:63], v[80:83], a[248:255], v1
    ds_write_b32 v6, v52 offset:512
    v_cvt_pk_bf16_f32 v53, v49, v53
    v_smfmac_f32_16x16x64_bf16 v[60:63], v[84:87], v[160:167], v1
    ds_write_b32 v6, v53 offset:528
    v_add_f32 v56, v56, v58
    v_smfmac_f32_16x16x64_bf16 v[60:63], v[88:91], v[176:183], v1
    s_waitcnt lgkmcnt(3)
    ds_read_b128 v[72:75], v7 offset:2048
    v_add_f32_e64 v57, v57, v59
    v_smfmac_f32_16x16x64_bf16 v[60:63], v[92:95], v[136:143], v1
    s_waitcnt lgkmcnt(3)
    ds_read_b128 v[76:79], v7 offset:3072
    v_cvt_pk_bf16_f32 v26, v56, v57
    v_mfma_f32_16x16x32_bf16 v[40:43], v[96:99], v[64:67], 0
    s_cmp_eq_u32 s51, 63
    v_cvt_pk_bf16_f32 v54, v56, v57
    v_mfma_f32_16x16x32_bf16 v[40:43], v[100:103], v[68:71], v[40:43]
    s_waitcnt lgkmcnt(1)
    s_barrier
    v_mfma_f32_16x16x32_bf16 v[40:43], v[104:107], v[72:75], v[40:43]
    s_waitcnt lgkmcnt(0)
    ds_read_b128 v[80:83], v8 offset:0
    v_add_f32 v60, v60, v62
    v_mfma_f32_16x16x32_bf16 v[40:43], v[108:111], v[76:79], v[40:43]
    ds_read_b128 v[84:87], v8 offset:1024
    v_add_f32_e64 v61, v61, v63
    v_mfma_f32_16x16x32_bf16 v[44:47], v[112:115], v[64:67], 0
    ds_read_b128 v[88:91], v8 offset:2048
    v_cvt_pk_bf16_f32 v34, v60, v61
    v_mfma_f32_16x16x32_bf16 v[44:47], v[116:119], v[68:71], v[44:47]
    ds_read_b128 v[92:95], v8 offset:3072
    v_cvt_pk_bf16_f32 v55, v60, v61
    v_mfma_f32_16x16x32_bf16 v[44:47], v[120:123], v[72:75], v[44:47]
    v_permlane16_swap_b32 v26, v30
    v_mfma_f32_16x16x32_bf16 v[44:47], v[124:127], v[76:79], v[44:47]
    s_waitcnt lgkmcnt(2)
    v_permlane16_swap_b32_e64 v34, v38
    v_mfma_f32_16x16x32_bf16 v[48:51], v[80:83], v[64:67], 0
    s_cbranch_scc1 L_c0_done
    v_mov_b64 v[56:57], 0
    v_mov_b64 v[58:59], 0
    v_mfma_f32_16x16x32_bf16 v[48:51], v[84:87], v[68:71], v[48:51]
    s_waitcnt lgkmcnt(0)
    v_cndmask_b32 v40, v40, v44, s[66:67]
    v_cndmask_b32 v41, v41, v45, s[66:67]
    v_mfma_f32_16x16x32_bf16 v[48:51], v[88:91], v[72:75], v[48:51]
    v_cndmask_b32 v42, v42, v46, s[66:67]
    v_cndmask_b32 v43, v43, v47, s[66:67]
    v_mfma_f32_16x16x32_bf16 v[48:51], v[92:95], v[76:79], v[48:51]
    v_max3_f32 v44, v40, v41, v42
    v_max_f32 v44, v44, v43
    v_mov_b64 v[60:61], 0
    v_mov_b64 v[62:63], 0
    v_max_f32_dpp v44, v44, v44 quad_perm:[2,3,0,1] row_mask:0xf bank_mask:0xf
    v_mov_b32 v45, v44
    v_mov_b64 v[96:97], s[70:71]
    v_max3_f32 v46, v48, v49, v50
    v_permlane16_swap_b32 v44, v45
    v_max3_f32 v44, v44, v45, v51
    v_max_f32 v45, v44, v46
    v_max_f32 v44, v44, v46
    v_cndmask_b32 v48, v48, v49, s[66:67]
    v_mov_b64 v[98:99], s[70:71]
    v_permlane32_swap_b32 v44, v45
    v_max_f32 v44, v44, v45
    v_mul_f32 v44, s63, v44
    v_pk_fma_f32 v[40:41], v[40:41], s[62:63], v[44:45] op_sel_hi:[1,1,0] neg_lo:[0,0,1] neg_hi:[0,0,1]
    v_pk_fma_f32 v[42:43], v[42:43], s[62:63], v[44:45] op_sel_hi:[1,1,0] neg_lo:[0,0,1] neg_hi:[0,0,1]
    v_fma_f32 v48, v48, s63, -v44
    v_exp_f32 v40, v40
    v_exp_f32 v41, v41
    v_exp_f32 v42, v42
    v_cvt_pk_bf16_f32 v20, v40, v41
    v_exp_f32 v43, v43
    v_exp_f32_e64 v48, v48
    v_cvt_pk_bf16_f32 v22, v42, v43
    v_cvt_pk_bf16_f32 v21, v48, v23
    s_nop 1
    v_mfma_f32_16x16x32_bf16 v[44:47], v[20:23], v[96:99], 0
    v_smfmac_f32_16x16x64_bf16 v[56:59], v[20:23], v[24:31], v1 abid:1
    ds_read_b128 v[128:131], v2 offset:12288
    v_smfmac_f32_16x16x64_bf16 v[60:63], v[20:23], v[32:39], v1 abid:1
    ds_read_b128 v[132:135], v2 offset:13312
    v_add_f32 v44, v44, v46
    v_add_f32 v45, v45, v47
    v_rcp_f32 v44, v44
    v_rcp_f32_e64 v45, v45
    v_pk_add_f32 v[56:57], v[56:57], v[58:59]
    v_pk_mul_f32 v[56:57], v[56:57], v[44:45]
    v_pk_add_f32 v[60:61], v[60:61], v[62:63]
    v_pk_mul_f32 v[60:61], v[60:61], v[44:45]
    v_cvt_pk_bf16_f32 v58, v56, v60
    v_cvt_pk_bf16_f32 v59, v57, v61
    v_mfma_f32_4x4x1_16b_f32 v[80:83], v23, v23, 0
    ds_write2_b32 v9, v58, v59 offset0:0 offset1:4
    v_mfma_f32_16x16x1_4b_f32 v[64:79], v23, v23, 0
    s_and_b32 s56, s51, 1
    s_add_u32 s51, s51, 1
    s_lshl_b32 s47, s56, 13
    s_sub_u32 s57, 3153920, s47
    s_add_u32 s58, s57, 4096
    buffer_store_dwordx4 v[52:55], v3, s[4:7], s61 offen nt
    s_waitcnt lgkmcnt(0)
    s_barrier
    ds_read_b128 v[40:43], v3 offset:4096
    v_mfma_f32_4x4x1_16b_f32 v[84:87], v23, v23, 0
    ds_read_b128 v[44:47], v3 offset:5120
    v_mfma_f32_4x4x1_16b_f32 v[88:91], v23, v23, 0
    v_mfma_f32_4x4x1_16b_f32 v[92:95], v23, v23, 0
    ds_read_b128 v[136:139], v2 offset:14336
    s_waitcnt lgkmcnt(2)
    v_smfmac_f32_16x16x64_bf16 v[64:67], v[40:43], v[184:191], v1
    ds_read_b128 v[140:143], v2 offset:15360
    v_smfmac_f32_16x16x64_bf16 v[68:71], v[40:43], v[200:207], v1
    s_waitcnt lgkmcnt(2)
    ds_read_b128 v[104:107], v2 offset:32768
    v_smfmac_f32_16x16x64_bf16 v[64:67], v[44:47], v[192:199], v1
    ds_read_b128 v[108:111], v2 offset:33792
    v_smfmac_f32_16x16x64_bf16 v[68:71], v[44:47], v[208:215], v1
    ds_read_b128 v[112:115], v2 offset:34816
    ds_read_b128 v[116:119], v2 offset:35840
    v_smfmac_f32_16x16x64_bf16 v[72:75], v[40:43], v[216:223], v1
    ds_read_b128 v[120:123], v2 offset:16384
    v_add_f32 v64, v64, v66
    v_add_f32_e64 v65, v65, v67
    v_smfmac_f32_16x16x64_bf16 v[72:75], v[44:47], v[224:231], v1
    ds_read_b128 v[124:127], v2 offset:17408
    v_add_f32 v68, v68, v70
    v_add_f32 v69, v69, v71
    v_smfmac_f32_16x16x64_bf16 v[76:79], v[40:43], v[232:239], v1
    ds_read_b128 v[96:99], v2 offset:18432
    v_cvt_pk_bf16_f32 v48, v64, v68
    v_cvt_pk_bf16_f32 v49, v65, v69
    v_bfi_b32 v48, 1, s56, v48
    v_smfmac_f32_16x16x64_bf16 v[76:79], v[44:47], v[240:247], v1
    buffer_store_dwordx2 v[48:49], v4, s[4:7], s52 offen offset:0
    v_add_f32 v72, v72, v74
    v_smfmac_f32_16x16x64_bf16 v[80:83], v[40:43], v[248:255], v1
    s_waitcnt lgkmcnt(5)
    ds_read_b128 v[100:103], v2 offset:19456
    v_add_f32 v73, v73, v75
    v_smfmac_f32_16x16x64_bf16 v[80:83], v[44:47], v[128:135], v1
    ds_read_b128 v[128:131], v2 offset:36864
    v_add_f32 v76, v76, v78
    v_add_f32_e64 v77, v77, v79
    v_smfmac_f32_16x16x64_bf16 v[84:87], v[40:43], v[136:143], v1
    ds_read_b128 v[132:135], v2 offset:37888
    v_cvt_pk_bf16_f32 v50, v72, v76
    v_cvt_pk_bf16_f32 v51, v73, v77
    v_bfi_b32 v50, 1, s56, v50
    v_smfmac_f32_16x16x64_bf16 v[84:87], v[44:47], v[104:111], v1
    s_waitcnt lgkmcnt(4)
    buffer_store_dwordx2 v[50:51], v4, s[4:7], s52 offen offset:64
    v_add_f32 v80, v80, v82
    v_smfmac_f32_16x16x64_bf16 v[88:91], v[40:43], v[112:119], v1
    v_add_f32 v81, v81, v83
    v_smfmac_f32_16x16x64_bf16 v[88:91], v[44:47], v[120:127], v1
    s_waitcnt lgkmcnt(2)
    v_add_f32 v84, v84, v86
    v_add_f32_e64 v85, v85, v87
    v_smfmac_f32_16x16x64_bf16 v[92:95], v[40:43], v[96:103], v1
    s_waitcnt lgkmcnt(0)
    v_cvt_pk_bf16_f32 v56, v80, v84
    v_cvt_pk_bf16_f32 v57, v81, v85
    v_bfi_b32 v56, 1, s56, v56
    v_smfmac_f32_16x16x64_bf16 v[92:95], v[44:47], v[128:135], v1
    buffer_store_dwordx2 v[56:57], v4, s[4:7], s53 offen offset:0
    v_add_f32 v88, v88, v90
    v_add_f32 v89, v89, v91
    s_nop 3
    v_add_f32 v92, v92, v94
    v_add_f32_e64 v93, v93, v95
    v_cvt_pk_bf16_f32 v58, v88, v92
    v_cvt_pk_bf16_f32 v59, v89, v93
    v_bfi_b32 v58, 1, s56, v58
    buffer_store_dwordx2 v[58:59], v4, s[4:7], s53 offen offset:64
    s_waitcnt vmcnt(4)
    s_barrier
    ds_write_b128 v3, v[144:147] offset:6144
    ds_write_b128 v3, v[148:151] offset:7168
    s_waitcnt lgkmcnt(0)
    s_barrier
    s_nop 15
    s_add_u32 s60, s60, 524288
    s_cmp_eq_u32 s51, 63
    s_cselect_b32 s60, 0x40000000, s60
    s_add_u32 s100, s60, 0
    s_add_u32 s101, s60, 8192
    s_add_u32 s61, s61, 131072
    ds_read_b128 v[128:131], v2 offset:24576
    ds_read_b128 v[132:135], v2 offset:25600
    ds_read_b128 v[136:139], v2 offset:26624
    ds_read_b128 v[140:143], v2 offset:27648
    v_mfma_f32_4x4x1_16b_f32 v[40:43], v23, v23, 0
    v_mfma_f32_4x4x1_16b_f32 v[44:47], v23, v23, 0
    v_mfma_f32_4x4x1_16b_f32 v[48:51], v23, v23, 0
    v_mov_b64 v[24:25], v[12:13]
    v_mov_b64 v[28:29], v[14:15]
    v_mov_b64 v[32:33], v[16:17]
    v_mov_b64 v[36:37], v[18:19]
    v_mfma_f32_4x4x1_16b_f32 v[52:55], v23, v23, 0
    v_mfma_f32_4x4x1_16b_f32 v[56:59], v23, v23, 0
    ds_read_b128 v[96:99], v3 offset:6144
    ds_read_b128 v[100:103], v3 offset:7168
    ds_read_b128 v[104:107], v3 offset:4096
    ds_read_b128 v[108:111], v3 offset:5120
    ds_read_b128 v[112:115], v3 offset:0
    ds_read_b128 v[116:119], v3 offset:1024
    ds_read_b128 v[120:123], v3 offset:2048
    ds_read_b128 v[124:127], v3 offset:3072
    v_mfma_f32_4x4x1_16b_f32 v[60:63], v23, v23, 0
    v_cmp_eq_u32 s[68:69], 1, v10
    s_add_u32 s49, s51, 1
    s_nop 3
    s_bitcmp1_b64 s[68:69], s49
    s_cbranch_scc0 L_c0_flag
L_c0_flagok:
    s_waitcnt lgkmcnt(0)
    s_branch L_c0_top
L_c0_pad1:
    s_branch L_c0_pad2
L_c0_pad2:
    s_branch L_c0_pad3
.p2align 5
L_c0_no0:
    buffer_load_dwordx4 v[64:67], v31, s[4:7], s57 offen offset:0 sc1
    s_nop 0
    ds_read_b128 v[128:131], v2 offset:0
    ds_read_b128 v[132:135], v2 offset:1024
    ds_read_b128 v[136:139], v2 offset:2048
    ds_read_b128 v[140:143], v2 offset:3072
    v_mfma_f32_4x4x1_16b_f32 v[40:43], v23, v23, 0
    v_mfma_f32_4x4x1_16b_f32 v[44:47], v23, v23, 0
    s_nop 0
L_c0_c1:
    s_waitcnt vmcnt(4)
    v_cmp_eq_u32_e64 vcc, s12, v68
    v_smfmac_f32_16x16x64_bf16 v[40:43], v[68:71], a[0:7], v1
    v_smfmac_f32_16x16x64_bf16 v[44:47], v[68:71], a[8:15], v1
    s_cbranch_vccnz L_c0_no1
L_c0_go1:
    buffer_load_dwordx4 v31, s[4:7], s58 offen offset:0 sc1 lds
    v_smfmac_f32_16x16x64_bf16 v[48:51], v[68:71], a[112:119], v1
    v_smfmac_f32_16x16x64_bf16 v[52:55], v[68:71], a[120:127], v1
    s_waitcnt lgkmcnt(0)
    v_smfmac_f32_16x16x64_bf16 v[56:59], v[68:71], v[128:135], v1
    ds_read_b128 v[128:131], v2 offset:4096
    v_smfmac_f32_16x16x64_bf16 v[60:63], v[68:71], v[136:143], v1
    s_waitcnt vmcnt(4)
    ds_read_b128 v[132:135], v2 offset:5120
    v_smfmac_f32_16x16x64_bf16 v[40:43], v[72:75], a[16:23], v1
    ds_read_b128 v[136:139], v2 offset:6144
    s_barrier
    v_smfmac_f32_16x16x64_bf16 v[44:47], v[72:75], a[24:31], v1
    ds_read_b128 v[140:143], v2 offset:7168
    buffer_load_dwordx4 v[144:147], v3, s[4:7], s100 offen offset:0 sc1
    v_smfmac_f32_16x16x64_bf16 v[48:51], v[72:75], a[128:135], v1
    v_smfmac_f32_16x16x64_bf16 v[52:55], v[72:75], a[136:143], v1
    v_smfmac_f32_16x16x64_bf16 v[56:59], v[72:75], a[208:215], v1
    v_smfmac_f32_16x16x64_bf16 v[60:63], v[72:75], a[216:223], v1
    s_waitcnt vmcnt(4) lgkmcnt(2)
    buffer_load_dwordx4 v[148:151], v3, s[4:7], s100 offen offset:1024 sc1
    v_smfmac_f32_16x16x64_bf16 v[48:51], v[76:79], v[128:135], v1
    s_waitcnt lgkmcnt(0)
    ds_read_b128 v[128:131], v2 offset:24576
    v_smfmac_f32_16x16x64_bf16 v[52:55], v[76:79], v[136:143], v1
    ds_read_b128 v[132:135], v2 offset:25600
    v_smfmac_f32_16x16x64_bf16 v[40:43], v[76:79], a[32:39], v1
    ds_read_b128 v[136:139], v2 offset:26624
    v_smfmac_f32_16x16x64_bf16 v[44:47], v[76:79], a[40:47], v1
    ds_read_b128 v[140:143], v2 offset:27648
    buffer_load_dwordx4 v[12:15], v3, s[4:7], s101 offen offset:0 sc1
    v_smfmac_f32_16x16x64_bf16 v[56:59], v[76:79], a[224:231], v1
    v_smfmac_f32_16x16x64_bf16 v[60:63], v[76:79], a[232:239], v1
    s_waitcnt vmcnt(4)
    v_smfmac_f32_16x16x64_bf16 v[48:51], v[64:67], a[96:103], v1
    s_waitcnt vmcnt(3)
    s_barrier
    v_smfmac_f32_16x16x64_bf16 v[52:55], v[64:67], a[104:111], v1
    s_waitcnt lgkmcnt(2)
    ds_read_b128 v[80:83], v3 offset:4096
    v_smfmac_f32_16x16x64_bf16 v[40:43], v[64:67], v[128:135], v1
    s_waitcnt lgkmcnt(1)
    ds_read_b128 v[84:87], v3 offset:5120
    v_smfmac_f32_16x16x64_bf16 v[44:47], v[64:67], v[136:143], v1
    ds_read_b128 v[128:131], v2 offset:8192
    buffer_load_dwordx4 v[16:19], v3, s[4:7], s101 offen offset:1024 sc1
    v_smfmac_f32_16x16x64_bf16 v[56:59], v[64:67], a[192:199], v1
    ds_read_b128 v[88:91], v3 offset:6144
    v_smfmac_f32_16x16x64_bf16 v[60:63], v[64:67], a[200:207], v1
    s_waitcnt lgkmcnt(3)
    ds_read_b128 v[92:95], v3 offset:7168
    s_branch L_c0_j20
L_c0_pad3:
    s_branch L_c_warm0
.p2align 5
L_c0_no1:
    buffer_load_dwordx4 v[68:71], v31, s[4:7], s57 offen offset:2048 sc1
    s_nop 0
    ds_read_b128 v[128:131], v2 offset:4096
    ds_read_b128 v[132:135], v2 offset:5120
    ds_read_b128 v[136:139], v2 offset:6144
    ds_read_b128 v[140:143], v2 offset:7168
    v_mfma_f32_4x4x1_16b_f32 v[40:43], v23, v23, 0
    v_mfma_f32_4x4x1_16b_f32 v[44:47], v23, v23, 0
    s_nop 0
L_c0_c2:
    s_waitcnt vmcnt(4)
    v_cmp_eq_u32_e64 vcc, s12, v72
    v_smfmac_f32_16x16x64_bf16 v[40:43], v[72:75], a[16:23], v1
    v_smfmac_f32_16x16x64_bf16 v[44:47], v[72:75], a[24:31], v1
    s_cbranch_vccnz L_c0_no2
L_c0_go2:
    buffer_load_dwordx4 v31, s[4:7], s58 offen offset:0 sc1 lds
    v_smfmac_f32_16x16x64_bf16 v[48:51], v[72:75], a[128:135], v1
    v_smfmac_f32_16x16x64_bf16 v[52:55], v[72:75], a[136:143], v1
    v_smfmac_f32_16x16x64_bf16 v[56:59], v[72:75], a[208:215], v1
    v_smfmac_f32_16x16x64_bf16 v[60:63], v[72:75], a[216:223], v1
    s_waitcnt vmcnt(4) lgkmcnt(0)
    v_smfmac_f32_16x16x64_bf16 v[48:51], v[76:79], v[128:135], v1
    ds_read_b128 v[128:131], v2 offset:24576
    s_barrier
    v_smfmac_f32_16x16x64_bf16 v[52:55], v[76:79], v[136:143], v1
    ds_read_b128 v[132:135], v2 offset:25600
    buffer_load_dwordx4 v[144:147], v3, s[4:7], s100 offen offset:0 sc1
    v_smfmac_f32_16x16x64_bf16 v[40:43], v[76:79], a[32:39], v1
    ds_read_b128 v[136:139], v2 offset:26624
    v_smfmac_f32_16x16x64_bf16 v[44:47], v[76:79], a[40:47], v1
    ds_read_b128 v[140:143], v2 offset:27648
    v_smfmac_f32_16x16x64_bf16 v[56:59], v[76:79], a[224:231], v1
    v_smfmac_f32_16x16x64_bf16 v[60:63], v[76:79], a[232:239], v1
    s_waitcnt vmcnt(3)
    buffer_load_dwordx4 v[148:151], v3, s[4:7], s100 offen offset:1024 sc1
    v_smfmac_f32_16x16x64_bf16 v[48:51], v[64:67], a[96:103], v1
    v_smfmac_f32_16x16x64_bf16 v[52:55], v[64:67], a[104:111], v1
    s_waitcnt lgkmcnt(2)
    v_smfmac_f32_16x16x64_bf16 v[40:43], v[64:67], v[128:135], v1
    s_waitcnt lgkmcnt(0)
    ds_read_b128 v[128:131], v2 offset:0
    v_smfmac_f32_16x16x64_bf16 v[44:47], v[64:67], v[136:143], v1
    ds_read_b128 v[132:135], v2 offset:1024
    buffer_load_dwordx4 v[12:15], v3, s[4:7], s101 offen offset:0 sc1
    v_smfmac_f32_16x16x64_bf16 v[56:59], v[64:67], a[192:199], v1
    ds_read_b128 v[136:139], v2 offset:2048
    v_smfmac_f32_16x16x64_bf16 v[60:63], v[64:67], a[200:207], v1
    s_waitcnt vmcnt(4)
    ds_read_b128 v[140:143], v2 offset:3072
    v_smfmac_f32_16x16x64_bf16 v[40:43], v[68:71], a[0:7], v1
    s_waitcnt vmcnt(3)
    s_barrier
    v_smfmac_f32_16x16x64_bf16 v[44:47], v[68:71], a[8:15], v1
    s_waitcnt lgkmcnt(2)
    ds_read_b128 v[80:83], v3 offset:4096
    v_smfmac_f32_16x16x64_bf16 v[56:59], v[68:71], v[128:135], v1
    s_waitcnt lgkmcnt(1)
    ds_read_b128 v[84:87], v3 offset:5120
    v_smfmac_f32_16x16x64_bf16 v[60:63], v[68:71], v[136:143], v1
    ds_read_b128 v[128:131], v2 offset:8192
    buffer_load_dwordx4 v[16:19], v3, s[4:7], s101 offen offset:1024 sc1
    v_smfmac_f32_16x16x64_bf16 v[48:51], v[68:71], a[112:119], v1
    ds_read_b128 v[88:91], v3 offset:6144
    v_smfmac_f32_16x16x64_bf16 v[52:55], v[68:71], a[120:127], v1
    s_waitcnt lgkmcnt(3)
    ds_read_b128 v[92:95], v3 offset:7168
    s_branch L_c0_j20
L_c0_pad4:
    s_branch L_c0_pad5
.p2align 5
L_c0_no2:
    buffer_load_dwordx4 v[72:75], v31, s[4:7], s57 offen offset:128 sc1
    s_nop 0
    s_nop 3
    v_mfma_f32_4x4x1_16b_f32 v[40:43], v23, v23, 0
    v_mfma_f32_4x4x1_16b_f32 v[44:47], v23, v23, 0
    s_nop 0
L_c0_c3:
    s_waitcnt vmcnt(4)
    v_cmp_eq_u32_e64 vcc, s12, v76
    v_smfmac_f32_16x16x64_bf16 v[40:43], v[76:79], a[32:39], v1
    v_smfmac_f32_16x16x64_bf16 v[44:47], v[76:79], a[40:47], v1
    s_cbranch_vccnz L_c0_no3
L_c0_go3:
    s_waitcnt lgkmcnt(0)
    buffer_load_dwordx4 v31, s[4:7], s58 offen offset:0 sc1 lds
    v_smfmac_f32_16x16x64_bf16 v[48:51], v[76:79], v[128:135], v1
    ds_read_b128 v[128:131], v2 offset:24576
    v_smfmac_f32_16x16x64_bf16 v[52:55], v[76:79], v[136:143], v1
    ds_read_b128 v[132:135], v2 offset:25600
    v_smfmac_f32_16x16x64_bf16 v[56:59], v[76:79], a[224:231], v1
    ds_read_b128 v[136:139], v2 offset:26624
    v_smfmac_f32_16x16x64_bf16 v[60:63], v[76:79], a[232:239], v1
    s_waitcnt vmcnt(3)
    ds_read_b128 v[140:143], v2 offset:27648
    v_smfmac_f32_16x16x64_bf16 v[48:51], v[64:67], a[96:103], v1
    s_barrier
    v_smfmac_f32_16x16x64_bf16 v[52:55], v[64:67], a[104:111], v1
    buffer_load_dwordx4 v[144:147], v3, s[4:7], s100 offen offset:0 sc1
    v_smfmac_f32_16x16x64_bf16 v[56:59], v[64:67], a[192:199], v1
    v_smfmac_f32_16x16x64_bf16 v[60:63], v[64:67], a[200:207], v1
    s_waitcnt lgkmcnt(2)
    v_smfmac_f32_16x16x64_bf16 v[40:43], v[64:67], v[128:135], v1
    s_waitcnt lgkmcnt(0)
    ds_read_b128 v[128:131], v2 offset:0
    v_smfmac_f32_16x16x64_bf16 v[44:47], v[64:67], v[136:143], v1
    s_waitcnt vmcnt(3)
    ds_read_b128 v[132:135], v2 offset:1024
    buffer_load_dwordx4 v[148:151], v3, s[4:7], s100 offen offset:1024 sc1
    v_smfmac_f32_16x16x64_bf16 v[40:43], v[68:71], a[0:7], v1
    ds_read_b128 v[136:139], v2 offset:2048
    v_smfmac_f32_16x16x64_bf16 v[44:47], v[68:71], a[8:15], v1
    ds_read_b128 v[140:143], v2 offset:3072
    v_smfmac_f32_16x16x64_bf16 v[48:51], v[68:71], a[112:119], v1
    v_smfmac_f32_16x16x64_bf16 v[52:55], v[68:71], a[120:127], v1
    s_waitcnt lgkmcnt(2)
    buffer_load_dwordx4 v[12:15], v3, s[4:7], s101 offen offset:0 sc1
    v_smfmac_f32_16x16x64_bf16 v[56:59], v[68:71], v[128:135], v1
    s_waitcnt lgkmcnt(0)
    v_smfmac_f32_16x16x64_bf16 v[60:63], v[68:71], v[136:143], v1
    s_waitcnt vmcnt(4)
    v_smfmac_f32_16x16x64_bf16 v[40:43], v[72:75], a[16:23], v1
    s_waitcnt vmcnt(3)
    s_barrier
    v_smfmac_f32_16x16x64_bf16 v[44:47], v[72:75], a[24:31], v1
    ds_read_b128 v[80:83], v3 offset:4096
    v_smfmac_f32_16x16x64_bf16 v[48:51], v[72:75], a[128:135], v1
    ds_read_b128 v[84:87], v3 offset:5120
    v_smfmac_f32_16x16x64_bf16 v[52:55], v[72:75], a[136:143], v1
    ds_read_b128 v[128:131], v2 offset:8192
    buffer_load_dwordx4 v[16:19], v3, s[4:7], s101 offen offset:1024 sc1
    v_smfmac_f32_16x16x64_bf16 v[56:59], v[72:75], a[208:215], v1
    ds_read_b128 v[88:91], v3 offset:6144
    v_smfmac_f32_16x16x64_bf16 v[60:63], v[72:75], a[216:223], v1
    s_waitcnt lgkmcnt(3)
    ds_read_b128 v[92:95], v3 offset:7168
    s_branch L_c0_j20
L_c0_pad5:
    s_branch L_c0_pad6
.p2align 5
L_c0_no3:
    s_add_u32 s3, s3, 1
    s_cmp_gt_u32 s3, 262144
    s_cbranch_scc1 L_c0_go3
    buffer_load_dwordx4 v[76:79], v31, s[4:7], s57 offen offset:2176 sc1
    buffer_load_dwordx4 v31, s[4:7], s58 offen offset:0 sc1 lds
    ds_read_b128 v[128:131], v2 offset:24576
    ds_read_b128 v[132:135], v2 offset:25600
    ds_read_b128 v[136:139], v2 offset:26624
    ds_read_b128 v[140:143], v2 offset:27648
    v_mfma_f32_4x4x1_16b_f32 v[40:43], v23, v23, 0
    v_mfma_f32_4x4x1_16b_f32 v[44:47], v23, v23, 0
    s_nop 0
    s_branch L_c0_c0
L_c0_nan:
    v_mov_b32 v20, 0
    v_max3_u32 v20, v20, v64, v65
    v_max3_u32 v20, v20, v66, v67
    v_max3_u32 v20, v20, v68, v69
    v_max3_u32 v20, v20, v70, v71
    v_max3_u32 v20, v20, v72, v73
    v_max3_u32 v20, v20, v74, v75
    v_max3_u32 v20, v20, v76, v77
    v_max3_u32 v20, v20, v78, v79
    v_max3_u32 v20, v20, v80, v81
    v_max3_u32 v20, v20, v82, v83
    v_max3_u32 v20, v20, v84, v85
    v_max3_u32 v20, v20, v86, v87
    v_max3_u32 v20, v20, v88, v89
    v_max3_u32 v20, v20, v90, v91
    v_max3_u32 v20, v20, v92, v93
    v_max3_u32 v20, v20, v94, v95
    v_cmp_eq_u32 vcc, s12, v20
    s_cbranch_vccz L_c0_nanok
L_c0_nanl:
    buffer_load_dwordx4 v[64:67], v31, s[4:7], s57 offen offset:0 sc1
    buffer_load_dwordx4 v[68:71], v31, s[4:7], s57 offen offset:2048 sc1
    buffer_load_dwordx4 v[72:75], v31, s[4:7], s57 offen offset:128 sc1
    buffer_load_dwordx4 v[76:79], v31, s[4:7], s57 offen offset:2176 sc1
    buffer_load_dwordx4 v[80:83], v31, s[4:7], s58 offen offset:0 sc1
    buffer_load_dwordx4 v[84:87], v31, s[4:7], s58 offen offset:2048 sc1
    buffer_load_dwordx4 v[88:91], v31, s[4:7], s58 offen offset:128 sc1
    buffer_load_dwordx4 v[92:95], v31, s[4:7], s58 offen offset:2176 sc1
    s_waitcnt vmcnt(0)
    v_mov_b32 v20, 0
    v_max3_u32 v20, v20, v64, v65
    v_max3_u32 v20, v20, v66, v67
    v_max3_u32 v20, v20, v68, v69
    v_max3_u32 v20, v20, v70, v71
    v_max3_u32 v20, v20, v72, v73
    v_max3_u32 v20, v20, v74, v75
    v_max3_u32 v20, v20, v76, v77
    v_max3_u32 v20, v20, v78, v79
    v_max3_u32 v20, v20, v80, v81
    v_max3_u32 v20, v20, v82, v83
    v_max3_u32 v20, v20, v84, v85
    v_max3_u32 v20, v20, v86, v87
    v_max3_u32 v20, v20, v88, v89
    v_max3_u32 v20, v20, v90, v91
    v_max3_u32 v20, v20, v92, v93
    v_max3_u32 v20, v20, v94, v95
    v_cmp_eq_u32 vcc, s12, v20
    s_cbranch_vccz L_c0_nanr
    s_add_u32 s3, s3, 1
    s_cmp_gt_u32 s3, 262144
    s_cbranch_scc1 L_c0_nanr
    s_branch L_c0_nanl
L_c0_nanr:
    s_waitcnt lgkmcnt(0)
    v_mov_b64 v[40:41], 0
    v_mov_b64 v[42:43], 0
    v_mov_b64 v[44:45], 0
    v_mov_b64 v[46:47], 0
    v_mov_b64 v[48:49], 0
    v_mov_b64 v[50:51], 0
    v_mov_b64 v[52:53], 0
    v_mov_b64 v[54:55], 0
    v_mov_b64 v[56:57], 0
    v_mov_b64 v[58:59], 0
    v_mov_b64 v[60:61], 0
    v_mov_b64 v[62:63], 0
    ds_read_b128 v[128:131], v2 offset:24576
    ds_read_b128 v[132:135], v2 offset:25600
    ds_read_b128 v[136:139], v2 offset:26624
    ds_read_b128 v[140:143], v2 offset:27648
    s_waitcnt lgkmcnt(0)
    v_smfmac_f32_16x16x64_bf16 v[40:43], v[64:67], v[128:135], v1
    v_smfmac_f32_16x16x64_bf16 v[44:47], v[64:67], v[136:143], v1
    v_smfmac_f32_16x16x64_bf16 v[48:51], v[64:67], a[96:103], v1
    v_smfmac_f32_16x16x64_bf16 v[52:55], v[64:67], a[104:111], v1
    v_smfmac_f32_16x16x64_bf16 v[56:59], v[64:67], a[192:199], v1
    v_smfmac_f32_16x16x64_bf16 v[60:63], v[64:67], a[200:207], v1
    v_smfmac_f32_16x16x64_bf16 v[40:43], v[68:71], a[0:7], v1
    v_smfmac_f32_16x16x64_bf16 v[44:47], v[68:71], a[8:15], v1
    v_smfmac_f32_16x16x64_bf16 v[48:51], v[68:71], a[112:119], v1
    v_smfmac_f32_16x16x64_bf16 v[52:55], v[68:71], a[120:127], v1
    ds_read_b128 v[128:131], v2 offset:0
    ds_read_b128 v[132:135], v2 offset:1024
    ds_read_b128 v[136:139], v2 offset:2048
    ds_read_b128 v[140:143], v2 offset:3072
    s_waitcnt lgkmcnt(0)
    v_smfmac_f32_16x16x64_bf16 v[56:59], v[68:71], v[128:135], v1
    v_smfmac_f32_16x16x64_bf16 v[60:63], v[68:71], v[136:143], v1
    v_smfmac_f32_16x16x64_bf16 v[40:43], v[72:75], a[16:23], v1
    v_smfmac_f32_16x16x64_bf16 v[44:47], v[72:75], a[24:31], v1
    v_smfmac_f32_16x16x64_bf16 v[48:51], v[72:75], a[128:135], v1
    v_smfmac_f32_16x16x64_bf16 v[52:55], v[72:75], a[136:143], v1
    v_smfmac_f32_16x16x64_bf16 v[56:59], v[72:75], a[208:215], v1
    v_smfmac_f32_16x16x64_bf16 v[60:63], v[72:75], a[216:223], v1
    v_smfmac_f32_16x16x64_bf16 v[40:43], v[76:79], a[32:39], v1
    v_smfmac_f32_16x16x64_bf16 v[44:47], v[76:79], a[40:47], v1
    ds_read_b128 v[128:131], v2 offset:4096
    ds_read_b128 v[132:135], v2 offset:5120
    ds_read_b128 v[136:139], v2 offset:6144
    ds_read_b128 v[140:143], v2 offset:7168
    s_waitcnt lgkmcnt(0)
    v_smfmac_f32_16x16x64_bf16 v[48:51], v[76:79], v[128:135], v1
    v_smfmac_f32_16x16x64_bf16 v[52:55], v[76:79], v[136:143], v1
    v_smfmac_f32_16x16x64_bf16 v[56:59], v[76:79], a[224:231], v1
    v_smfmac_f32_16x16x64_bf16 v[60:63], v[76:79], a[232:239], v1
    v_smfmac_f32_16x16x64_bf16 v[40:43], v[80:83], a[48:55], v1
    v_smfmac_f32_16x16x64_bf16 v[40:43], v[84:87], a[64:71], v1
    v_smfmac_f32_16x16x64_bf16 v[44:47], v[80:83], a[56:63], v1
    v_smfmac_f32_16x16x64_bf16 v[44:47], v[84:87], a[72:79], v1
    v_smfmac_f32_16x16x64_bf16 v[40:43], v[88:91], a[80:87], v1
    ds_read_b128 v[128:131], v2 offset:8192
    ds_read_b128 v[132:135], v2 offset:9216
    ds_read_b128 v[136:139], v2 offset:10240
    ds_read_b128 v[140:143], v2 offset:11264
    s_waitcnt lgkmcnt(0)
    v_smfmac_f32_16x16x64_bf16 v[40:43], v[92:95], v[128:135], v1
    v_smfmac_f32_16x16x64_bf16 v[44:47], v[88:91], a[88:95], v1
    v_smfmac_f32_16x16x64_bf16 v[44:47], v[92:95], v[136:143], v1
    v_smfmac_f32_16x16x64_bf16 v[48:51], v[80:83], a[144:151], v1
    v_smfmac_f32_16x16x64_bf16 v[48:51], v[84:87], a[160:167], v1
    v_smfmac_f32_16x16x64_bf16 v[48:51], v[88:91], a[176:183], v1
    ds_read_b128 v[128:131], v2 offset:20480
    ds_read_b128 v[132:135], v2 offset:21504
    ds_read_b128 v[136:139], v2 offset:22528
    ds_read_b128 v[140:143], v2 offset:23552
    s_waitcnt lgkmcnt(0)
    v_smfmac_f32_16x16x64_bf16 v[48:51], v[92:95], v[128:135], v1
    v_smfmac_f32_16x16x64_bf16 v[52:55], v[80:83], a[152:159], v1
    v_smfmac_f32_16x16x64_bf16 v[52:55], v[84:87], a[168:175], v1
    v_smfmac_f32_16x16x64_bf16 v[52:55], v[88:91], a[184:191], v1
    v_smfmac_f32_16x16x64_bf16 v[52:55], v[92:95], v[136:143], v1
    ds_read_b128 v[128:131], v2 offset:28672
    ds_read_b128 v[132:135], v2 offset:29696
    v_add_f32 v40, v40, v42
    v_add_f32 v41, v41, v43
    v_add_f32 v44, v44, v46
    v_add_f32 v45, v45, v47
    v_cvt_pk_bf16_f32 v42, v40, v44
    v_cvt_pk_bf16_f32 v43, v41, v45
    ds_write_b32 v6, v42
    ds_write_b32 v6, v43 offset:16
    v_add_f32 v48, v48, v50
    v_add_f32 v49, v49, v51
    s_waitcnt lgkmcnt(0)
    s_branch L_c0_nanok
L_c0_pad6:
    s_branch L_c_warm1
L_c0_flag:
L_c0_f1:
    buffer_load_dword v10, v11, s[4:7], s64 offen sc1
    s_add_u32 s3, s3, 1
    s_cmp_gt_u32 s3, 262144
    s_cbranch_scc1 L_c0_f1_out
    s_waitcnt vmcnt(0)
    v_cmp_eq_u32 s[68:69], 1, v10
    s_nop 4
    s_bitcmp1_b64 s[68:69], s49
    s_cbranch_scc0 L_c0_f1
L_c0_f1_out:
    s_waitcnt vmcnt(0)
    s_branch L_c0_flagok
L_c0_done:
    buffer_store_dwordx4 v[52:55], v3, s[4:7], s61 offen sc1
    s_cmp_ge_u32 s45, 1
    s_cbranch_scc1 L_c0_fin
    s_waitcnt vmcnt(0)
    buffer_wbl2 sc1
L_c0_fin:
    s_waitcnt vmcnt(0)
    s_endpgm
L_c_w1:
    v_mov_b64 v[56:57], 0
    v_mov_b64 v[58:59], 0
    v_mov_b64 v[60:61], 0
    v_mov_b64 v[62:63], 0
    s_waitcnt vmcnt(0)
    ds_write_b128 v3, v[144:147] offset:4096
    ds_write_b128 v3, v[148:151] offset:5120
    v_mov_b64 v[24:25], v[12:13]
    v_mov_b64 v[28:29], v[14:15]
    v_mov_b64 v[32:33], v[16:17]
    v_mov_b64 v[36:37], v[18:19]
    s_waitcnt lgkmcnt(0)
    s_barrier
    ds_read_b128 v[96:99], v3 offset:6144
    ds_read_b128 v[100:103], v3 offset:7168
    ds_read_b128 v[104:107], v3 offset:4096
    ds_read_b128 v[108:111], v3 offset:5120
    ds_read_b128 v[112:115], v3 offset:0
    ds_read_b128 v[116:119], v3 offset:1024
    ds_read_b128 v[120:123], v3 offset:2048
    ds_read_b128 v[124:127], v3 offset:3072
    ds_read_b128 v[128:131], v2 offset:24576
    ds_read_b128 v[132:135], v2 offset:25600
    ds_read_b128 v[136:139], v2 offset:26624
    ds_read_b128 v[140:143], v2 offset:27648
    s_add_u32 s60, s60, 524288
    s_add_u32 s100, s60, 2048
    s_add_u32 s101, s60, 10240
    s_waitcnt lgkmcnt(0)
    s_branch L_c1_top
L_c1_pad0:
    s_branch L_c1_pad1
.p2align 5
L_c1_top:
    s_barrier
L_c1_again:
    buffer_load_dwordx4 v[64:67], v31, s[4:7], s57 offen offset:0 sc1
    s_mov_b32 m0, 158720
    s_nop 15
    s_nop 1
    buffer_load_dwordx4 v[68:71], v31, s[4:7], s57 offen offset:2048 sc1
    s_nop 15
    s_nop 1
    buffer_load_dwordx4 v[72:75], v31, s[4:7], s57 offen offset:128 sc1
    s_nop 15
    s_nop 1
    buffer_load_dwordx4 v[76:79], v31, s[4:7], s57 offen offset:2176 sc1
    buffer_load_dwordx4 v31, s[4:7], s58 offen offset:2048 sc1 lds
L_c1_c0:
    s_waitcnt vmcnt(4) lgkmcnt(0)
    v_cmp_eq_u32_e64 vcc, s12, v64
    v_smfmac_f32_16x16x64_bf16 v[40:43], v[64:67], v[128:135], v1
    v_smfmac_f32_16x16x64_bf16 v[44:47], v[64:67], v[136:143], v1
    s_cbranch_vccnz L_c1_no0
L_c1_go0:
    v_smfmac_f32_16x16x64_bf16 v[56:59], v[64:67], a[192:199], v1
    ds_read_b128 v[128:131], v2 offset:0
    v_smfmac_f32_16x16x64_bf16 v[60:63], v[64:67], a[200:207], v1
    ds_read_b128 v[132:135], v2 offset:1024
    v_smfmac_f32_16x16x64_bf16 v[52:55], v[64:67], a[104:111], v1
    ds_read_b128 v[136:139], v2 offset:2048
    v_smfmac_f32_16x16x64_bf16 v[48:51], v[64:67], a[96:103], v1
    s_waitcnt vmcnt(3)
    ds_read_b128 v[140:143], v2 offset:3072
    v_smfmac_f32_16x16x64_bf16 v[48:51], v[68:71], a[112:119], v1
    s_barrier
    v_smfmac_f32_16x16x64_bf16 v[40:43], v[68:71], a[0:7], v1
    v_smfmac_f32_16x16x64_bf16 v[44:47], v[68:71], a[8:15], v1
    buffer_load_dwordx4 v[144:147], v3, s[4:7], s100 offen offset:0 sc1
    v_smfmac_f32_16x16x64_bf16 v[52:55], v[68:71], a[120:127], v1
    s_waitcnt lgkmcnt(0)
    v_smfmac_f32_16x16x64_bf16 v[56:59], v[68:71], v[128:135], v1
    ds_read_b128 v[128:131], v2 offset:4096
    v_smfmac_f32_16x16x64_bf16 v[60:63], v[68:71], v[136:143], v1
    s_waitcnt vmcnt(3)
    ds_read_b128 v[132:135], v2 offset:5120
    v_smfmac_f32_16x16x64_bf16 v[60:63], v[72:75], a[216:223], v1
    ds_read_b128 v[136:139], v2 offset:6144
    buffer_load_dwordx4 v[148:151], v3, s[4:7], s100 offen offset:1024 sc1
    v_smfmac_f32_16x16x64_bf16 v[56:59], v[72:75], a[208:215], v1
    ds_read_b128 v[140:143], v2 offset:7168
    v_smfmac_f32_16x16x64_bf16 v[52:55], v[72:75], a[136:143], v1
    v_smfmac_f32_16x16x64_bf16 v[40:43], v[72:75], a[16:23], v1
    v_smfmac_f32_16x16x64_bf16 v[44:47], v[72:75], a[24:31], v1
    buffer_load_dwordx4 v[12:15], v3, s[4:7], s101 offen offset:0 sc1
    v_smfmac_f32_16x16x64_bf16 v[48:51], v[72:75], a[128:135], v1
    s_waitcnt lgkmcnt(0)
    s_waitcnt vmcnt(4)
    v_smfmac_f32_16x16x64_bf16 v[48:51], v[76:79], v[128:135], v1
    s_waitcnt vmcnt(3)
    s_barrier
    v_smfmac_f32_16x16x64_bf16 v[56:59], v[76:79], a[224:231], v1
    ds_read_b128 v[80:83], v3 offset:4096
    v_smfmac_f32_16x16x64_bf16 v[60:63], v[76:79], a[232:239], v1
    ds_read_b128 v[84:87], v3 offset:5120
    v_smfmac_f32_16x16x64_bf16 v[52:55], v[76:79], v[136:143], v1
    ds_read_b128 v[128:131], v2 offset:8192
    v_smfmac_f32_16x16x64_bf16 v[44:47], v[76:79], a[40:47], v1
    ds_read_b128 v[88:91], v3 offset:6144
    buffer_load_dwordx4 v[16:19], v3, s[4:7], s101 offen offset:1024 sc1
    v_smfmac_f32_16x16x64_bf16 v[40:43], v[76:79], a[32:39], v1
    s_waitcnt lgkmcnt(3)
    ds_read_b128 v[92:95], v3 offset:7168
L_c1_j20:
    v_smfmac_f32_16x16x64_bf16 v[40:43], v[80:83], a[48:55], v1
    s_waitcnt lgkmcnt(3)
    ds_read_b128 v[132:135], v2 offset:9216
    v_smfmac_f32_16x16x64_bf16 v[40:43], v[84:87], a[64:71], v1
    ds_read_b128 v[136:139], v2 offset:10240
    v_smfmac_f32_16x16x64_bf16 v[44:47], v[80:83], a[56:63], v1
    ds_read_b128 v[140:143], v2 offset:11264
    v_smfmac_f32_16x16x64_bf16 v[44:47], v[84:87], a[72:79], v1
    s_waitcnt lgkmcnt(3)
    v_smfmac_f32_16x16x64_bf16 v[40:43], v[88:91], a[80:87], v1
    s_waitcnt lgkmcnt(2)
    v_smfmac_f32_16x16x64_bf16 v[40:43], v[92:95], v[128:135], v1
    ds_read_b128 v[128:131], v2 offset:20480
    v_smfmac_f32_16x16x64_bf16 v[44:47], v[88:91], a[88:95], v1
    s_waitcnt lgkmcnt(1)
    ds_read_b128 v[132:135], v2 offset:21504
    v_smfmac_f32_16x16x64_bf16 v[44:47], v[92:95], v[136:143], v1
    ds_read_b128 v[136:139], v2 offset:22528
    v_add_f32 v40, v40, v42
    v_smfmac_f32_16x16x64_bf16 v[48:51], v[80:83], a[144:151], v1
    ds_read_b128 v[140:143], v2 offset:23552
    v_add_f32 v41, v41, v43
    v_smfmac_f32_16x16x64_bf16 v[48:51], v[84:87], a[160:167], v1
    v_add_f32 v44, v44, v46
    v_add_f32_e64 v45, v45, v47
    v_smfmac_f32_16x16x64_bf16 v[48:51], v[88:91], a[176:183], v1
    s_waitcnt lgkmcnt(2)
    v_cvt_pk_bf16_f32 v42, v40, v44
    v_smfmac_f32_16x16x64_bf16 v[48:51], v[92:95], v[128:135], v1
    ds_write_b32 v6, v42
    v_cvt_pk_bf16_f32 v43, v41, v45
    v_smfmac_f32_16x16x64_bf16 v[52:55], v[80:83], a[152:159], v1
    ds_write_b32 v6, v43 offset:16
    v_cmp_u_f32_e64 vcc, v40, v41
    v_smfmac_f32_16x16x64_bf16 v[52:55], v[84:87], a[168:175], v1
    ds_read_b128 v[128:131], v2 offset:28672
    v_add_f32 v48, v48, v50
    v_smfmac_f32_16x16x64_bf16 v[52:55], v[88:91], a[184:191], v1
    s_waitcnt lgkmcnt(3)
    ds_read_b128 v[132:135], v2 offset:29696
    v_add_f32 v49, v49, v51
    v_smfmac_f32_16x16x64_bf16 v[52:55], v[92:95], v[136:143], v1
    s_cbranch_vccnz L_c1_nan
L_c1_nanok:
    ds_read_b128 v[136:139], v2 offset:30720
    v_smfmac_f32_16x16x64_bf16 v[56:59], v[80:83], a[240:247], v1
    s_waitcnt lgkmcnt(3)
    s_barrier
    v_smfmac_f32_16x16x64_bf16 v[56:59], v[84:87], v[152:159], v1
    ds_read_b128 v[64:67], v7 offset:0
    v_add_f32_e64 v52, v52, v54
    v_smfmac_f32_16x16x64_bf16 v[56:59], v[88:91], v[168:175], v1
    s_waitcnt lgkmcnt(2)
    ds_read_b128 v[140:143], v2 offset:31744
    v_add_f32 v53, v53, v55
    v_smfmac_f32_16x16x64_bf16 v[56:59], v[92:95], v[128:135], v1
    ds_read_b128 v[68:71], v7 offset:1024
    v_cvt_pk_bf16_f32 v52, v48, v52
    v_smfmac_f32_16x16x64_bf16 v[60:63], v[80:83], a[248:255], v1
    ds_write_b32 v6, v52 offset:512
    v_cvt_pk_bf16_f32 v53, v49, v53
    v_smfmac_f32_16x16x64_bf16 v[60:63], v[84:87], v[160:167], v1
    ds_write_b32 v6, v53 offset:528
    v_add_f32_e64 v56, v56, v58
    v_smfmac_f32_16x16x64_bf16 v[60:63], v[88:91], v[176:183], v1
    s_waitcnt lgkmcnt(3)
    ds_read_b128 v[72:75], v7 offset:2048
    v_add_f32 v57, v57, v59
    v_smfmac_f32_16x16x64_bf16 v[60:63], v[92:95], v[136:143], v1
    s_waitcnt lgkmcnt(3)
    ds_read_b128 v[76:79], v7 offset:3072
    v_cvt_pk_bf16_f32 v26, v56, v57
    v_mfma_f32_16x16x32_bf16 v[40:43], v[96:99], v[64:67], 0
    s_cmp_eq_u32 s51, 63
    v_cvt_pk_bf16_f32 v54, v56, v57
    v_mfma_f32_16x16x32_bf16 v[40:43], v[100:103], v[68:71], v[40:43]
    s_waitcnt lgkmcnt(1)
    s_barrier
    v_mfma_f32_16x16x32_bf16 v[40:43], v[104:107], v[72:75], v[40:43]
    s_waitcnt lgkmcnt(0)
    ds_read_b128 v[80:83], v8 offset:0
    v_add_f32 v60, v60, v62
    v_mfma_f32_16x16x32_bf16 v[40:43], v[108:111], v[76:79], v[40:43]
    ds_read_b128 v[84:87], v8 offset:1024
    v_add_f32_e64 v61, v61, v63
    v_mfma_f32_16x16x32_bf16 v[44:47], v[112:115], v[64:67], 0
    ds_read_b128 v[88:91], v8 offset:2048
    v_cvt_pk_bf16_f32 v34, v60, v61
    v_mfma_f32_16x16x32_bf16 v[44:47], v[116:119], v[68:71], v[44:47]
    ds_read_b128 v[92:95], v8 offset:3072
    v_cvt_pk_bf16_f32 v55, v60, v61
    v_mfma_f32_16x16x32_bf16 v[44:47], v[120:123], v[72:75], v[44:47]
    v_permlane16_swap_b32 v26, v30
    v_mfma_f32_16x16x32_bf16 v[44:47], v[124:127], v[76:79], v[44:47]
    s_waitcnt lgkmcnt(2)
    v_permlane16_swap_b32 v34, v38
    v_mfma_f32_16x16x32_bf16 v[48:51], v[80:83], v[64:67], 0
    s_cbranch_scc1 L_c1_done
    v_mov_b64 v[56:57], 0
    v_mov_b64_e64 v[58:59], 0
    v_mfma_f32_16x16x32_bf16 v[48:51], v[84:87], v[68:71], v[48:51]
    s_waitcnt lgkmcnt(0)
    v_cndmask_b32 v40, v40, v44, s[66:67]
    v_cndmask_b32 v41, v41, v45, s[66:67]
    v_mfma_f32_16x16x32_bf16 v[48:51], v[88:91], v[72:75], v[48:51]
    v_cndmask_b32 v42, v42, v46, s[66:67]
    v_cndmask_b32 v43, v43, v47, s[66:67]
    v_mfma_f32_16x16x32_bf16 v[48:51], v[92:95], v[76:79], v[48:51]
    v_max3_f32 v44, v40, v41, v42
    v_max_f32 v44, v44, v43
    v_mov_b64 v[60:61], 0
    v_mov_b64_e64 v[62:63], 0
    v_max_f32_dpp v44, v44, v44 quad_perm:[2,3,0,1] row_mask:0xf bank_mask:0xf
    v_mov_b32 v45, v44
    v_mov_b64 v[96:97], s[70:71]
    v_max3_f32 v46, v48, v49, v50
    v_permlane16_swap_b32_e64 v44, v45
    v_max3_f32 v44, v44, v45, v51
    v_max_f32 v45, v44, v46
    v_max_f32 v44, v44, v46
    v_cndmask_b32 v48, v48, v49, s[66:67]
    v_mov_b64 v[98:99], s[70:71]
    v_permlane32_swap_b32 v44, v45
    v_max_f32 v44, v44, v45
    v_mul_f32 v44, s63, v44
    v_pk_fma_f32 v[40:41], v[40:41], s[62:63], v[44:45] op_sel_hi:[1,1,0] neg_lo:[0,0,1] neg_hi:[0,0,1]
    v_pk_fma_f32 v[42:43], v[42:43], s[62:63], v[44:45] op_sel_hi:[1,1,0] neg_lo:[0,0,1] neg_hi:[0,0,1]
    v_fma_f32 v48, v48, s63, -v44
    v_exp_f32 v40, v40
    v_exp_f32 v41, v41
    v_exp_f32 v42, v42
    v_cvt_pk_bf16_f32 v20, v40, v41
    v_exp_f32 v43, v43
    v_exp_f32_e64 v48, v48
    v_cvt_pk_bf16_f32 v22, v42, v43
    v_cvt_pk_bf16_f32 v21, v48, v23
    s_nop 1
    v_mfma_f32_16x16x32_bf16 v[44:47], v[20:23], v[96:99], 0
    v_smfmac_f32_16x16x64_bf16 v[56:59], v[20:23], v[24:31], v1 abid:1
    ds_read_b128 v[128:131], v2 offset:12288
    v_smfmac_f32_16x16x64_bf16 v[60:63], v[20:23], v[32:39], v1 abid:1
    ds_read_b128 v[132:135], v2 offset:13312
    v_add_f32 v44, v44, v46
    v_add_f32 v45, v45, v47
    v_rcp_f32 v44, v44
    v_rcp_f32_e64 v45, v45
    v_pk_add_f32 v[56:57], v[56:57], v[58:59]
    v_pk_mul_f32 v[56:57], v[56:57], v[44:45]
    v_pk_add_f32 v[60:61], v[60:61], v[62:63]
    v_pk_mul_f32 v[60:61], v[60:61], v[44:45]
    v_cvt_pk_bf16_f32 v58, v56, v60
    v_cvt_pk_bf16_f32 v59, v57, v61
    v_mfma_f32_4x4x1_16b_f32 v[80:83], v23, v23, 0
    ds_write2_b32 v9, v58, v59 offset0:0 offset1:4
    v_mfma_f32_16x16x1_4b_f32 v[64:79], v23, v23, 0
    s_and_b32 s56, s51, 1
    s_add_u32 s51, s51, 1
    s_lshl_b32 s47, s56, 13
    s_sub_u32 s57, 3153920, s47
    s_add_u32 s58, s57, 4096
    buffer_store_dwordx4 v[52:55], v3, s[4:7], s61 offen nt
    s_waitcnt lgkmcnt(0)
    s_barrier
    ds_read_b128 v[40:43], v3 offset:4096
    v_mfma_f32_4x4x1_16b_f32 v[84:87], v23, v23, 0
    ds_read_b128 v[44:47], v3 offset:5120
    v_mfma_f32_4x4x1_16b_f32 v[88:91], v23, v23, 0
    v_mfma_f32_4x4x1_16b_f32 v[92:95], v23, v23, 0
    ds_read_b128 v[136:139], v2 offset:14336
    s_waitcnt lgkmcnt(2)
    v_smfmac_f32_16x16x64_bf16 v[64:67], v[40:43], v[184:191], v1
    ds_read_b128 v[140:143], v2 offset:15360
    v_smfmac_f32_16x16x64_bf16 v[68:71], v[40:43], v[200:207], v1
    s_waitcnt lgkmcnt(2)
    ds_read_b128 v[104:107], v2 offset:32768
    v_smfmac_f32_16x16x64_bf16 v[64:67], v[44:47], v[192:199], v1
    ds_read_b128 v[108:111], v2 offset:33792
    v_smfmac_f32_16x16x64_bf16 v[68:71], v[44:47], v[208:215], v1
    ds_read_b128 v[112:115], v2 offset:34816
    ds_read_b128 v[116:119], v2 offset:35840
    v_smfmac_f32_16x16x64_bf16 v[72:75], v[40:43], v[216:223], v1
    ds_read_b128 v[120:123], v2 offset:16384
    v_add_f32 v64, v64, v66
    v_add_f32_e64 v65, v65, v67
    v_smfmac_f32_16x16x64_bf16 v[72:75], v[44:47], v[224:231], v1
    ds_read_b128 v[124:127], v2 offset:17408
    v_add_f32 v68, v68, v70
    v_add_f32 v69, v69, v71
    v_smfmac_f32_16x16x64_bf16 v[76:79], v[40:43], v[232:239], v1
    ds_read_b128 v[96:99], v2 offset:18432
    v_cvt_pk_bf16_f32 v48, v64, v68
    v_cvt_pk_bf16_f32 v49, v65, v69
    v_bfi_b32 v48, 1, s56, v48
    v_smfmac_f32_16x16x64_bf16 v[76:79], v[44:47], v[240:247], v1
    buffer_store_dwordx2 v[48:49], v4, s[4:7], s52 offen offset:0
    v_add_f32 v72, v72, v74
    v_smfmac_f32_16x16x64_bf16 v[80:83], v[40:43], v[248:255], v1
    s_waitcnt lgkmcnt(5)
    ds_read_b128 v[100:103], v2 offset:19456
    v_add_f32 v73, v73, v75
    v_smfmac_f32_16x16x64_bf16 v[80:83], v[44:47], v[128:135], v1
    ds_read_b128 v[128:131], v2 offset:36864
    v_add_f32 v76, v76, v78
    v_add_f32_e64 v77, v77, v79
    v_smfmac_f32_16x16x64_bf16 v[84:87], v[40:43], v[136:143], v1
    ds_read_b128 v[132:135], v2 offset:37888
    v_cvt_pk_bf16_f32 v50, v72, v76
    v_cvt_pk_bf16_f32 v51, v73, v77
    v_bfi_b32 v50, 1, s56, v50
    v_smfmac_f32_16x16x64_bf16 v[84:87], v[44:47], v[104:111], v1
    s_waitcnt lgkmcnt(4)
    buffer_store_dwordx2 v[50:51], v4, s[4:7], s52 offen offset:64
    v_add_f32 v80, v80, v82
    v_smfmac_f32_16x16x64_bf16 v[88:91], v[40:43], v[112:119], v1
    v_add_f32 v81, v81, v83
    v_smfmac_f32_16x16x64_bf16 v[88:91], v[44:47], v[120:127], v1
    s_waitcnt lgkmcnt(2)
    v_add_f32 v84, v84, v86
    v_add_f32_e64 v85, v85, v87
    v_smfmac_f32_16x16x64_bf16 v[92:95], v[40:43], v[96:103], v1
    s_waitcnt lgkmcnt(0)
    v_cvt_pk_bf16_f32 v56, v80, v84
    v_cvt_pk_bf16_f32 v57, v81, v85
    v_bfi_b32 v56, 1, s56, v56
    v_smfmac_f32_16x16x64_bf16 v[92:95], v[44:47], v[128:135], v1
    buffer_store_dwordx2 v[56:57], v4, s[4:7], s53 offen offset:0
    v_add_f32 v88, v88, v90
    v_add_f32 v89, v89, v91
    s_nop 3
    v_add_f32 v92, v92, v94
    v_add_f32_e64 v93, v93, v95
    v_cvt_pk_bf16_f32 v58, v88, v92
    v_cvt_pk_bf16_f32 v59, v89, v93
    v_bfi_b32 v58, 1, s56, v58
    buffer_store_dwordx2 v[58:59], v4, s[4:7], s53 offen offset:64
    s_waitcnt vmcnt(4)
    s_barrier
    ds_write_b128 v3, v[144:147] offset:4096
    ds_write_b128 v3, v[148:151] offset:5120
    s_waitcnt lgkmcnt(0)
    s_barrier
    s_nop 15
    s_add_u32 s60, s60, 524288
    s_cmp_eq_u32 s51, 63
    s_cselect_b32 s60, 0x40000000, s60
    s_add_u32 s100, s60, 2048
    s_add_u32 s101, s60, 10240
    s_add_u32 s61, s61, 131072
    ds_read_b128 v[128:131], v2 offset:24576
    ds_read_b128 v[132:135], v2 offset:25600
    ds_read_b128 v[136:139], v2 offset:26624
    ds_read_b128 v[140:143], v2 offset:27648
    v_mfma_f32_4x4x1_16b_f32 v[40:43], v23, v23, 0
    v_mfma_f32_4x4x1_16b_f32 v[44:47], v23, v23, 0
    v_mfma_f32_4x4x1_16b_f32 v[48:51], v23, v23, 0
    v_mov_b64 v[24:25], v[12:13]
    v_mov_b64 v[28:29], v[14:15]
    v_mov_b64 v[32:33], v[16:17]
    v_mov_b64_e64 v[36:37], v[18:19]
    v_mfma_f32_4x4x1_16b_f32 v[52:55], v23, v23, 0
    v_mfma_f32_4x4x1_16b_f32 v[56:59], v23, v23, 0
    ds_read_b128 v[96:99], v3 offset:6144
    ds_read_b128 v[100:103], v3 offset:7168
    ds_read_b128 v[104:107], v3 offset:4096
    ds_read_b128 v[108:111], v3 offset:5120
    ds_read_b128 v[112:115], v3 offset:0
    ds_read_b128 v[116:119], v3 offset:1024
    ds_read_b128 v[120:123], v3 offset:2048
    ds_read_b128 v[124:127], v3 offset:3072
    v_mfma_f32_4x4x1_16b_f32 v[60:63], v23, v23, 0
    s_waitcnt lgkmcnt(0)
    s_branch L_c1_top
L_c1_pad1:
    s_branch L_c1_pad2
L_c1_pad2:
    s_branch L_c1_pad3
.p2align 5
L_c1_no0:
    buffer_load_dwordx4 v[64:67], v31, s[4:7], s57 offen offset:0 sc1
    s_nop 0
    ds_read_b128 v[128:131], v2 offset:0
    ds_read_b128 v[132:135], v2 offset:1024
    ds_read_b128 v[136:139], v2 offset:2048
    ds_read_b128 v[140:143], v2 offset:3072
    v_mfma_f32_4x4x1_16b_f32 v[40:43], v23, v23, 0
    v_mfma_f32_4x4x1_16b_f32 v[44:47], v23, v23, 0
    s_nop 0
L_c1_c1:
    s_waitcnt vmcnt(4)
    v_cmp_eq_u32_e64 vcc, s12, v68
    v_smfmac_f32_16x16x64_bf16 v[40:43], v[68:71], a[0:7], v1
    v_smfmac_f32_16x16x64_bf16 v[44:47], v[68:71], a[8:15], v1
    s_cbranch_vccnz L_c1_no1
L_c1_go1:
    buffer_load_dwordx4 v31, s[4:7], s58 offen offset:2048 sc1 lds
    v_smfmac_f32_16x16x64_bf16 v[48:51], v[68:71], a[112:119], v1
    v_smfmac_f32_16x16x64_bf16 v[52:55], v[68:71], a[120:127], v1
    s_waitcnt lgkmcnt(0)
    v_smfmac_f32_16x16x64_bf16 v[56:59], v[68:71], v[128:135], v1
    ds_read_b128 v[128:131], v2 offset:4096
    v_smfmac_f32_16x16x64_bf16 v[60:63], v[68:71], v[136:143], v1
    s_waitcnt vmcnt(4)
    ds_read_b128 v[132:135], v2 offset:5120
    v_smfmac_f32_16x16x64_bf16 v[40:43], v[72:75], a[16:23], v1
    ds_read_b128 v[136:139], v2 offset:6144
    s_barrier
    v_smfmac_f32_16x16x64_bf16 v[44:47], v[72:75], a[24:31], v1
    ds_read_b128 v[140:143], v2 offset:7168
    v_smfmac_f32_16x16x64_bf16 v[48:51], v[72:75], a[128:135], v1
    buffer_load_dwordx4 v[144:147], v3, s[4:7], s100 offen offset:0 sc1
    v_smfmac_f32_16x16x64_bf16 v[52:55], v[72:75], a[136:143], v1
    v_smfmac_f32_16x16x64_bf16 v[56:59], v[72:75], a[208:215], v1
    v_smfmac_f32_16x16x64_bf16 v[60:63], v[72:75], a[216:223], v1
    s_waitcnt vmcnt(4) lgkmcnt(2)
    v_smfmac_f32_16x16x64_bf16 v[48:51], v[76:79], v[128:135], v1
    s_waitcnt lgkmcnt(0)
    ds_read_b128 v[128:131], v2 offset:24576
    buffer_load_dwordx4 v[148:151], v3, s[4:7], s100 offen offset:1024 sc1
    v_smfmac_f32_16x16x64_bf16 v[52:55], v[76:79], v[136:143], v1
    ds_read_b128 v[132:135], v2 offset:25600
    v_smfmac_f32_16x16x64_bf16 v[40:43], v[76:79], a[32:39], v1
    ds_read_b128 v[136:139], v2 offset:26624
    v_smfmac_f32_16x16x64_bf16 v[44:47], v[76:79], a[40:47], v1
    ds_read_b128 v[140:143], v2 offset:27648
    v_smfmac_f32_16x16x64_bf16 v[56:59], v[76:79], a[224:231], v1
    buffer_load_dwordx4 v[12:15], v3, s[4:7], s101 offen offset:0 sc1
    v_smfmac_f32_16x16x64_bf16 v[60:63], v[76:79], a[232:239], v1
    s_waitcnt vmcnt(4)
    v_smfmac_f32_16x16x64_bf16 v[48:51], v[64:67], a[96:103], v1
    s_waitcnt vmcnt(3)
    s_barrier
    v_smfmac_f32_16x16x64_bf16 v[52:55], v[64:67], a[104:111], v1
    s_waitcnt lgkmcnt(2)
    ds_read_b128 v[80:83], v3 offset:4096
    v_smfmac_f32_16x16x64_bf16 v[40:43], v[64:67], v[128:135], v1
    s_waitcnt lgkmcnt(1)
    ds_read_b128 v[84:87], v3 offset:5120
    v_smfmac_f32_16x16x64_bf16 v[44:47], v[64:67], v[136:143], v1
    ds_read_b128 v[128:131], v2 offset:8192
    v_smfmac_f32_16x16x64_bf16 v[56:59], v[64:67], a[192:199], v1
    ds_read_b128 v[88:91], v3 offset:6144
    buffer_load_dwordx4 v[16:19], v3, s[4:7], s101 offen offset:1024 sc1
    v_smfmac_f32_16x16x64_bf16 v[60:63], v[64:67], a[200:207], v1
    s_waitcnt lgkmcnt(3)
    ds_read_b128 v[92:95], v3 offset:7168
    s_branch L_c1_j20
L_c1_pad3:
    s_branch L_c_warm0
.p2align 5
L_c1_no1:
    buffer_load_dwordx4 v[68:71], v31, s[4:7], s57 offen offset:2048 sc1
    s_nop 0
    ds_read_b128 v[128:131], v2 offset:4096
    ds_read_b128 v[132:135], v2 offset:5120
    ds_read_b128 v[136:139], v2 offset:6144
    ds_read_b128 v[140:143], v2 offset:7168
    v_mfma_f32_4x4x1_16b_f32 v[40:43], v23, v23, 0
    v_mfma_f32_4x4x1_16b_f32 v[44:47], v23, v23, 0
    s_nop 0
L_c1_c2:
    s_waitcnt vmcnt(4)
    v_cmp_eq_u32_e64 vcc, s12, v72
    v_smfmac_f32_16x16x64_bf16 v[40:43], v[72:75], a[16:23], v1
    v_smfmac_f32_16x16x64_bf16 v[44:47], v[72:75], a[24:31], v1
    s_cbranch_vccnz L_c1_no2
L_c1_go2:
    buffer_load_dwordx4 v31, s[4:7], s58 offen offset:2048 sc1 lds
    v_smfmac_f32_16x16x64_bf16 v[48:51], v[72:75], a[128:135], v1
    v_smfmac_f32_16x16x64_bf16 v[52:55], v[72:75], a[136:143], v1
    v_smfmac_f32_16x16x64_bf16 v[56:59], v[72:75], a[208:215], v1
    v_smfmac_f32_16x16x64_bf16 v[60:63], v[72:75], a[216:223], v1
    s_waitcnt vmcnt(4) lgkmcnt(0)
    v_smfmac_f32_16x16x64_bf16 v[48:51], v[76:79], v[128:135], v1
    ds_read_b128 v[128:131], v2 offset:24576
    s_barrier
    v_smfmac_f32_16x16x64_bf16 v[52:55], v[76:79], v[136:143], v1
    ds_read_b128 v[132:135], v2 offset:25600
    v_smfmac_f32_16x16x64_bf16 v[40:43], v[76:79], a[32:39], v1
    ds_read_b128 v[136:139], v2 offset:26624
    buffer_load_dwordx4 v[144:147], v3, s[4:7], s100 offen offset:0 sc1
    v_smfmac_f32_16x16x64_bf16 v[44:47], v[76:79], a[40:47], v1
    ds_read_b128 v[140:143], v2 offset:27648
    v_smfmac_f32_16x16x64_bf16 v[56:59], v[76:79], a[224:231], v1
    v_smfmac_f32_16x16x64_bf16 v[60:63], v[76:79], a[232:239], v1
    s_waitcnt vmcnt(3)
    v_smfmac_f32_16x16x64_bf16 v[48:51], v[64:67], a[96:103], v1
    buffer_load_dwordx4 v[148:151], v3, s[4:7], s100 offen offset:1024 sc1
    v_smfmac_f32_16x16x64_bf16 v[52:55], v[64:67], a[104:111], v1
    s_waitcnt lgkmcnt(2)
    v_smfmac_f32_16x16x64_bf16 v[40:43], v[64:67], v[128:135], v1
    s_waitcnt lgkmcnt(0)
    ds_read_b128 v[128:131], v2 offset:0
    v_smfmac_f32_16x16x64_bf16 v[44:47], v[64:67], v[136:143], v1
    ds_read_b128 v[132:135], v2 offset:1024
    v_smfmac_f32_16x16x64_bf16 v[56:59], v[64:67], a[192:199], v1
    ds_read_b128 v[136:139], v2 offset:2048
    buffer_load_dwordx4 v[12:15], v3, s[4:7], s101 offen offset:0 sc1
    v_smfmac_f32_16x16x64_bf16 v[60:63], v[64:67], a[200:207], v1
    s_waitcnt vmcnt(4)
    ds_read_b128 v[140:143], v2 offset:3072
    v_smfmac_f32_16x16x64_bf16 v[40:43], v[68:71], a[0:7], v1
    s_waitcnt vmcnt(3)
    s_barrier
    v_smfmac_f32_16x16x64_bf16 v[44:47], v[68:71], a[8:15], v1
    s_waitcnt lgkmcnt(2)
    ds_read_b128 v[80:83], v3 offset:4096
    v_smfmac_f32_16x16x64_bf16 v[56:59], v[68:71], v[128:135], v1
    s_waitcnt lgkmcnt(1)
    ds_read_b128 v[84:87], v3 offset:5120
    v_smfmac_f32_16x16x64_bf16 v[60:63], v[68:71], v[136:143], v1
    ds_read_b128 v[128:131], v2 offset:8192
    v_smfmac_f32_16x16x64_bf16 v[48:51], v[68:71], a[112:119], v1
    ds_read_b128 v[88:91], v3 offset:6144
    buffer_load_dwordx4 v[16:19], v3, s[4:7], s101 offen offset:1024 sc1
    v_smfmac_f32_16x16x64_bf16 v[52:55], v[68:71], a[120:127], v1
    s_waitcnt lgkmcnt(3)
    ds_read_b128 v[92:95], v3 offset:7168
    s_branch L_c1_j20
L_c1_pad4:
    s_branch L_c1_pad5
.p2align 5
L_c1_no2:
    buffer_load_dwordx4 v[72:75], v31, s[4:7], s57 offen offset:128 sc1
    s_nop 0
    s_nop 3
    v_mfma_f32_4x4x1_16b_f32 v[40:43], v23, v23, 0
    v_mfma_f32_4x4x1_16b_f32 v[44:47], v23, v23, 0
    s_nop 0
L_c1_c3:
    s_waitcnt vmcnt(4)
    v_cmp_eq_u32_e64 vcc, s12, v76
    v_smfmac_f32_16x16x64_bf16 v[40:43], v[76:79], a[32:39], v1
    v_smfmac_f32_16x16x64_bf16 v[44:47], v[76:79], a[40:47], v1
    s_cbranch_vccnz L_c1_no3
L_c1_go3:
    s_waitcnt lgkmcnt(0)
    buffer_load_dwordx4 v31, s[4:7], s58 offen offset:2048 sc1 lds
    v_smfmac_f32_16x16x64_bf16 v[48:51], v[76:79], v[128:135], v1
    ds_read_b128 v[128:131], v2 offset:24576
    v_smfmac_f32_16x16x64_bf16 v[52:55], v[76:79], v[136:143], v1
    ds_read_b128 v[132:135], v2 offset:25600
    v_smfmac_f32_16x16x64_bf16 v[56:59], v[76:79], a[224:231], v1
    ds_read_b128 v[136:139], v2 offset:26624
    v_smfmac_f32_16x16x64_bf16 v[60:63], v[76:79], a[232:239], v1
    s_waitcnt vmcnt(3)
    ds_read_b128 v[140:143], v2 offset:27648
    v_smfmac_f32_16x16x64_bf16 v[48:51], v[64:67], a[96:103], v1
    s_barrier
    v_smfmac_f32_16x16x64_bf16 v[52:55], v[64:67], a[104:111], v1
    v_smfmac_f32_16x16x64_bf16 v[56:59], v[64:67], a[192:199], v1
    buffer_load_dwordx4 v[144:147], v3, s[4:7], s100 offen offset:0 sc1
    v_smfmac_f32_16x16x64_bf16 v[60:63], v[64:67], a[200:207], v1
    s_waitcnt lgkmcnt(2)
    v_smfmac_f32_16x16x64_bf16 v[40:43], v[64:67], v[128:135], v1
    s_waitcnt lgkmcnt(0)
    ds_read_b128 v[128:131], v2 offset:0
    v_smfmac_f32_16x16x64_bf16 v[44:47], v[64:67], v[136:143], v1
    s_waitcnt vmcnt(3)
    ds_read_b128 v[132:135], v2 offset:1024
    v_smfmac_f32_16x16x64_bf16 v[40:43], v[68:71], a[0:7], v1
    ds_read_b128 v[136:139], v2 offset:2048
    buffer_load_dwordx4 v[148:151], v3, s[4:7], s100 offen offset:1024 sc1
    v_smfmac_f32_16x16x64_bf16 v[44:47], v[68:71], a[8:15], v1
    ds_read_b128 v[140:143], v2 offset:3072
    v_smfmac_f32_16x16x64_bf16 v[48:51], v[68:71], a[112:119], v1
    v_smfmac_f32_16x16x64_bf16 v[52:55], v[68:71], a[120:127], v1
    s_waitcnt lgkmcnt(2)
    v_smfmac_f32_16x16x64_bf16 v[56:59], v[68:71], v[128:135], v1
    s_waitcnt lgkmcnt(0)
    buffer_load_dwordx4 v[12:15], v3, s[4:7], s101 offen offset:0 sc1
    v_smfmac_f32_16x16x64_bf16 v[60:63], v[68:71], v[136:143], v1
    s_waitcnt vmcnt(4)
    v_smfmac_f32_16x16x64_bf16 v[40:43], v[72:75], a[16:23], v1
    s_waitcnt vmcnt(3)
    s_barrier
    v_smfmac_f32_16x16x64_bf16 v[44:47], v[72:75], a[24:31], v1
    ds_read_b128 v[80:83], v3 offset:4096
    v_smfmac_f32_16x16x64_bf16 v[48:51], v[72:75], a[128:135], v1
    ds_read_b128 v[84:87], v3 offset:5120
    v_smfmac_f32_16x16x64_bf16 v[52:55], v[72:75], a[136:143], v1
    ds_read_b128 v[128:131], v2 offset:8192
    v_smfmac_f32_16x16x64_bf16 v[56:59], v[72:75], a[208:215], v1
    ds_read_b128 v[88:91], v3 offset:6144
    buffer_load_dwordx4 v[16:19], v3, s[4:7], s101 offen offset:1024 sc1
    v_smfmac_f32_16x16x64_bf16 v[60:63], v[72:75], a[216:223], v1
    s_waitcnt lgkmcnt(3)
    ds_read_b128 v[92:95], v3 offset:7168
    s_branch L_c1_j20
L_c1_pad5:
    s_branch L_c1_pad6
.p2align 5
L_c1_no3:
    s_add_u32 s3, s3, 1
    s_cmp_gt_u32 s3, 262144
    s_cbranch_scc1 L_c1_go3
    buffer_load_dwordx4 v[76:79], v31, s[4:7], s57 offen offset:2176 sc1
    buffer_load_dwordx4 v31, s[4:7], s58 offen offset:2048 sc1 lds
    ds_read_b128 v[128:131], v2 offset:24576
    ds_read_b128 v[132:135], v2 offset:25600
    ds_read_b128 v[136:139], v2 offset:26624
    ds_read_b128 v[140:143], v2 offset:27648
    v_mfma_f32_4x4x1_16b_f32 v[40:43], v23, v23, 0
    v_mfma_f32_4x4x1_16b_f32 v[44:47], v23, v23, 0
    s_nop 0
    s_branch L_c1_c0
L_c1_nan:
    v_mov_b32 v20, 0
    v_max3_u32 v20, v20, v64, v65
    v_max3_u32 v20, v20, v66, v67
    v_max3_u32 v20, v20, v68, v69
    v_max3_u32 v20, v20, v70, v71
    v_max3_u32 v20, v20, v72, v73
    v_max3_u32 v20, v20, v74, v75
    v_max3_u32 v20, v20, v76, v77
    v_max3_u32 v20, v20, v78, v79
    v_max3_u32 v20, v20, v80, v81
    v_max3_u32 v20, v20, v82, v83
    v_max3_u32 v20, v20, v84, v85
    v_max3_u32 v20, v20, v86, v87
    v_max3_u32 v20, v20, v88, v89
    v_max3_u32 v20, v20, v90, v91
    v_max3_u32 v20, v20, v92, v93
    v_max3_u32 v20, v20, v94, v95
    v_cmp_eq_u32 vcc, s12, v20
    s_cbranch_vccz L_c1_nanok
L_c1_nanl:
    buffer_load_dwordx4 v[64:67], v31, s[4:7], s57 offen offset:0 sc1
    buffer_load_dwordx4 v[68:71], v31, s[4:7], s57 offen offset:2048 sc1
    buffer_load_dwordx4 v[72:75], v31, s[4:7], s57 offen offset:128 sc1
    buffer_load_dwordx4 v[76:79], v31, s[4:7], s57 offen offset:2176 sc1
    buffer_load_dwordx4 v[80:83], v31, s[4:7], s58 offen offset:0 sc1
    buffer_load_dwordx4 v[84:87], v31, s[4:7], s58 offen offset:2048 sc1
    buffer_load_dwordx4 v[88:91], v31, s[4:7], s58 offen offset:128 sc1
    buffer_load_dwordx4 v[92:95], v31, s[4:7], s58 offen offset:2176 sc1
    s_waitcnt vmcnt(0)
    v_mov_b32 v20, 0
    v_max3_u32 v20, v20, v64, v65
    v_max3_u32 v20, v20, v66, v67
    v_max3_u32 v20, v20, v68, v69
    v_max3_u32 v20, v20, v70, v71
    v_max3_u32 v20, v20, v72, v73
    v_max3_u32 v20, v20, v74, v75
    v_max3_u32 v20, v20, v76, v77
    v_max3_u32 v20, v20, v78, v79
    v_max3_u32 v20, v20, v80, v81
    v_max3_u32 v20, v20, v82, v83
    v_max3_u32 v20, v20, v84, v85
    v_max3_u32 v20, v20, v86, v87
    v_max3_u32 v20, v20, v88, v89
    v_max3_u32 v20, v20, v90, v91
    v_max3_u32 v20, v20, v92, v93
    v_max3_u32 v20, v20, v94, v95
    v_cmp_eq_u32 vcc, s12, v20
    s_cbranch_vccz L_c1_nanr
    s_add_u32 s3, s3, 1
    s_cmp_gt_u32 s3, 262144
    s_cbranch_scc1 L_c1_nanr
    s_branch L_c1_nanl
L_c1_nanr:
    s_waitcnt lgkmcnt(0)
    v_mov_b64 v[40:41], 0
    v_mov_b64 v[42:43], 0
    v_mov_b64 v[44:45], 0
    v_mov_b64 v[46:47], 0
    v_mov_b64 v[48:49], 0
    v_mov_b64 v[50:51], 0
    v_mov_b64 v[52:53], 0
    v_mov_b64 v[54:55], 0
    v_mov_b64 v[56:57], 0
    v_mov_b64 v[58:59], 0
    v_mov_b64 v[60:61], 0
    v_mov_b64 v[62:63], 0
    ds_read_b128 v[128:131], v2 offset:24576
    ds_read_b128 v[132:135], v2 offset:25600
    ds_read_b128 v[136:139], v2 offset:26624
    ds_read_b128 v[140:143], v2 offset:27648
    s_waitcnt lgkmcnt(0)
    v_smfmac_f32_16x16x64_bf16 v[40:43], v[64:67], v[128:135], v1
    v_smfmac_f32_16x16x64_bf16 v[44:47], v[64:67], v[136:143], v1
    v_smfmac_f32_16x16x64_bf16 v[48:51], v[64:67], a[96:103], v1
    v_smfmac_f32_16x16x64_bf16 v[52:55], v[64:67], a[104:111], v1
    v_smfmac_f32_16x16x64_bf16 v[56:59], v[64:67], a[192:199], v1
    v_smfmac_f32_16x16x64_bf16 v[60:63], v[64:67], a[200:207], v1
    v_smfmac_f32_16x16x64_bf16 v[40:43], v[68:71], a[0:7], v1
    v_smfmac_f32_16x16x64_bf16 v[44:47], v[68:71], a[8:15], v1
    v_smfmac_f32_16x16x64_bf16 v[48:51], v[68:71], a[112:119], v1
    v_smfmac_f32_16x16x64_bf16 v[52:55], v[68:71], a[120:127], v1
    ds_read_b128 v[128:131], v2 offset:0
    ds_read_b128 v[132:135], v2 offset:1024
    ds_read_b128 v[136:139], v2 offset:2048
    ds_read_b128 v[140:143], v2 offset:3072
    s_waitcnt lgkmcnt(0)
    v_smfmac_f32_16x16x64_bf16 v[56:59], v[68:71], v[128:135], v1
    v_smfmac_f32_16x16x64_bf16 v[60:63], v[68:71], v[136:143], v1
    v_smfmac_f32_16x16x64_bf16 v[40:43], v[72:75], a[16:23], v1
    v_smfmac_f32_16x16x64_bf16 v[44:47], v[72:75], a[24:31], v1
    v_smfmac_f32_16x16x64_bf16 v[48:51], v[72:75], a[128:135], v1
    v_smfmac_f32_16x16x64_bf16 v[52:55], v[72:75], a[136:143], v1
    v_smfmac_f32_16x16x64_bf16 v[56:59], v[72:75], a[208:215], v1
    v_smfmac_f32_16x16x64_bf16 v[60:63], v[72:75], a[216:223], v1
    v_smfmac_f32_16x16x64_bf16 v[40:43], v[76:79], a[32:39], v1
    v_smfmac_f32_16x16x64_bf16 v[44:47], v[76:79], a[40:47], v1
    ds_read_b128 v[128:131], v2 offset:4096
    ds_read_b128 v[132:135], v2 offset:5120
    ds_read_b128 v[136:139], v2 offset:6144
    ds_read_b128 v[140:143], v2 offset:7168
    s_waitcnt lgkmcnt(0)
    v_smfmac_f32_16x16x64_bf16 v[48:51], v[76:79], v[128:135], v1
    v_smfmac_f32_16x16x64_bf16 v[52:55], v[76:79], v[136:143], v1
    v_smfmac_f32_16x16x64_bf16 v[56:59], v[76:79], a[224:231], v1
    v_smfmac_f32_16x16x64_bf16 v[60:63], v[76:79], a[232:239], v1
    v_smfmac_f32_16x16x64_bf16 v[40:43], v[80:83], a[48:55], v1
    v_smfmac_f32_16x16x64_bf16 v[40:43], v[84:87], a[64:71], v1
    v_smfmac_f32_16x16x64_bf16 v[44:47], v[80:83], a[56:63], v1
    v_smfmac_f32_16x16x64_bf16 v[44:47], v[84:87], a[72:79], v1
    v_smfmac_f32_16x16x64_bf16 v[40:43], v[88:91], a[80:87], v1
    ds_read_b128 v[128:131], v2 offset:8192
    ds_read_b128 v[132:135], v2 offset:9216
    ds_read_b128 v[136:139], v2 offset:10240
    ds_read_b128 v[140:143], v2 offset:11264
    s_waitcnt lgkmcnt(0)
    v_smfmac_f32_16x16x64_bf16 v[40:43], v[92:95], v[128:135], v1
    v_smfmac_f32_16x16x64_bf16 v[44:47], v[88:91], a[88:95], v1
    v_smfmac_f32_16x16x64_bf16 v[44:47], v[92:95], v[136:143], v1
    v_smfmac_f32_16x16x64_bf16 v[48:51], v[80:83], a[144:151], v1
    v_smfmac_f32_16x16x64_bf16 v[48:51], v[84:87], a[160:167], v1
    v_smfmac_f32_16x16x64_bf16 v[48:51], v[88:91], a[176:183], v1
    ds_read_b128 v[128:131], v2 offset:20480
    ds_read_b128 v[132:135], v2 offset:21504
    ds_read_b128 v[136:139], v2 offset:22528
    ds_read_b128 v[140:143], v2 offset:23552
    s_waitcnt lgkmcnt(0)
    v_smfmac_f32_16x16x64_bf16 v[48:51], v[92:95], v[128:135], v1
    v_smfmac_f32_16x16x64_bf16 v[52:55], v[80:83], a[152:159], v1
    v_smfmac_f32_16x16x64_bf16 v[52:55], v[84:87], a[168:175], v1
    v_smfmac_f32_16x16x64_bf16 v[52:55], v[88:91], a[184:191], v1
    v_smfmac_f32_16x16x64_bf16 v[52:55], v[92:95], v[136:143], v1
    ds_read_b128 v[128:131], v2 offset:28672
    ds_read_b128 v[132:135], v2 offset:29696
    v_add_f32 v40, v40, v42
    v_add_f32 v41, v41, v43
    v_add_f32 v44, v44, v46
    v_add_f32 v45, v45, v47
    v_cvt_pk_bf16_f32 v42, v40, v44
    v_cvt_pk_bf16_f32 v43, v41, v45
    ds_write_b32 v6, v42
    ds_write_b32 v6, v43 offset:16
    v_add_f32 v48, v48, v50
    v_add_f32 v49, v49, v51
    s_waitcnt lgkmcnt(0)
    s_branch L_c1_nanok
L_c1_pad6:
    s_branch L_c_warm1
L_c1_done:
    buffer_store_dwordx4 v[52:55], v3, s[4:7], s61 offen sc1
    s_waitcnt vmcnt(0)
    s_endpgm
L_c_w2:
    v_and_b32 v56, 15, v0
    v_and_b32 v57, 1, v0
    v_mov_b32 v35, v8
    v_mov_b32 v39, v9
    v_lshlrev_b32 v57, 4, v57
    v_mov_b32 v58, 0x3f80
    v_lshlrev_b32 v57, v57, v58
    v_lshrrev_b32 v56, 1, v56
    v_cmp_eq_u32 vcc, 0, v56
    s_nop 1
    v_cndmask_b32 v8, 0, v57, vcc
    v_cmp_eq_u32 vcc, 2, v56
    s_nop 1
    v_cndmask_b32 v9, 0, v57, vcc
    v_cmp_eq_u32 vcc, 1, v56
    s_nop 1
    v_cndmask_b32 v10, 0, v57, vcc
    v_cmp_eq_u32 vcc, 3, v56
    s_nop 1
    v_cndmask_b32 v11, 0, v57, vcc
    v_mov_b64 v[56:57], 0
    v_mov_b64 v[58:59], 0
    v_mov_b64 v[60:61], 0
    v_mov_b64 v[62:63], 0
    s_waitcnt vmcnt(0)
    ds_write_b128 v3, v[144:147] offset:0
    ds_write_b128 v3, v[148:151] offset:1024
    v_mov_b64 v[24:25], v[12:13]
    v_mov_b64 v[28:29], v[14:15]
    v_mov_b64 v[32:33], v[16:17]
    v_mov_b64 v[36:37], v[18:19]
    s_waitcnt lgkmcnt(0)
    s_barrier
    ds_read_b128 v[96:99], v3 offset:6144
    ds_read_b128 v[100:103], v3 offset:7168
    ds_read_b128 v[104:107], v3 offset:4096
    ds_read_b128 v[108:111], v3 offset:5120
    ds_read_b128 v[112:115], v3 offset:0
    ds_read_b128 v[116:119], v3 offset:1024
    ds_read_b128 v[120:123], v3 offset:2048
    ds_read_b128 v[124:127], v3 offset:3072
    ds_read_b128 v[128:131], v2 offset:24576
    ds_read_b128 v[132:135], v2 offset:25600
    ds_read_b128 v[136:139], v2 offset:26624
    ds_read_b128 v[140:143], v2 offset:27648
    s_add_u32 s60, s60, 524288
    s_add_u32 s100, s60, 4096
    s_add_u32 s101, s60, 12288
    s_waitcnt lgkmcnt(0)
    s_branch L_c2_top
L_c2_pad0:
    s_branch L_c2_pad1
.p2align 5
L_c2_top:
    s_barrier
L_c2_again:
    buffer_load_dwordx4 v[64:67], v31, s[4:7], s57 offen offset:0 sc1
    s_mov_b32 m0, 161664
    v_mov_b64 v[20:21], s[12:13]
    v_mfma_f32_4x4x1_16b_f32 v[60:63], v23, v23, 0
    s_nop 12
    s_nop 1
    buffer_load_dwordx4 v[68:71], v31, s[4:7], s57 offen offset:2048 sc1
    s_nop 15
    s_nop 1
    buffer_load_dwordx4 v[72:75], v31, s[4:7], s57 offen offset:128 sc1
    s_nop 15
    s_nop 1
    buffer_load_dwordx4 v[76:79], v31, s[4:7], s57 offen offset:2176 sc1
    buffer_load_dwordx4 v31, s[4:7], s58 offen offset:128 sc1 lds
L_c2_c0:
    s_waitcnt vmcnt(4) lgkmcnt(0)
    v_cmp_eq_u32 vcc, s12, v64
    v_smfmac_f32_16x16x64_bf16 v[40:43], v[64:67], v[128:135], v1
    v_smfmac_f32_16x16x64_bf16 v[44:47], v[64:67], v[136:143], v1
    s_cbranch_vccnz L_c2_no0
L_c2_go0:
    v_smfmac_f32_16x16x64_bf16 v[56:59], v[64:67], a[192:199], v1
    ds_read_b128 v[128:131], v2 offset:0
    v_smfmac_f32_16x16x64_bf16 v[60:63], v[64:67], a[200:207], v1
    ds_read_b128 v[132:135], v2 offset:1024
    v_smfmac_f32_16x16x64_bf16 v[52:55], v[64:67], a[104:111], v1
    ds_read_b128 v[136:139], v2 offset:2048
    v_smfmac_f32_16x16x64_bf16 v[48:51], v[64:67], a[96:103], v1
    s_waitcnt vmcnt(3)
    ds_read_b128 v[140:143], v2 offset:3072
    v_smfmac_f32_16x16x64_bf16 v[48:51], v[68:71], a[112:119], v1
    buffer_store_dwordx2 v[20:21], v5, s[4:7], s72 offen
    s_barrier
    v_smfmac_f32_16x16x64_bf16 v[40:43], v[68:71], a[0:7], v1
    v_smfmac_f32_16x16x64_bf16 v[44:47], v[68:71], a[8:15], v1
    v_smfmac_f32_16x16x64_bf16 v[52:55], v[68:71], a[120:127], v1
    s_waitcnt lgkmcnt(0)
    buffer_load_dwordx4 v[144:147], v3, s[4:7], s100 offen offset:0 sc1
    v_smfmac_f32_16x16x64_bf16 v[56:59], v[68:71], v[128:135], v1
    ds_read_b128 v[128:131], v2 offset:4096
    v_smfmac_f32_16x16x64_bf16 v[60:63], v[68:71], v[136:143], v1
    s_waitcnt vmcnt(4)
    ds_read_b128 v[132:135], v2 offset:5120
    v_smfmac_f32_16x16x64_bf16 v[60:63], v[72:75], a[216:223], v1
    ds_read_b128 v[136:139], v2 offset:6144
    v_smfmac_f32_16x16x64_bf16 v[56:59], v[72:75], a[208:215], v1
    ds_read_b128 v[140:143], v2 offset:7168
    buffer_load_dwordx4 v[148:151], v3, s[4:7], s100 offen offset:1024 sc1
    v_smfmac_f32_16x16x64_bf16 v[52:55], v[72:75], a[136:143], v1
    v_smfmac_f32_16x16x64_bf16 v[40:43], v[72:75], a[16:23], v1
    v_smfmac_f32_16x16x64_bf16 v[44:47], v[72:75], a[24:31], v1
    v_smfmac_f32_16x16x64_bf16 v[48:51], v[72:75], a[128:135], v1
    s_waitcnt lgkmcnt(0)
    s_waitcnt vmcnt(4)
    v_smfmac_f32_16x16x64_bf16 v[48:51], v[76:79], v[128:135], v1
    s_waitcnt vmcnt(3)
    s_barrier
    v_smfmac_f32_16x16x64_bf16 v[56:59], v[76:79], a[224:231], v1
    ds_read_b128 v[80:83], v3 offset:4096
    buffer_load_dwordx4 v[12:15], v3, s[4:7], s101 offen offset:0 sc1
    v_smfmac_f32_16x16x64_bf16 v[60:63], v[76:79], a[232:239], v1
    ds_read_b128 v[84:87], v3 offset:5120
    v_smfmac_f32_16x16x64_bf16 v[52:55], v[76:79], v[136:143], v1
    ds_read_b128 v[128:131], v2 offset:8192
    v_smfmac_f32_16x16x64_bf16 v[44:47], v[76:79], a[40:47], v1
    ds_read_b128 v[88:91], v3 offset:6144
    v_smfmac_f32_16x16x64_bf16 v[40:43], v[76:79], a[32:39], v1
    s_waitcnt lgkmcnt(3)
    ds_read_b128 v[92:95], v3 offset:7168
    buffer_load_dwordx4 v[16:19], v3, s[4:7], s101 offen offset:1024 sc1
L_c2_j20:
    v_smfmac_f32_16x16x64_bf16 v[40:43], v[80:83], a[48:55], v1
    s_waitcnt lgkmcnt(3)
    ds_read_b128 v[132:135], v2 offset:9216
    v_smfmac_f32_16x16x64_bf16 v[40:43], v[84:87], a[64:71], v1
    ds_read_b128 v[136:139], v2 offset:10240
    v_smfmac_f32_16x16x64_bf16 v[44:47], v[80:83], a[56:63], v1
    ds_read_b128 v[140:143], v2 offset:11264
    v_smfmac_f32_16x16x64_bf16 v[44:47], v[84:87], a[72:79], v1
    s_waitcnt lgkmcnt(3)
    v_smfmac_f32_16x16x64_bf16 v[40:43], v[88:91], a[80:87], v1
    s_waitcnt lgkmcnt(2)
    v_smfmac_f32_16x16x64_bf16 v[40:43], v[92:95], v[128:135], v1
    ds_read_b128 v[128:131], v2 offset:20480
    v_smfmac_f32_16x16x64_bf16 v[44:47], v[88:91], a[88:95], v1
    s_waitcnt lgkmcnt(1)
    ds_read_b128 v[132:135], v2 offset:21504
    v_smfmac_f32_16x16x64_bf16 v[44:47], v[92:95], v[136:143], v1
    ds_read_b128 v[136:139], v2 offset:22528
    v_add_f32_e64 v40, v40, v42
    v_smfmac_f32_16x16x64_bf16 v[48:51], v[80:83], a[144:151], v1
    ds_read_b128 v[140:143], v2 offset:23552
    v_add_f32 v41, v41, v43
    v_smfmac_f32_16x16x64_bf16 v[48:51], v[84:87], a[160:167], v1
    v_add_f32 v44, v44, v46
    v_add_f32 v45, v45, v47
    v_smfmac_f32_16x16x64_bf16 v[48:51], v[88:91], a[176:183], v1
    s_waitcnt lgkmcnt(2)
    v_cvt_pk_bf16_f32 v42, v40, v44
    v_smfmac_f32_16x16x64_bf16 v[48:51], v[92:95], v[128:135], v1
    ds_write_b32 v6, v42
    v_cvt_pk_bf16_f32 v43, v41, v45
    v_smfmac_f32_16x16x64_bf16 v[52:55], v[80:83], a[152:159], v1
    ds_write_b32 v6, v43 offset:16
    v_cmp_u_f32 vcc, v40, v41
    v_smfmac_f32_16x16x64_bf16 v[52:55], v[84:87], a[168:175], v1
    ds_read_b128 v[128:131], v2 offset:28672
    v_add_f32 v48, v48, v50
    v_smfmac_f32_16x16x64_bf16 v[52:55], v[88:91], a[184:191], v1
    s_waitcnt lgkmcnt(3)
    ds_read_b128 v[132:135], v2 offset:29696
    v_add_f32_e64 v49, v49, v51
    v_smfmac_f32_16x16x64_bf16 v[52:55], v[92:95], v[136:143], v1
    s_cbranch_vccnz L_c2_nan
L_c2_nanok:
    ds_read_b128 v[136:139], v2 offset:30720
    v_smfmac_f32_16x16x64_bf16 v[56:59], v[80:83], a[240:247], v1
    s_waitcnt lgkmcnt(3) vmcnt(4)
    s_barrier
    v_smfmac_f32_16x16x64_bf16 v[56:59], v[84:87], v[152:159], v1
    ds_read_b128 v[64:67], v7 offset:0
    v_add_f32 v52, v52, v54
    v_smfmac_f32_16x16x64_bf16 v[56:59], v[88:91], v[168:175], v1
    s_waitcnt lgkmcnt(2)
    ds_read_b128 v[140:143], v2 offset:31744
    v_add_f32_e64 v53, v53, v55
    v_smfmac_f32_16x16x64_bf16 v[56:59], v[92:95], v[128:135], v1
    ds_read_b128 v[68:71], v7 offset:1024
    v_cvt_pk_bf16_f32 v52, v48, v52
    v_smfmac_f32_16x16x64_bf16 v[60:63], v[80:83], a[248:255], v1
    ds_write_b32 v6, v52 offset:512
    v_cvt_pk_bf16_f32 v53, v49, v53
    v_smfmac_f32_16x16x64_bf16 v[60:63], v[84:87], v[160:167], v1
    ds_write_b32 v6, v53 offset:528
    v_add_f32 v56, v56, v58
    v_smfmac_f32_16x16x64_bf16 v[60:63], v[88:91], v[176:183], v1
    s_waitcnt lgkmcnt(3)
    ds_read_b128 v[72:75], v7 offset:2048
    v_add_f32 v57, v57, v59
    v_smfmac_f32_16x16x64_bf16 v[60:63], v[92:95], v[136:143], v1
    s_waitcnt lgkmcnt(3)
    ds_read_b128 v[76:79], v7 offset:3072
    v_cvt_pk_bf16_f32 v26, v56, v57
    v_mfma_f32_16x16x32_bf16 v[40:43], v[96:99], v[64:67], 0
    s_cmp_eq_u32 s51, 63
    v_cvt_pk_bf16_f32 v54, v56, v57
    v_mfma_f32_16x16x32_bf16 v[40:43], v[100:103], v[68:71], v[40:43]
    s_waitcnt lgkmcnt(1)
    s_barrier
    v_mfma_f32_16x16x32_bf16 v[40:43], v[104:107], v[72:75], v[40:43]
    s_waitcnt lgkmcnt(0)
    ds_read_b128 v[80:83], v35 offset:0
    v_add_f32_e64 v60, v60, v62
    v_mfma_f32_16x16x32_bf16 v[40:43], v[108:111], v[76:79], v[40:43]
    ds_read_b128 v[84:87], v35 offset:1024
    v_add_f32_e64 v61, v61, v63
    v_mfma_f32_16x16x32_bf16 v[44:47], v[112:115], v[64:67], 0
    ds_read_b128 v[88:91], v35 offset:2048
    v_cvt_pk_bf16_f32 v34, v60, v61
    v_mfma_f32_16x16x32_bf16 v[44:47], v[116:119], v[68:71], v[44:47]
    ds_read_b128 v[92:95], v35 offset:3072
    v_cvt_pk_bf16_f32 v55, v60, v61
    v_mfma_f32_16x16x32_bf16 v[44:47], v[120:123], v[72:75], v[44:47]
    v_permlane16_swap_b32 v26, v30
    v_mfma_f32_16x16x32_bf16 v[44:47], v[124:127], v[76:79], v[44:47]
    s_waitcnt lgkmcnt(2)
    v_permlane16_swap_b32 v34, v38
    v_mfma_f32_16x16x32_bf16 v[48:51], v[80:83], v[64:67], 0
    s_cbranch_scc1 L_c2_done
    v_mov_b64 v[56:57], 0
    v_mov_b64 v[58:59], 0
    v_mfma_f32_16x16x32_bf16 v[48:51], v[84:87], v[68:71], v[48:51]
    s_waitcnt lgkmcnt(0)
    v_cndmask_b32 v40, v40, v44, s[66:67]
    v_cndmask_b32 v41, v41, v45, s[66:67]
    v_mfma_f32_16x16x32_bf16 v[48:51], v[88:91], v[72:75], v[48:51]
    v_cndmask_b32 v42, v42, v46, s[66:67]
    v_cndmask_b32 v43, v43, v47, s[66:67]
    v_mfma_f32_16x16x32_bf16 v[48:51], v[92:95], v[76:79], v[48:51]
    v_max3_f32 v44, v40, v41, v42
    v_max_f32 v44, v44, v43
    v_mov_b64 v[60:61], 0
    v_mov_b64 v[62:63], 0
    v_max_f32_dpp v44, v44, v44 quad_perm:[2,3,0,1] row_mask:0xf bank_mask:0xf
    v_mov_b32 v45, v44
    v_mov_b64 v[96:97], s[70:71]
    v_max3_f32 v46, v48, v49, v50
    v_permlane16_swap_b32 v44, v45
    v_max3_f32 v44, v44, v45, v51
    v_max_f32 v45, v44, v46
    v_max_f32 v44, v44, v46
    v_cndmask_b32 v48, v48, v49, s[66:67]
    v_mov_b64 v[98:99], s[70:71]
    v_permlane32_swap_b32 v44, v45
    v_max_f32 v44, v44, v45
    v_mul_f32_e64 v44, s63, v44
    v_pk_fma_f32 v[40:41], v[40:41], s[62:63], v[44:45] op_sel_hi:[1,1,0] neg_lo:[0,0,1] neg_hi:[0,0,1]
    v_pk_fma_f32 v[42:43], v[42:43], s[62:63], v[44:45] op_sel_hi:[1,1,0] neg_lo:[0,0,1] neg_hi:[0,0,1]
    v_fma_f32 v48, v48, s63, -v44
    v_exp_f32 v40, v40
    v_exp_f32 v41, v41
    v_exp_f32 v42, v42
    v_cvt_pk_bf16_f32 v20, v40, v41
    v_exp_f32 v43, v43
    v_exp_f32 v48, v48
    v_cvt_pk_bf16_f32 v22, v42, v43
    v_cvt_pk_bf16_f32 v21, v48, v23
    s_nop 1
    v_mfma_f32_16x16x32_bf16 v[44:47], v[20:23], v[96:99], 0
    v_smfmac_f32_16x16x64_bf16 v[56:59], v[20:23], v[24:31], v1 abid:1
    ds_read_b128 v[128:131], v2 offset:12288
    v_smfmac_f32_16x16x64_bf16 v[60:63], v[20:23], v[32:39], v1 abid:1
    ds_read_b128 v[132:135], v2 offset:13312
    v_add_f32 v44, v44, v46
    v_add_f32 v45, v45, v47
    v_rcp_f32 v44, v44
    v_rcp_f32 v45, v45
    v_pk_add_f32 v[56:57], v[56:57], v[58:59]
    v_pk_mul_f32 v[56:57], v[56:57], v[44:45]
    v_pk_add_f32 v[60:61], v[60:61], v[62:63]
    v_pk_mul_f32 v[60:61], v[60:61], v[44:45]
    v_cvt_pk_bf16_f32 v58, v56, v60
    v_cvt_pk_bf16_f32 v59, v57, v61
    v_mfma_f32_4x4x1_16b_f32 v[80:83], v23, v23, 0
    ds_write2_b32 v39, v58, v59 offset0:0 offset1:4
    v_mfma_f32_16x16x1_4b_f32 v[64:79], v23, v23, 0
    s_and_b32 s56, s51, 1
    s_add_u32 s51, s51, 1
    s_lshl_b32 s47, s56, 13
    s_sub_u32 s57, 3153920, s47
    s_add_u32 s58, s57, 4096
    s_add_u32 s72, s47, 3145728
    s_xor_b32 s59, s72, 8192
    buffer_store_dwordx4 v[52:55], v3, s[4:7], s61 offen nt
    s_waitcnt lgkmcnt(0)
    s_barrier
    ds_read_b128 v[40:43], v3 offset:4096
    v_mfma_f32_4x4x1_16b_f32 v[84:87], v23, v23, 0
    ds_read_b128 v[44:47], v3 offset:5120
    v_mfma_f32_4x4x1_16b_f32 v[88:91], v23, v23, 0
    v_mfma_f32_4x4x1_16b_f32 v[92:95], v23, v23, 0
    ds_read_b128 v[136:139], v2 offset:14336
    s_waitcnt lgkmcnt(2)
    v_smfmac_f32_16x16x64_bf16 v[64:67], v[40:43], v[184:191], v1
    ds_read_b128 v[140:143], v2 offset:15360
    v_smfmac_f32_16x16x64_bf16 v[68:71], v[40:43], v[200:207], v1
    s_waitcnt lgkmcnt(2)
    ds_read_b128 v[104:107], v2 offset:32768
    v_smfmac_f32_16x16x64_bf16 v[64:67], v[44:47], v[192:199], v1
    ds_read_b128 v[108:111], v2 offset:33792
    v_smfmac_f32_16x16x64_bf16 v[68:71], v[44:47], v[208:215], v1
    ds_read_b128 v[112:115], v2 offset:34816
    ds_read_b128 v[116:119], v2 offset:35840
    v_smfmac_f32_16x16x64_bf16 v[72:75], v[40:43], v[216:223], v1
    ds_read_b128 v[120:123], v2 offset:16384
    v_add_f32 v64, v64, v66
    v_add_f32 v65, v65, v67
    v_smfmac_f32_16x16x64_bf16 v[72:75], v[44:47], v[224:231], v1
    ds_read_b128 v[124:127], v2 offset:17408
    v_add_f32 v68, v68, v70
    v_add_f32_e64 v69, v69, v71
    v_smfmac_f32_16x16x64_bf16 v[76:79], v[40:43], v[232:239], v1
    ds_read_b128 v[96:99], v2 offset:18432
    v_cvt_pk_bf16_f32 v48, v64, v68
    v_cvt_pk_bf16_f32 v49, v65, v69
    v_bfi_b32 v48, 1, s56, v48
    v_smfmac_f32_16x16x64_bf16 v[76:79], v[44:47], v[240:247], v1
    buffer_store_dwordx2 v[48:49], v4, s[4:7], s52 offen offset:0
    v_add_f32 v72, v72, v74
    v_smfmac_f32_16x16x64_bf16 v[80:83], v[40:43], v[248:255], v1
    s_waitcnt lgkmcnt(5)
    ds_read_b128 v[100:103], v2 offset:19456
    v_add_f32_e64 v73, v73, v75
    v_smfmac_f32_16x16x64_bf16 v[80:83], v[44:47], v[128:135], v1
    ds_read_b128 v[128:131], v2 offset:36864
    v_add_f32 v76, v76, v78
    v_add_f32 v77, v77, v79
    v_smfmac_f32_16x16x64_bf16 v[84:87], v[40:43], v[136:143], v1
    ds_read_b128 v[132:135], v2 offset:37888
    v_cvt_pk_bf16_f32 v50, v72, v76
    v_cvt_pk_bf16_f32 v51, v73, v77
    v_bfi_b32 v50, 1, s56, v50
    v_smfmac_f32_16x16x64_bf16 v[84:87], v[44:47], v[104:111], v1
    s_waitcnt lgkmcnt(4)
    buffer_store_dwordx2 v[50:51], v4, s[4:7], s52 offen offset:64
    v_add_f32 v80, v80, v82
    v_smfmac_f32_16x16x64_bf16 v[88:91], v[40:43], v[112:119], v1
    v_add_f32 v81, v81, v83
    v_smfmac_f32_16x16x64_bf16 v[88:91], v[44:47], v[120:127], v1
    s_waitcnt lgkmcnt(2)
    v_add_f32 v84, v84, v86
    v_add_f32 v85, v85, v87
    v_smfmac_f32_16x16x64_bf16 v[92:95], v[40:43], v[96:103], v1
    s_waitcnt lgkmcnt(0)
    v_cvt_pk_bf16_f32 v56, v80, v84
    v_cvt_pk_bf16_f32 v57, v81, v85
    v_bfi_b32 v56, 1, s56, v56
    v_smfmac_f32_16x16x64_bf16 v[92:95], v[44:47], v[128:135], v1
    buffer_store_dwordx2 v[56:57], v4, s[4:7], s53 offen offset:0
    v_add_f32 v88, v88, v90
    v_add_f32 v89, v89, v91
    s_nop 3
    v_add_f32 v92, v92, v94
    v_add_f32 v93, v93, v95
    v_cvt_pk_bf16_f32 v58, v88, v92
    v_cvt_pk_bf16_f32 v59, v89, v93
    v_bfi_b32 v58, 1, s56, v58
    buffer_store_dwordx2 v[58:59], v4, s[4:7], s53 offen offset:64
    s_waitcnt vmcnt(4)
    ds_write_b128 v3, v[144:147] offset:0
    ds_write_b128 v3, v[148:151] offset:1024
    s_barrier
    s_nop 15
    s_nop 1
    buffer_load_dwordx4 v[80:83], v3, s[4:7], s54 offen offset:0 sc1
    buffer_load_dwordx4 v[84:87], v3, s[4:7], s54 offen offset:1024 sc1
    buffer_load_dwordx4 v[88:91], v3, s[4:7], s54 offen offset:2048 sc1
    buffer_load_dwordx4 v[92:95], v3, s[4:7], s54 offen offset:3072 sc1
    s_waitcnt lgkmcnt(0)
    s_barrier
    buffer_load_dwordx4 v[64:67], v3, s[4:7], s54 offen offset:0 sc1
    buffer_load_dwordx4 v[68:71], v3, s[4:7], s54 offen offset:1024 sc1
    buffer_load_dwordx4 v[72:75], v3, s[4:7], s54 offen offset:2048 sc1
    buffer_load_dwordx4 v[76:79], v3, s[4:7], s54 offen offset:3072 sc1
    s_add_u32 s60, s60, 524288
    s_cmp_eq_u32 s51, 63
    s_cselect_b32 s60, 0x40000000, s60
    s_add_u32 s100, s60, 4096
    s_add_u32 s101, s60, 12288
    s_add_u32 s61, s61, 131072
    ds_read_b128 v[128:131], v2 offset:24576
    ds_read_b128 v[132:135], v2 offset:25600
    ds_read_b128 v[136:139], v2 offset:26624
    ds_read_b128 v[140:143], v2 offset:27648
    v_mfma_f32_4x4x1_16b_f32 v[40:43], v23, v23, 0
    v_mfma_f32_4x4x1_16b_f32 v[44:47], v23, v23, 0
    v_mfma_f32_4x4x1_16b_f32 v[48:51], v23, v23, 0
    ds_read_b128 v[96:99], v3 offset:6144
    ds_read_b128 v[100:103], v3 offset:7168
    ds_read_b128 v[104:107], v3 offset:4096
    ds_read_b128 v[108:111], v3 offset:5120
    ds_read_b128 v[112:115], v3 offset:0
    ds_read_b128 v[116:119], v3 offset:1024
    ds_read_b128 v[120:123], v3 offset:2048
    ds_read_b128 v[124:127], v3 offset:3072
L_c2_ra:
    s_waitcnt vmcnt(7)
    v_mfma_f32_16x16x32_bf16 v[60:63], v[8:11], v[80:83], 0
    v_xor_b32 v20, s56, v80
    v_bitop3_b32 v20, v20, v82, s56 bitop3:0xf6
    s_waitcnt vmcnt(6)
    v_mfma_f32_16x16x32_bf16 v[60:63], v[8:11], v[84:87], v[60:63]
    v_bitop3_b32 v20, v20, v84, s56 bitop3:0xf6
    v_bitop3_b32 v20, v20, v86, s56 bitop3:0xf6
    s_waitcnt vmcnt(5)
    v_mfma_f32_16x16x32_bf16 v[60:63], v[8:11], v[88:91], v[60:63]
    v_bitop3_b32 v20, v20, v88, s56 bitop3:0xf6
    v_bitop3_b32 v20, v20, v90, s56 bitop3:0xf6
    s_waitcnt vmcnt(4)
    v_mfma_f32_16x16x32_bf16 v[60:63], v[8:11], v[92:95], v[60:63]
    v_bitop3_b32 v20, v20, v92, s56 bitop3:0xf6
    v_bitop3_b32 v20, v20, v94, s56 bitop3:0xf6
    v_and_b32 v20, 1, v20
    v_cmp_eq_u32 vcc, 1, v20
    s_nop 2
    v_add_f32_dpp v80, v60, v60 row_ror:8 row_mask:0xf bank_mask:0xf
    v_add_f32_dpp v81, v61, v61 row_ror:8 row_mask:0xf bank_mask:0xf
    v_add_f32_dpp v82, v62, v62 row_ror:8 row_mask:0xf bank_mask:0xf
    v_add_f32_dpp v83, v63, v63 row_ror:8 row_mask:0xf bank_mask:0xf
    v_cvt_pk_bf16_f32 v84, v80, v81
    v_cvt_pk_bf16_f32 v85, v82, v83
    s_cbranch_vccnz L_c2_rano
L_c2_raok:
    buffer_store_dwordx2 v[84:85], v5, s[4:7], s59 offen
L_c2_rdone:
    v_mov_b64 v[24:25], v[12:13]
    v_mov_b64 v[28:29], v[14:15]
    v_mov_b64 v[32:33], v[16:17]
    v_mov_b64 v[36:37], v[18:19]
    v_mfma_f32_4x4x1_16b_f32 v[52:55], v23, v23, 0
    v_mfma_f32_4x4x1_16b_f32 v[56:59], v23, v23, 0
    s_waitcnt lgkmcnt(0)
    s_branch L_c2_top
L_c2_pad1:
    s_branch L_c2_pad2
L_c2_rano:
    s_add_u32 s3, s3, 1
    s_cmp_gt_u32 s3, 262144
    s_cbranch_scc1 L_c2_raok
    buffer_load_dwordx4 v[80:83], v3, s[4:7], s54 offen offset:0 sc1
    buffer_load_dwordx4 v[84:87], v3, s[4:7], s54 offen offset:1024 sc1
    buffer_load_dwordx4 v[88:91], v3, s[4:7], s54 offen offset:2048 sc1
    buffer_load_dwordx4 v[92:95], v3, s[4:7], s54 offen offset:3072 sc1
L_c2_rb:
    s_waitcnt vmcnt(7)
    v_mfma_f32_16x16x32_bf16 v[60:63], v[8:11], v[64:67], 0
    v_xor_b32 v20, s56, v64
    v_bitop3_b32 v20, v20, v66, s56 bitop3:0xf6
    s_waitcnt vmcnt(6)
    v_mfma_f32_16x16x32_bf16 v[60:63], v[8:11], v[68:71], v[60:63]
    v_bitop3_b32 v20, v20, v68, s56 bitop3:0xf6
    v_bitop3_b32 v20, v20, v70, s56 bitop3:0xf6
    s_waitcnt vmcnt(5)
    v_mfma_f32_16x16x32_bf16 v[60:63], v[8:11], v[72:75], v[60:63]
    v_bitop3_b32 v20, v20, v72, s56 bitop3:0xf6
    v_bitop3_b32 v20, v20, v74, s56 bitop3:0xf6
    s_waitcnt vmcnt(4)
    v_mfma_f32_16x16x32_bf16 v[60:63], v[8:11], v[76:79], v[60:63]
    v_bitop3_b32 v20, v20, v76, s56 bitop3:0xf6
    v_bitop3_b32 v20, v20, v78, s56 bitop3:0xf6
    v_and_b32 v20, 1, v20
    v_cmp_eq_u32 vcc, 1, v20
    s_nop 2
    v_add_f32_dpp v64, v60, v60 row_ror:8 row_mask:0xf bank_mask:0xf
    v_add_f32_dpp v65, v61, v61 row_ror:8 row_mask:0xf bank_mask:0xf
    v_add_f32_dpp v66, v62, v62 row_ror:8 row_mask:0xf bank_mask:0xf
    v_add_f32_dpp v67, v63, v63 row_ror:8 row_mask:0xf bank_mask:0xf
    v_cvt_pk_bf16_f32 v68, v64, v65
    v_cvt_pk_bf16_f32 v69, v66, v67
    s_cbranch_vccnz L_c2_rbno
L_c2_rbok:
    buffer_store_dwordx2 v[68:69], v5, s[4:7], s59 offen
    s_branch L_c2_rdone
L_c2_rbno:
    buffer_load_dwordx4 v[64:67], v3, s[4:7], s54 offen offset:0 sc1
    buffer_load_dwordx4 v[68:71], v3, s[4:7], s54 offen offset:1024 sc1
    buffer_load_dwordx4 v[72:75], v3, s[4:7], s54 offen offset:2048 sc1
    buffer_load_dwordx4 v[76:79], v3, s[4:7], s54 offen offset:3072 sc1
    s_branch L_c2_ra
L_c2_pad2:
    s_branch L_c2_pad3
.p2align 5
L_c2_no0:
    buffer_load_dwordx4 v[64:67], v31, s[4:7], s57 offen offset:0 sc1
    s_nop 0
    ds_read_b128 v[128:131], v2 offset:0
    ds_read_b128 v[132:135], v2 offset:1024
    ds_read_b128 v[136:139], v2 offset:2048
    ds_read_b128 v[140:143], v2 offset:3072
    v_mfma_f32_4x4x1_16b_f32 v[40:43], v23, v23, 0
    v_mfma_f32_4x4x1_16b_f32 v[44:47], v23, v23, 0
    s_nop 0
L_c2_c1:
    s_waitcnt vmcnt(4)
    v_cmp_eq_u32_e64 vcc, s12, v68
    v_smfmac_f32_16x16x64_bf16 v[40:43], v[68:71], a[0:7], v1
    v_smfmac_f32_16x16x64_bf16 v[44:47], v[68:71], a[8:15], v1
    s_cbranch_vccnz L_c2_no1
L_c2_go1:
    buffer_load_dwordx4 v31, s[4:7], s58 offen offset:128 sc1 lds
    v_smfmac_f32_16x16x64_bf16 v[48:51], v[68:71], a[112:119], v1
    v_smfmac_f32_16x16x64_bf16 v[52:55], v[68:71], a[120:127], v1
    s_waitcnt lgkmcnt(0)
    v_smfmac_f32_16x16x64_bf16 v[56:59], v[68:71], v[128:135], v1
    ds_read_b128 v[128:131], v2 offset:4096
    v_smfmac_f32_16x16x64_bf16 v[60:63], v[68:71], v[136:143], v1
    s_waitcnt vmcnt(4)
    ds_read_b128 v[132:135], v2 offset:5120
    v_smfmac_f32_16x16x64_bf16 v[40:43], v[72:75], a[16:23], v1
    ds_read_b128 v[136:139], v2 offset:6144
    buffer_store_dwordx2 v[20:21], v5, s[4:7], s72 offen
    s_barrier
    v_smfmac_f32_16x16x64_bf16 v[44:47], v[72:75], a[24:31], v1
    ds_read_b128 v[140:143], v2 offset:7168
    v_smfmac_f32_16x16x64_bf16 v[48:51], v[72:75], a[128:135], v1
    v_smfmac_f32_16x16x64_bf16 v[52:55], v[72:75], a[136:143], v1
    buffer_load_dwordx4 v[144:147], v3, s[4:7], s100 offen offset:0 sc1
    v_smfmac_f32_16x16x64_bf16 v[56:59], v[72:75], a[208:215], v1
    v_smfmac_f32_16x16x64_bf16 v[60:63], v[72:75], a[216:223], v1
    s_waitcnt vmcnt(5) lgkmcnt(2)
    v_smfmac_f32_16x16x64_bf16 v[48:51], v[76:79], v[128:135], v1
    s_waitcnt lgkmcnt(0)
    ds_read_b128 v[128:131], v2 offset:24576
    v_smfmac_f32_16x16x64_bf16 v[52:55], v[76:79], v[136:143], v1
    ds_read_b128 v[132:135], v2 offset:25600
    buffer_load_dwordx4 v[148:151], v3, s[4:7], s100 offen offset:1024 sc1
    v_smfmac_f32_16x16x64_bf16 v[40:43], v[76:79], a[32:39], v1
    ds_read_b128 v[136:139], v2 offset:26624
    v_smfmac_f32_16x16x64_bf16 v[44:47], v[76:79], a[40:47], v1
    ds_read_b128 v[140:143], v2 offset:27648
    v_smfmac_f32_16x16x64_bf16 v[56:59], v[76:79], a[224:231], v1
    v_smfmac_f32_16x16x64_bf16 v[60:63], v[76:79], a[232:239], v1
    s_waitcnt vmcnt(4)
    v_smfmac_f32_16x16x64_bf16 v[48:51], v[64:67], a[96:103], v1
    s_waitcnt vmcnt(3)
    s_barrier
    v_smfmac_f32_16x16x64_bf16 v[52:55], v[64:67], a[104:111], v1
    s_waitcnt lgkmcnt(2)
    ds_read_b128 v[80:83], v3 offset:4096
    buffer_load_dwordx4 v[12:15], v3, s[4:7], s101 offen offset:0 sc1
    v_smfmac_f32_16x16x64_bf16 v[40:43], v[64:67], v[128:135], v1
    s_waitcnt lgkmcnt(1)
    ds_read_b128 v[84:87], v3 offset:5120
    v_smfmac_f32_16x16x64_bf16 v[44:47], v[64:67], v[136:143], v1
    ds_read_b128 v[128:131], v2 offset:8192
    v_smfmac_f32_16x16x64_bf16 v[56:59], v[64:67], a[192:199], v1
    ds_read_b128 v[88:91], v3 offset:6144
    v_smfmac_f32_16x16x64_bf16 v[60:63], v[64:67], a[200:207], v1
    s_waitcnt lgkmcnt(3)
    ds_read_b128 v[92:95], v3 offset:7168
    buffer_load_dwordx4 v[16:19], v3, s[4:7], s101 offen offset:1024 sc1
    s_branch L_c2_j20
L_c2_pad3:
    s_branch L_c_warm0
.p2align 5
L_c2_no1:
    buffer_load_dwordx4 v[68:71], v31, s[4:7], s57 offen offset:2048 sc1
    s_nop 0
    ds_read_b128 v[128:131], v2 offset:4096
    ds_read_b128 v[132:135], v2 offset:5120
    ds_read_b128 v[136:139], v2 offset:6144
    ds_read_b128 v[140:143], v2 offset:7168
    v_mfma_f32_4x4x1_16b_f32 v[40:43], v23, v23, 0
    v_mfma_f32_4x4x1_16b_f32 v[44:47], v23, v23, 0
    s_nop 0
L_c2_c2:
    s_waitcnt vmcnt(4)
    v_cmp_eq_u32_e64 vcc, s12, v72
    v_smfmac_f32_16x16x64_bf16 v[40:43], v[72:75], a[16:23], v1
    v_smfmac_f32_16x16x64_bf16 v[44:47], v[72:75], a[24:31], v1
    s_cbranch_vccnz L_c2_no2
L_c2_go2:
    buffer_load_dwordx4 v31, s[4:7], s58 offen offset:128 sc1 lds
    v_smfmac_f32_16x16x64_bf16 v[48:51], v[72:75], a[128:135], v1
    v_smfmac_f32_16x16x64_bf16 v[52:55], v[72:75], a[136:143], v1
    v_smfmac_f32_16x16x64_bf16 v[56:59], v[72:75], a[208:215], v1
    v_smfmac_f32_16x16x64_bf16 v[60:63], v[72:75], a[216:223], v1
    s_waitcnt vmcnt(4) lgkmcnt(0)
    v_smfmac_f32_16x16x64_bf16 v[48:51], v[76:79], v[128:135], v1
    ds_read_b128 v[128:131], v2 offset:24576
    buffer_store_dwordx2 v[20:21], v5, s[4:7], s72 offen
    s_barrier
    v_smfmac_f32_16x16x64_bf16 v[52:55], v[76:79], v[136:143], v1
    ds_read_b128 v[132:135], v2 offset:25600
    v_smfmac_f32_16x16x64_bf16 v[40:43], v[76:79], a[32:39], v1
    ds_read_b128 v[136:139], v2 offset:26624
    v_smfmac_f32_16x16x64_bf16 v[44:47], v[76:79], a[40:47], v1
    ds_read_b128 v[140:143], v2 offset:27648
    buffer_load_dwordx4 v[144:147], v3, s[4:7], s100 offen offset:0 sc1
    v_smfmac_f32_16x16x64_bf16 v[56:59], v[76:79], a[224:231], v1
    v_smfmac_f32_16x16x64_bf16 v[60:63], v[76:79], a[232:239], v1
    s_waitcnt vmcnt(4)
    v_smfmac_f32_16x16x64_bf16 v[48:51], v[64:67], a[96:103], v1
    v_smfmac_f32_16x16x64_bf16 v[52:55], v[64:67], a[104:111], v1
    s_waitcnt lgkmcnt(2)
    buffer_load_dwordx4 v[148:151], v3, s[4:7], s100 offen offset:1024 sc1
    v_smfmac_f32_16x16x64_bf16 v[40:43], v[64:67], v[128:135], v1
    s_waitcnt lgkmcnt(0)
    ds_read_b128 v[128:131], v2 offset:0
    v_smfmac_f32_16x16x64_bf16 v[44:47], v[64:67], v[136:143], v1
    ds_read_b128 v[132:135], v2 offset:1024
    v_smfmac_f32_16x16x64_bf16 v[56:59], v[64:67], a[192:199], v1
    ds_read_b128 v[136:139], v2 offset:2048
    v_smfmac_f32_16x16x64_bf16 v[60:63], v[64:67], a[200:207], v1
    s_waitcnt vmcnt(4)
    ds_read_b128 v[140:143], v2 offset:3072
    v_smfmac_f32_16x16x64_bf16 v[40:43], v[68:71], a[0:7], v1
    s_waitcnt vmcnt(3)
    s_barrier
    v_smfmac_f32_16x16x64_bf16 v[44:47], v[68:71], a[8:15], v1
    s_waitcnt lgkmcnt(2)
    ds_read_b128 v[80:83], v3 offset:4096
    buffer_load_dwordx4 v[12:15], v3, s[4:7], s101 offen offset:0 sc1
    v_smfmac_f32_16x16x64_bf16 v[56:59], v[68:71], v[128:135], v1
    s_waitcnt lgkmcnt(1)
    ds_read_b128 v[84:87], v3 offset:5120
    v_smfmac_f32_16x16x64_bf16 v[60:63], v[68:71], v[136:143], v1
    ds_read_b128 v[128:131], v2 offset:8192
    v_smfmac_f32_16x16x64_bf16 v[48:51], v[68:71], a[112:119], v1
    ds_read_b128 v[88:91], v3 offset:6144
    v_smfmac_f32_16x16x64_bf16 v[52:55], v[68:71], a[120:127], v1
    s_waitcnt lgkmcnt(3)
    ds_read_b128 v[92:95], v3 offset:7168
    buffer_load_dwordx4 v[16:19], v3, s[4:7], s101 offen offset:1024 sc1
    s_branch L_c2_j20
L_c2_pad4:
    s_branch L_c2_pad5
.p2align 5
L_c2_no2:
    buffer_load_dwordx4 v[72:75], v31, s[4:7], s57 offen offset:128 sc1
    s_nop 0
    s_nop 3
    v_mfma_f32_4x4x1_16b_f32 v[40:43], v23, v23, 0
    v_mfma_f32_4x4x1_16b_f32 v[44:47], v23, v23, 0
    s_nop 0
L_c2_c3:
    s_waitcnt vmcnt(4)
    v_cmp_eq_u32_e64 vcc, s12, v76
    v_smfmac_f32_16x16x64_bf16 v[40:43], v[76:79], a[32:39], v1
    v_smfmac_f32_16x16x64_bf16 v[44:47], v[76:79], a[40:47], v1
    s_cbranch_vccnz L_c2_no3
L_c2_go3:
    s_waitcnt lgkmcnt(0)
    buffer_load_dwordx4 v31, s[4:7], s58 offen offset:128 sc1 lds
    v_smfmac_f32_16x16x64_bf16 v[48:51], v[76:79], v[128:135], v1
    ds_read_b128 v[128:131], v2 offset:24576
    v_smfmac_f32_16x16x64_bf16 v[52:55], v[76:79], v[136:143], v1
    ds_read_b128 v[132:135], v2 offset:25600
    v_smfmac_f32_16x16x64_bf16 v[56:59], v[76:79], a[224:231], v1
    ds_read_b128 v[136:139], v2 offset:26624
    v_smfmac_f32_16x16x64_bf16 v[60:63], v[76:79], a[232:239], v1
    s_waitcnt vmcnt(3)
    ds_read_b128 v[140:143], v2 offset:27648
    v_smfmac_f32_16x16x64_bf16 v[48:51], v[64:67], a[96:103], v1
    buffer_store_dwordx2 v[20:21], v5, s[4:7], s72 offen
    s_barrier
    v_smfmac_f32_16x16x64_bf16 v[52:55], v[64:67], a[104:111], v1
    v_smfmac_f32_16x16x64_bf16 v[56:59], v[64:67], a[192:199], v1
    v_smfmac_f32_16x16x64_bf16 v[60:63], v[64:67], a[200:207], v1
    s_waitcnt lgkmcnt(2)
    buffer_load_dwordx4 v[144:147], v3, s[4:7], s100 offen offset:0 sc1
    v_smfmac_f32_16x16x64_bf16 v[40:43], v[64:67], v[128:135], v1
    s_waitcnt lgkmcnt(0)
    ds_read_b128 v[128:131], v2 offset:0
    v_smfmac_f32_16x16x64_bf16 v[44:47], v[64:67], v[136:143], v1
    s_waitcnt vmcnt(4)
    ds_read_b128 v[132:135], v2 offset:1024
    v_smfmac_f32_16x16x64_bf16 v[40:43], v[68:71], a[0:7], v1
    ds_read_b128 v[136:139], v2 offset:2048
    v_smfmac_f32_16x16x64_bf16 v[44:47], v[68:71], a[8:15], v1
    ds_read_b128 v[140:143], v2 offset:3072
    buffer_load_dwordx4 v[148:151], v3, s[4:7], s100 offen offset:1024 sc1
    v_smfmac_f32_16x16x64_bf16 v[48:51], v[68:71], a[112:119], v1
    v_smfmac_f32_16x16x64_bf16 v[52:55], v[68:71], a[120:127], v1
    s_waitcnt lgkmcnt(2)
    v_smfmac_f32_16x16x64_bf16 v[56:59], v[68:71], v[128:135], v1
    s_waitcnt lgkmcnt(0)
    v_smfmac_f32_16x16x64_bf16 v[60:63], v[68:71], v[136:143], v1
    s_waitcnt vmcnt(4)
    v_smfmac_f32_16x16x64_bf16 v[40:43], v[72:75], a[16:23], v1
    s_waitcnt vmcnt(3)
    s_barrier
    v_smfmac_f32_16x16x64_bf16 v[44:47], v[72:75], a[24:31], v1
    ds_read_b128 v[80:83], v3 offset:4096
    buffer_load_dwordx4 v[12:15], v3, s[4:7], s101 offen offset:0 sc1
    v_smfmac_f32_16x16x64_bf16 v[48:51], v[72:75], a[128:135], v1
    ds_read_b128 v[84:87], v3 offset:5120
    v_smfmac_f32_16x16x64_bf16 v[52:55], v[72:75], a[136:143], v1
    ds_read_b128 v[128:131], v2 offset:8192
    v_smfmac_f32_16x16x64_bf16 v[56:59], v[72:75], a[208:215], v1
    ds_read_b128 v[88:91], v3 offset:6144
    v_smfmac_f32_16x16x64_bf16 v[60:63], v[72:75], a[216:223], v1
    s_waitcnt lgkmcnt(3)
    ds_read_b128 v[92:95], v3 offset:7168
    buffer_load_dwordx4 v[16:19], v3, s[4:7], s101 offen offset:1024 sc1
    s_branch L_c2_j20
L_c2_pad5:
    s_branch L_c2_pad6
.p2align 5
L_c2_no3:
    s_add_u32 s3, s3, 1
    s_cmp_gt_u32 s3, 262144
    s_cbranch_scc1 L_c2_go3
    buffer_load_dwordx4 v[76:79], v31, s[4:7], s57 offen offset:2176 sc1
    buffer_load_dwordx4 v31, s[4:7], s58 offen offset:128 sc1 lds
    ds_read_b128 v[128:131], v2 offset:24576
    ds_read_b128 v[132:135], v2 offset:25600
    ds_read_b128 v[136:139], v2 offset:26624
    ds_read_b128 v[140:143], v2 offset:27648
    v_mfma_f32_4x4x1_16b_f32 v[40:43], v23, v23, 0
    v_mfma_f32_4x4x1_16b_f32 v[44:47], v23, v23, 0
    s_nop 0
    s_branch L_c2_c0
L_c2_nan:
    v_mov_b32 v20, 0
    v_max3_u32 v20, v20, v64, v65
    v_max3_u32 v20, v20, v66, v67
    v_max3_u32 v20, v20, v68, v69
    v_max3_u32 v20, v20, v70, v71
    v_max3_u32 v20, v20, v72, v73
    v_max3_u32 v20, v20, v74, v75
    v_max3_u32 v20, v20, v76, v77
    v_max3_u32 v20, v20, v78, v79
    v_max3_u32 v20, v20, v80, v81
    v_max3_u32 v20, v20, v82, v83
    v_max3_u32 v20, v20, v84, v85
    v_max3_u32 v20, v20, v86, v87
    v_max3_u32 v20, v20, v88, v89
    v_max3_u32 v20, v20, v90, v91
    v_max3_u32 v20, v20, v92, v93
    v_max3_u32 v20, v20, v94, v95
    v_cmp_eq_u32 vcc, s12, v20
    s_cbranch_vccz L_c2_nanok
L_c2_nanl:
    buffer_load_dwordx4 v[64:67], v31, s[4:7], s57 offen offset:0 sc1
    buffer_load_dwordx4 v[68:71], v31, s[4:7], s57 offen offset:2048 sc1
    buffer_load_dwordx4 v[72:75], v31, s[4:7], s57 offen offset:128 sc1
    buffer_load_dwordx4 v[76:79], v31, s[4:7], s57 offen offset:2176 sc1
    buffer_load_dwordx4 v[80:83], v31, s[4:7], s58 offen offset:0 sc1
    buffer_load_dwordx4 v[84:87], v31, s[4:7], s58 offen offset:2048 sc1
    buffer_load_dwordx4 v[88:91], v31, s[4:7], s58 offen offset:128 sc1
    buffer_load_dwordx4 v[92:95], v31, s[4:7], s58 offen offset:2176 sc1
    s_waitcnt vmcnt(0)
    v_mov_b32 v20, 0
    v_max3_u32 v20, v20, v64, v65
    v_max3_u32 v20, v20, v66, v67
    v_max3_u32 v20, v20, v68, v69
    v_max3_u32 v20, v20, v70, v71
    v_max3_u32 v20, v20, v72, v73
    v_max3_u32 v20, v20, v74, v75
    v_max3_u32 v20, v20, v76, v77
    v_max3_u32 v20, v20, v78, v79
    v_max3_u32 v20, v20, v80, v81
    v_max3_u32 v20, v20, v82, v83
    v_max3_u32 v20, v20, v84, v85
    v_max3_u32 v20, v20, v86, v87
    v_max3_u32 v20, v20, v88, v89
    v_max3_u32 v20, v20, v90, v91
    v_max3_u32 v20, v20, v92, v93
    v_max3_u32 v20, v20, v94, v95
    v_cmp_eq_u32 vcc, s12, v20
    s_cbranch_vccz L_c2_nanr
    s_add_u32 s3, s3, 1
    s_cmp_gt_u32 s3, 262144
    s_cbranch_scc1 L_c2_nanr
    s_branch L_c2_nanl
L_c2_nanr:
    s_waitcnt lgkmcnt(0)
    v_mov_b64 v[40:41], 0
    v_mov_b64 v[42:43], 0
    v_mov_b64 v[44:45], 0
    v_mov_b64 v[46:47], 0
    v_mov_b64 v[48:49], 0
    v_mov_b64 v[50:51], 0
    v_mov_b64 v[52:53], 0
    v_mov_b64 v[54:55], 0
    v_mov_b64 v[56:57], 0
    v_mov_b64 v[58:59], 0
    v_mov_b64 v[60:61], 0
    v_mov_b64 v[62:63], 0
    ds_read_b128 v[128:131], v2 offset:24576
    ds_read_b128 v[132:135], v2 offset:25600
    ds_read_b128 v[136:139], v2 offset:26624
    ds_read_b128 v[140:143], v2 offset:27648
    s_waitcnt lgkmcnt(0)
    v_smfmac_f32_16x16x64_bf16 v[40:43], v[64:67], v[128:135], v1
    v_smfmac_f32_16x16x64_bf16 v[44:47], v[64:67], v[136:143], v1
    v_smfmac_f32_16x16x64_bf16 v[48:51], v[64:67], a[96:103], v1
    v_smfmac_f32_16x16x64_bf16 v[52:55], v[64:67], a[104:111], v1
    v_smfmac_f32_16x16x64_bf16 v[56:59], v[64:67], a[192:199], v1
    v_smfmac_f32_16x16x64_bf16 v[60:63], v[64:67], a[200:207], v1
    v_smfmac_f32_16x16x64_bf16 v[40:43], v[68:71], a[0:7], v1
    v_smfmac_f32_16x16x64_bf16 v[44:47], v[68:71], a[8:15], v1
    v_smfmac_f32_16x16x64_bf16 v[48:51], v[68:71], a[112:119], v1
    v_smfmac_f32_16x16x64_bf16 v[52:55], v[68:71], a[120:127], v1
    ds_read_b128 v[128:131], v2 offset:0
    ds_read_b128 v[132:135], v2 offset:1024
    ds_read_b128 v[136:139], v2 offset:2048
    ds_read_b128 v[140:143], v2 offset:3072
    s_waitcnt lgkmcnt(0)
    v_smfmac_f32_16x16x64_bf16 v[56:59], v[68:71], v[128:135], v1
    v_smfmac_f32_16x16x64_bf16 v[60:63], v[68:71], v[136:143], v1
    v_smfmac_f32_16x16x64_bf16 v[40:43], v[72:75], a[16:23], v1
    v_smfmac_f32_16x16x64_bf16 v[44:47], v[72:75], a[24:31], v1
    v_smfmac_f32_16x16x64_bf16 v[48:51], v[72:75], a[128:135], v1
    v_smfmac_f32_16x16x64_bf16 v[52:55], v[72:75], a[136:143], v1
    v_smfmac_f32_16x16x64_bf16 v[56:59], v[72:75], a[208:215], v1
    v_smfmac_f32_16x16x64_bf16 v[60:63], v[72:75], a[216:223], v1
    v_smfmac_f32_16x16x64_bf16 v[40:43], v[76:79], a[32:39], v1
    v_smfmac_f32_16x16x64_bf16 v[44:47], v[76:79], a[40:47], v1
    ds_read_b128 v[128:131], v2 offset:4096
    ds_read_b128 v[132:135], v2 offset:5120
    ds_read_b128 v[136:139], v2 offset:6144
    ds_read_b128 v[140:143], v2 offset:7168
    s_waitcnt lgkmcnt(0)
    v_smfmac_f32_16x16x64_bf16 v[48:51], v[76:79], v[128:135], v1
    v_smfmac_f32_16x16x64_bf16 v[52:55], v[76:79], v[136:143], v1
    v_smfmac_f32_16x16x64_bf16 v[56:59], v[76:79], a[224:231], v1
    v_smfmac_f32_16x16x64_bf16 v[60:63], v[76:79], a[232:239], v1
    v_smfmac_f32_16x16x64_bf16 v[40:43], v[80:83], a[48:55], v1
    v_smfmac_f32_16x16x64_bf16 v[40:43], v[84:87], a[64:71], v1
    v_smfmac_f32_16x16x64_bf16 v[44:47], v[80:83], a[56:63], v1
    v_smfmac_f32_16x16x64_bf16 v[44:47], v[84:87], a[72:79], v1
    v_smfmac_f32_16x16x64_bf16 v[40:43], v[88:91], a[80:87], v1
    ds_read_b128 v[128:131], v2 offset:8192
    ds_read_b128 v[132:135], v2 offset:9216
    ds_read_b128 v[136:139], v2 offset:10240
    ds_read_b128 v[140:143], v2 offset:11264
    s_waitcnt lgkmcnt(0)
    v_smfmac_f32_16x16x64_bf16 v[40:43], v[92:95], v[128:135], v1
    v_smfmac_f32_16x16x64_bf16 v[44:47], v[88:91], a[88:95], v1
    v_smfmac_f32_16x16x64_bf16 v[44:47], v[92:95], v[136:143], v1
    v_smfmac_f32_16x16x64_bf16 v[48:51], v[80:83], a[144:151], v1
    v_smfmac_f32_16x16x64_bf16 v[48:51], v[84:87], a[160:167], v1
    v_smfmac_f32_16x16x64_bf16 v[48:51], v[88:91], a[176:183], v1
    ds_read_b128 v[128:131], v2 offset:20480
    ds_read_b128 v[132:135], v2 offset:21504
    ds_read_b128 v[136:139], v2 offset:22528
    ds_read_b128 v[140:143], v2 offset:23552
    s_waitcnt lgkmcnt(0)
    v_smfmac_f32_16x16x64_bf16 v[48:51], v[92:95], v[128:135], v1
    v_smfmac_f32_16x16x64_bf16 v[52:55], v[80:83], a[152:159], v1
    v_smfmac_f32_16x16x64_bf16 v[52:55], v[84:87], a[168:175], v1
    v_smfmac_f32_16x16x64_bf16 v[52:55], v[88:91], a[184:191], v1
    v_smfmac_f32_16x16x64_bf16 v[52:55], v[92:95], v[136:143], v1
    ds_read_b128 v[128:131], v2 offset:28672
    ds_read_b128 v[132:135], v2 offset:29696
    v_add_f32 v40, v40, v42
    v_add_f32 v41, v41, v43
    v_add_f32 v44, v44, v46
    v_add_f32 v45, v45, v47
    v_cvt_pk_bf16_f32 v42, v40, v44
    v_cvt_pk_bf16_f32 v43, v41, v45
    ds_write_b32 v6, v42
    ds_write_b32 v6, v43 offset:16
    v_add_f32 v48, v48, v50
    v_add_f32 v49, v49, v51
    s_waitcnt lgkmcnt(0)
    s_branch L_c2_nanok
L_c2_pad6:
    s_branch L_c_warm1
L_c2_done:
    buffer_store_dwordx4 v[52:55], v3, s[4:7], s61 offen sc1
    s_waitcnt vmcnt(0)
    s_endpgm
L_c_w3:
    v_and_b32 v56, 15, v0
    v_and_b32 v57, 1, v0
    v_mov_b32 v35, v8
    v_mov_b32 v39, v9
    v_lshlrev_b32 v57, 4, v57
    v_mov_b32 v58, 0x3f80
    v_lshlrev_b32 v57, v57, v58
    v_lshrrev_b32 v56, 1, v56
    v_cmp_eq_u32 vcc, 0, v56
    s_nop 1
    v_cndmask_b32 v8, 0, v57, vcc
    v_cmp_eq_u32 vcc, 2, v56
    s_nop 1
    v_cndmask_b32 v9, 0, v57, vcc
    v_cmp_eq_u32 vcc, 1, v56
    s_nop 1
    v_cndmask_b32 v10, 0, v57, vcc
    v_cmp_eq_u32 vcc, 3, v56
    s_nop 1
    v_cndmask_b32 v11, 0, v57, vcc
    v_mov_b64 v[56:57], 0
    v_mov_b64 v[58:59], 0
    v_mov_b64 v[60:61], 0
    v_mov_b64 v[62:63], 0
    s_waitcnt vmcnt(0)
    ds_write_b128 v3, v[144:147] offset:2048
    ds_write_b128 v3, v[148:151] offset:3072
    v_mov_b64 v[24:25], v[12:13]
    v_mov_b64 v[28:29], v[14:15]
    v_mov_b64 v[32:33], v[16:17]
    v_mov_b64 v[36:37], v[18:19]
    s_waitcnt lgkmcnt(0)
    s_barrier
    ds_read_b128 v[96:99], v3 offset:6144
    ds_read_b128 v[100:103], v3 offset:7168
    ds_read_b128 v[104:107], v3 offset:4096
    ds_read_b128 v[108:111], v3 offset:5120
    ds_read_b128 v[112:115], v3 offset:0
    ds_read_b128 v[116:119], v3 offset:1024
    ds_read_b128 v[120:123], v3 offset:2048
    ds_read_b128 v[124:127], v3 offset:3072
    ds_read_b128 v[128:131], v2 offset:24576
    ds_read_b128 v[132:135], v2 offset:25600
    ds_read_b128 v[136:139], v2 offset:26624
    ds_read_b128 v[140:143], v2 offset:27648
    s_add_u32 s60, s60, 524288
    s_add_u32 s100, s60, 6144
    s_add_u32 s101, s60, 14336
    s_waitcnt lgkmcnt(0)
    s_branch L_c3_top
L_c3_pad0:
    s_branch L_c3_pad1
.p2align 5
L_c3_top:
    s_barrier
L_c3_again:
    buffer_load_dwordx4 v[64:67], v31, s[4:7], s57 offen offset:0 sc1
    s_mov_b32 m0, 160640
    v_mov_b64 v[20:21], s[12:13]
    v_mfma_f32_4x4x1_16b_f32 v[60:63], v23, v23, 0
    s_nop 12
    s_nop 1
    buffer_load_dwordx4 v[68:71], v31, s[4:7], s57 offen offset:2048 sc1
    s_nop 15
    s_nop 1
    buffer_load_dwordx4 v[72:75], v31, s[4:7], s57 offen offset:128 sc1
    s_nop 15
    s_nop 1
    buffer_load_dwordx4 v[76:79], v31, s[4:7], s57 offen offset:2176 sc1
    buffer_load_dwordx4 v31, s[4:7], s58 offen offset:2176 sc1 lds
L_c3_c0:
    s_waitcnt vmcnt(4) lgkmcnt(0)
    v_cmp_eq_u32 vcc, s12, v64
    v_smfmac_f32_16x16x64_bf16 v[40:43], v[64:67], v[128:135], v1
    v_smfmac_f32_16x16x64_bf16 v[44:47], v[64:67], v[136:143], v1
    s_cbranch_vccnz L_c3_no0
L_c3_go0:
    v_smfmac_f32_16x16x64_bf16 v[56:59], v[64:67], a[192:199], v1
    ds_read_b128 v[128:131], v2 offset:0
    v_smfmac_f32_16x16x64_bf16 v[60:63], v[64:67], a[200:207], v1
    ds_read_b128 v[132:135], v2 offset:1024
    v_smfmac_f32_16x16x64_bf16 v[52:55], v[64:67], a[104:111], v1
    ds_read_b128 v[136:139], v2 offset:2048
    v_smfmac_f32_16x16x64_bf16 v[48:51], v[64:67], a[96:103], v1
    s_waitcnt vmcnt(3)
    ds_read_b128 v[140:143], v2 offset:3072
    v_smfmac_f32_16x16x64_bf16 v[48:51], v[68:71], a[112:119], v1
    buffer_store_dwordx2 v[20:21], v5, s[4:7], s72 offen
    s_barrier
    v_smfmac_f32_16x16x64_bf16 v[40:43], v[68:71], a[0:7], v1
    v_smfmac_f32_16x16x64_bf16 v[44:47], v[68:71], a[8:15], v1
    v_smfmac_f32_16x16x64_bf16 v[52:55], v[68:71], a[120:127], v1
    s_waitcnt lgkmcnt(0)
    v_smfmac_f32_16x16x64_bf16 v[56:59], v[68:71], v[128:135], v1
    ds_read_b128 v[128:131], v2 offset:4096
    buffer_load_dwordx4 v[144:147], v3, s[4:7], s100 offen offset:0 sc1
    v_smfmac_f32_16x16x64_bf16 v[60:63], v[68:71], v[136:143], v1
    s_waitcnt vmcnt(4)
    ds_read_b128 v[132:135], v2 offset:5120
    v_smfmac_f32_16x16x64_bf16 v[60:63], v[72:75], a[216:223], v1
    ds_read_b128 v[136:139], v2 offset:6144
    v_smfmac_f32_16x16x64_bf16 v[56:59], v[72:75], a[208:215], v1
    ds_read_b128 v[140:143], v2 offset:7168
    v_smfmac_f32_16x16x64_bf16 v[52:55], v[72:75], a[136:143], v1
    buffer_load_dwordx4 v[148:151], v3, s[4:7], s100 offen offset:1024 sc1
    v_smfmac_f32_16x16x64_bf16 v[40:43], v[72:75], a[16:23], v1
    v_smfmac_f32_16x16x64_bf16 v[44:47], v[72:75], a[24:31], v1
    v_smfmac_f32_16x16x64_bf16 v[48:51], v[72:75], a[128:135], v1
    s_waitcnt lgkmcnt(0)
    s_waitcnt vmcnt(4)
    v_smfmac_f32_16x16x64_bf16 v[48:51], v[76:79], v[128:135], v1
    s_waitcnt vmcnt(3)
    s_barrier
    v_smfmac_f32_16x16x64_bf16 v[56:59], v[76:79], a[224:231], v1
    ds_read_b128 v[80:83], v3 offset:4096
    v_smfmac_f32_16x16x64_bf16 v[60:63], v[76:79], a[232:239], v1
    ds_read_b128 v[84:87], v3 offset:5120
    buffer_load_dwordx4 v[12:15], v3, s[4:7], s101 offen offset:0 sc1
    v_smfmac_f32_16x16x64_bf16 v[52:55], v[76:79], v[136:143], v1
    ds_read_b128 v[128:131], v2 offset:8192
    v_smfmac_f32_16x16x64_bf16 v[44:47], v[76:79], a[40:47], v1
    ds_read_b128 v[88:91], v3 offset:6144
    v_smfmac_f32_16x16x64_bf16 v[40:43], v[76:79], a[32:39], v1
    s_waitcnt lgkmcnt(3)
    ds_read_b128 v[92:95], v3 offset:7168
L_c3_j20:
    v_smfmac_f32_16x16x64_bf16 v[40:43], v[80:83], a[48:55], v1
    s_waitcnt lgkmcnt(3)
    ds_read_b128 v[132:135], v2 offset:9216
    buffer_load_dwordx4 v[16:19], v3, s[4:7], s101 offen offset:1024 sc1
    v_smfmac_f32_16x16x64_bf16 v[40:43], v[84:87], a[64:71], v1
    ds_read_b128 v[136:139], v2 offset:10240
    v_smfmac_f32_16x16x64_bf16 v[44:47], v[80:83], a[56:63], v1
    ds_read_b128 v[140:143], v2 offset:11264
    v_smfmac_f32_16x16x64_bf16 v[44:47], v[84:87], a[72:79], v1
    s_waitcnt lgkmcnt(3)
    v_smfmac_f32_16x16x64_bf16 v[40:43], v[88:91], a[80:87], v1
    s_waitcnt lgkmcnt(2)
    v_smfmac_f32_16x16x64_bf16 v[40:43], v[92:95], v[128:135], v1
    ds_read_b128 v[128:131], v2 offset:20480
    v_smfmac_f32_16x16x64_bf16 v[44:47], v[88:91], a[88:95], v1
    s_waitcnt lgkmcnt(1)
    ds_read_b128 v[132:135], v2 offset:21504
    v_smfmac_f32_16x16x64_bf16 v[44:47], v[92:95], v[136:143], v1
    ds_read_b128 v[136:139], v2 offset:22528
    v_add_f32_e64 v40, v40, v42
    v_smfmac_f32_16x16x64_bf16 v[48:51], v[80:83], a[144:151], v1
    ds_read_b128 v[140:143], v2 offset:23552
    v_add_f32 v41, v41, v43
    v_smfmac_f32_16x16x64_bf16 v[48:51], v[84:87], a[160:167], v1
    v_add_f32 v44, v44, v46
    v_add_f32 v45, v45, v47
    v_smfmac_f32_16x16x64_bf16 v[48:51], v[88:91], a[176:183], v1
    s_waitcnt lgkmcnt(2)
    v_cvt_pk_bf16_f32 v42, v40, v44
    v_smfmac_f32_16x16x64_bf16 v[48:51], v[92:95], v[128:135], v1
    ds_write_b32 v6, v42
    v_cvt_pk_bf16_f32 v43, v41, v45
    v_smfmac_f32_16x16x64_bf16 v[52:55], v[80:83], a[152:159], v1
    ds_write_b32 v6, v43 offset:16
    v_cmp_u_f32 vcc, v40, v41
    v_smfmac_f32_16x16x64_bf16 v[52:55], v[84:87], a[168:175], v1
    ds_read_b128 v[128:131], v2 offset:28672
    v_add_f32 v48, v48, v50
    v_smfmac_f32_16x16x64_bf16 v[52:55], v[88:91], a[184:191], v1
    s_waitcnt lgkmcnt(3)
    ds_read_b128 v[132:135], v2 offset:29696
    v_add_f32_e64 v49, v49, v51
    v_smfmac_f32_16x16x64_bf16 v[52:55], v[92:95], v[136:143], v1
    s_cbranch_vccnz L_c3_nan
L_c3_nanok:
    ds_read_b128 v[136:139], v2 offset:30720
    v_smfmac_f32_16x16x64_bf16 v[56:59], v[80:83], a[240:247], v1
    s_waitcnt lgkmcnt(3) vmcnt(4)
    s_barrier
    v_smfmac_f32_16x16x64_bf16 v[56:59], v[84:87], v[152:159], v1
    ds_read_b128 v[64:67], v7 offset:0
    v_add_f32 v52, v52, v54
    v_smfmac_f32_16x16x64_bf16 v[56:59], v[88:91], v[168:175], v1
    s_waitcnt lgkmcnt(2)
    ds_read_b128 v[140:143], v2 offset:31744
    v_add_f32_e64 v53, v53, v55
    v_smfmac_f32_16x16x64_bf16 v[56:59], v[92:95], v[128:135], v1
    ds_read_b128 v[68:71], v7 offset:1024
    v_cvt_pk_bf16_f32 v52, v48, v52
    v_smfmac_f32_16x16x64_bf16 v[60:63], v[80:83], a[248:255], v1
    ds_write_b32 v6, v52 offset:512
    v_cvt_pk_bf16_f32 v53, v49, v53
    v_smfmac_f32_16x16x64_bf16 v[60:63], v[84:87], v[160:167], v1
    ds_write_b32 v6, v53 offset:528
    v_add_f32 v56, v56, v58
    v_smfmac_f32_16x16x64_bf16 v[60:63], v[88:91], v[176:183], v1
    s_waitcnt lgkmcnt(3)
    ds_read_b128 v[72:75], v7 offset:2048
    v_add_f32 v57, v57, v59
    v_smfmac_f32_16x16x64_bf16 v[60:63], v[92:95], v[136:143], v1
    s_waitcnt lgkmcnt(3)
    ds_read_b128 v[76:79], v7 offset:3072
    v_cvt_pk_bf16_f32 v26, v56, v57
    v_mfma_f32_16x16x32_bf16 v[40:43], v[96:99], v[64:67], 0
    s_cmp_eq_u32 s51, 63
    v_cvt_pk_bf16_f32 v54, v56, v57
    v_mfma_f32_16x16x32_bf16 v[40:43], v[100:103], v[68:71], v[40:43]
    s_waitcnt lgkmcnt(1)
    s_barrier
    v_mfma_f32_16x16x32_bf16 v[40:43], v[104:107], v[72:75], v[40:43]
    s_waitcnt lgkmcnt(0)
    ds_read_b128 v[80:83], v35 offset:0
    v_add_f32_e64 v60, v60, v62
    v_mfma_f32_16x16x32_bf16 v[40:43], v[108:111], v[76:79], v[40:43]
    ds_read_b128 v[84:87], v35 offset:1024
    v_add_f32_e64 v61, v61, v63
    v_mfma_f32_16x16x32_bf16 v[44:47], v[112:115], v[64:67], 0
    ds_read_b128 v[88:91], v35 offset:2048
    v_cvt_pk_bf16_f32 v34, v60, v61
    v_mfma_f32_16x16x32_bf16 v[44:47], v[116:119], v[68:71], v[44:47]
    ds_read_b128 v[92:95], v35 offset:3072
    v_cvt_pk_bf16_f32 v55, v60, v61
    v_mfma_f32_16x16x32_bf16 v[44:47], v[120:123], v[72:75], v[44:47]
    v_permlane16_swap_b32 v26, v30
    v_mfma_f32_16x16x32_bf16 v[44:47], v[124:127], v[76:79], v[44:47]
    s_waitcnt lgkmcnt(2)
    v_permlane16_swap_b32 v34, v38
    v_mfma_f32_16x16x32_bf16 v[48:51], v[80:83], v[64:67], 0
    s_cbranch_scc1 L_c3_done
    v_mov_b64 v[56:57], 0
    v_mov_b64 v[58:59], 0
    v_mfma_f32_16x16x32_bf16 v[48:51], v[84:87], v[68:71], v[48:51]
    s_waitcnt lgkmcnt(0)
    v_cndmask_b32 v40, v40, v44, s[66:67]
    v_cndmask_b32 v41, v41, v45, s[66:67]
    v_mfma_f32_16x16x32_bf16 v[48:51], v[88:91], v[72:75], v[48:51]
    v_cndmask_b32 v42, v42, v46, s[66:67]
    v_cndmask_b32 v43, v43, v47, s[66:67]
    v_mfma_f32_16x16x32_bf16 v[48:51], v[92:95], v[76:79], v[48:51]
    v_max3_f32 v44, v40, v41, v42
    v_max_f32 v44, v44, v43
    v_mov_b64 v[60:61], 0
    v_mov_b64 v[62:63], 0
    v_max_f32_dpp v44, v44, v44 quad_perm:[2,3,0,1] row_mask:0xf bank_mask:0xf
    v_mov_b32 v45, v44
    v_mov_b64 v[96:97], s[70:71]
    v_max3_f32 v46, v48, v49, v50
    v_permlane16_swap_b32 v44, v45
    v_max3_f32 v44, v44, v45, v51
    v_max_f32 v45, v44, v46
    v_max_f32 v44, v44, v46
    v_cndmask_b32 v48, v48, v49, s[66:67]
    v_mov_b64 v[98:99], s[70:71]
    v_permlane32_swap_b32 v44, v45
    v_max_f32 v44, v44, v45
    v_mul_f32_e64 v44, s63, v44
    v_pk_fma_f32 v[40:41], v[40:41], s[62:63], v[44:45] op_sel_hi:[1,1,0] neg_lo:[0,0,1] neg_hi:[0,0,1]
    v_pk_fma_f32 v[42:43], v[42:43], s[62:63], v[44:45] op_sel_hi:[1,1,0] neg_lo:[0,0,1] neg_hi:[0,0,1]
    v_fma_f32 v48, v48, s63, -v44
    v_exp_f32 v40, v40
    v_exp_f32 v41, v41
    v_exp_f32 v42, v42
    v_cvt_pk_bf16_f32 v20, v40, v41
    v_exp_f32 v43, v43
    v_exp_f32 v48, v48
    v_cvt_pk_bf16_f32 v22, v42, v43
    v_cvt_pk_bf16_f32 v21, v48, v23
    s_nop 1
    v_mfma_f32_16x16x32_bf16 v[44:47], v[20:23], v[96:99], 0
    v_smfmac_f32_16x16x64_bf16 v[56:59], v[20:23], v[24:31], v1 abid:1
    ds_read_b128 v[128:131], v2 offset:12288
    v_smfmac_f32_16x16x64_bf16 v[60:63], v[20:23], v[32:39], v1 abid:1
    ds_read_b128 v[132:135], v2 offset:13312
    v_add_f32 v44, v44, v46
    v_add_f32 v45, v45, v47
    v_rcp_f32 v44, v44
    v_rcp_f32 v45, v45
    v_pk_add_f32 v[56:57], v[56:57], v[58:59]
    v_pk_mul_f32 v[56:57], v[56:57], v[44:45]
    v_pk_add_f32 v[60:61], v[60:61], v[62:63]
    v_pk_mul_f32 v[60:61], v[60:61], v[44:45]
    v_cvt_pk_bf16_f32 v58, v56, v60
    v_cvt_pk_bf16_f32 v59, v57, v61
    v_mfma_f32_4x4x1_16b_f32 v[80:83], v23, v23, 0
    ds_write2_b32 v39, v58, v59 offset0:0 offset1:4
    v_mfma_f32_16x16x1_4b_f32 v[64:79], v23, v23, 0
    s_and_b32 s56, s51, 1
    s_add_u32 s51, s51, 1
    s_lshl_b32 s47, s56, 13
    s_sub_u32 s57, 3153920, s47
    s_add_u32 s58, s57, 4096
    s_add_u32 s72, s47, 3145728
    s_xor_b32 s59, s72, 8192
    buffer_store_dwordx4 v[52:55], v3, s[4:7], s61 offen nt
    s_waitcnt lgkmcnt(0)
    s_barrier
    ds_read_b128 v[40:43], v3 offset:4096
    v_mfma_f32_4x4x1_16b_f32 v[84:87], v23, v23, 0
    ds_read_b128 v[44:47], v3 offset:5120
    v_mfma_f32_4x4x1_16b_f32 v[88:91], v23, v23, 0
    v_mfma_f32_4x4x1_16b_f32 v[92:95], v23, v23, 0
    ds_read_b128 v[136:139], v2 offset:14336
    s_waitcnt lgkmcnt(2)
    v_smfmac_f32_16x16x64_bf16 v[64:67], v[40:43], v[184:191], v1
    ds_read_b128 v[140:143], v2 offset:15360
    v_smfmac_f32_16x16x64_bf16 v[68:71], v[40:43], v[200:207], v1
    s_waitcnt lgkmcnt(2)
    ds_read_b128 v[104:107], v2 offset:32768
    v_smfmac_f32_16x16x64_bf16 v[64:67], v[44:47], v[192:199], v1
    ds_read_b128 v[108:111], v2 offset:33792
    v_smfmac_f32_16x16x64_bf16 v[68:71], v[44:47], v[208:215], v1
    ds_read_b128 v[112:115], v2 offset:34816
    ds_read_b128 v[116:119], v2 offset:35840
    v_smfmac_f32_16x16x64_bf16 v[72:75], v[40:43], v[216:223], v1
    ds_read_b128 v[120:123], v2 offset:16384
    v_add_f32 v64, v64, v66
    v_add_f32 v65, v65, v67
    v_smfmac_f32_16x16x64_bf16 v[72:75], v[44:47], v[224:231], v1
    ds_read_b128 v[124:127], v2 offset:17408
    v_add_f32 v68, v68, v70
    v_add_f32_e64 v69, v69, v71
    v_smfmac_f32_16x16x64_bf16 v[76:79], v[40:43], v[232:239], v1
    ds_read_b128 v[96:99], v2 offset:18432
    v_cvt_pk_bf16_f32 v48, v64, v68
    v_cvt_pk_bf16_f32 v49, v65, v69
    v_bfi_b32 v48, 1, s56, v48
    v_smfmac_f32_16x16x64_bf16 v[76:79], v[44:47], v[240:247], v1
    buffer_store_dwordx2 v[48:49], v4, s[4:7], s52 offen offset:0
    v_add_f32 v72, v72, v74
    v_smfmac_f32_16x16x64_bf16 v[80:83], v[40:43], v[248:255], v1
    s_waitcnt lgkmcnt(5)
    ds_read_b128 v[100:103], v2 offset:19456
    v_add_f32_e64 v73, v73, v75
    v_smfmac_f32_16x16x64_bf16 v[80:83], v[44:47], v[128:135], v1
    ds_read_b128 v[128:131], v2 offset:36864
    v_add_f32 v76, v76, v78
    v_add_f32 v77, v77, v79
    v_smfmac_f32_16x16x64_bf16 v[84:87], v[40:43], v[136:143], v1
    ds_read_b128 v[132:135], v2 offset:37888
    v_cvt_pk_bf16_f32 v50, v72, v76
    v_cvt_pk_bf16_f32 v51, v73, v77
    v_bfi_b32 v50, 1, s56, v50
    v_smfmac_f32_16x16x64_bf16 v[84:87], v[44:47], v[104:111], v1
    s_waitcnt lgkmcnt(4)
    buffer_store_dwordx2 v[50:51], v4, s[4:7], s52 offen offset:64
    v_add_f32 v80, v80, v82
    v_smfmac_f32_16x16x64_bf16 v[88:91], v[40:43], v[112:119], v1
    v_add_f32 v81, v81, v83
    v_smfmac_f32_16x16x64_bf16 v[88:91], v[44:47], v[120:127], v1
    s_waitcnt lgkmcnt(2)
    v_add_f32 v84, v84, v86
    v_add_f32 v85, v85, v87
    v_smfmac_f32_16x16x64_bf16 v[92:95], v[40:43], v[96:103], v1
    s_waitcnt lgkmcnt(0)
    v_cvt_pk_bf16_f32 v56, v80, v84
    v_cvt_pk_bf16_f32 v57, v81, v85
    v_bfi_b32 v56, 1, s56, v56
    v_smfmac_f32_16x16x64_bf16 v[92:95], v[44:47], v[128:135], v1
    buffer_store_dwordx2 v[56:57], v4, s[4:7], s53 offen offset:0
    v_add_f32 v88, v88, v90
    v_add_f32 v89, v89, v91
    s_nop 3
    v_add_f32 v92, v92, v94
    v_add_f32 v93, v93, v95
    v_cvt_pk_bf16_f32 v58, v88, v92
    v_cvt_pk_bf16_f32 v59, v89, v93
    v_bfi_b32 v58, 1, s56, v58
    buffer_store_dwordx2 v[58:59], v4, s[4:7], s53 offen offset:64
    s_waitcnt vmcnt(4)
    s_barrier
    ds_write_b128 v3, v[144:147] offset:2048
    ds_write_b128 v3, v[148:151] offset:3072
    s_add_u32 s60, s60, 524288
    s_cmp_eq_u32 s51, 63
    s_cselect_b32 s60, 0x40000000, s60
    s_add_u32 s100, s60, 6144
    s_add_u32 s101, s60, 14336
    s_add_u32 s61, s61, 131072
    ds_read_b128 v[128:131], v2 offset:24576
    ds_read_b128 v[132:135], v2 offset:25600
    ds_read_b128 v[136:139], v2 offset:26624
    ds_read_b128 v[140:143], v2 offset:27648
    v_mfma_f32_4x4x1_16b_f32 v[40:43], v23, v23, 0
    v_mfma_f32_4x4x1_16b_f32 v[44:47], v23, v23, 0
    v_mfma_f32_4x4x1_16b_f32 v[48:51], v23, v23, 0
    s_waitcnt lgkmcnt(4)
    s_barrier
    ds_read_b128 v[96:99], v3 offset:6144
    ds_read_b128 v[100:103], v3 offset:7168
    ds_read_b128 v[104:107], v3 offset:4096
    ds_read_b128 v[108:111], v3 offset:5120
    ds_read_b128 v[112:115], v3 offset:0
    ds_read_b128 v[116:119], v3 offset:1024
    ds_read_b128 v[120:123], v3 offset:2048
    ds_read_b128 v[124:127], v3 offset:3072
    s_nop 11
    buffer_load_dwordx4 v[80:83], v3, s[4:7], s54 offen offset:0 sc1
    buffer_load_dwordx4 v[84:87], v3, s[4:7], s54 offen offset:1024 sc1
    buffer_load_dwordx4 v[88:91], v3, s[4:7], s54 offen offset:2048 sc1
    buffer_load_dwordx4 v[92:95], v3, s[4:7], s54 offen offset:3072 sc1
    buffer_load_dwordx4 v[64:67], v3, s[4:7], s54 offen offset:0 sc1
    buffer_load_dwordx4 v[68:71], v3, s[4:7], s54 offen offset:1024 sc1
    buffer_load_dwordx4 v[72:75], v3, s[4:7], s54 offen offset:2048 sc1
    buffer_load_dwordx4 v[76:79], v3, s[4:7], s54 offen offset:3072 sc1
    v_mov_b64 v[24:25], v[12:13]
    v_mov_b64 v[28:29], v[14:15]
    v_mov_b64 v[32:33], v[16:17]
    v_mov_b64_e64 v[36:37], v[18:19]
    v_mfma_f32_4x4x1_16b_f32 v[52:55], v23, v23, 0
    v_mfma_f32_4x4x1_16b_f32 v[56:59], v23, v23, 0
L_c3_ra:
    s_waitcnt vmcnt(7)
    v_mfma_f32_16x16x32_bf16 v[60:63], v[8:11], v[80:83], 0
    v_xor_b32 v20, s56, v80
    v_bitop3_b32 v20, v20, v82, s56 bitop3:0xf6
    s_waitcnt vmcnt(6)
    v_mfma_f32_16x16x32_bf16 v[60:63], v[8:11], v[84:87], v[60:63]
    v_bitop3_b32 v20, v20, v84, s56 bitop3:0xf6
    v_bitop3_b32 v20, v20, v86, s56 bitop3:0xf6
    s_waitcnt vmcnt(5)
    v_mfma_f32_16x16x32_bf16 v[60:63], v[8:11], v[88:91], v[60:63]
    v_bitop3_b32 v20, v20, v88, s56 bitop3:0xf6
    v_bitop3_b32 v20, v20, v90, s56 bitop3:0xf6
    s_waitcnt vmcnt(4)
    v_mfma_f32_16x16x32_bf16 v[60:63], v[8:11], v[92:95], v[60:63]
    v_bitop3_b32 v20, v20, v92, s56 bitop3:0xf6
    v_bitop3_b32 v20, v20, v94, s56 bitop3:0xf6
    v_and_b32 v20, 1, v20
    v_cmp_eq_u32 vcc, 1, v20
    s_nop 2
    v_add_f32_dpp v80, v60, v60 row_ror:8 row_mask:0xf bank_mask:0xf
    v_add_f32_dpp v81, v61, v61 row_ror:8 row_mask:0xf bank_mask:0xf
    v_add_f32_dpp v82, v62, v62 row_ror:8 row_mask:0xf bank_mask:0xf
    v_add_f32_dpp v83, v63, v63 row_ror:8 row_mask:0xf bank_mask:0xf
    v_cvt_pk_bf16_f32 v84, v80, v81
    v_cvt_pk_bf16_f32 v85, v82, v83
    s_cbranch_vccnz L_c3_rano
L_c3_raok:
    buffer_store_dwordx2 v[84:85], v5, s[4:7], s59 offen
L_c3_rdone:
    s_waitcnt lgkmcnt(0)
    s_nop 2
    s_branch L_c3_top
L_c3_pad1:
    s_branch L_c3_pad2
L_c3_rano:
    s_add_u32 s3, s3, 1
    s_cmp_gt_u32 s3, 262144
    s_cbranch_scc1 L_c3_raok
    buffer_load_dwordx4 v[80:83], v3, s[4:7], s54 offen offset:0 sc1
    buffer_load_dwordx4 v[84:87], v3, s[4:7], s54 offen offset:1024 sc1
    buffer_load_dwordx4 v[88:91], v3, s[4:7], s54 offen offset:2048 sc1
    buffer_load_dwordx4 v[92:95], v3, s[4:7], s54 offen offset:3072 sc1
L_c3_rb:
    s_waitcnt vmcnt(7)
    v_mfma_f32_16x16x32_bf16 v[60:63], v[8:11], v[64:67], 0
    v_xor_b32 v20, s56, v64
    v_bitop3_b32 v20, v20, v66, s56 bitop3:0xf6
    s_waitcnt vmcnt(6)
    v_mfma_f32_16x16x32_bf16 v[60:63], v[8:11], v[68:71], v[60:63]
    v_bitop3_b32 v20, v20, v68, s56 bitop3:0xf6
    v_bitop3_b32 v20, v20, v70, s56 bitop3:0xf6
    s_waitcnt vmcnt(5)
    v_mfma_f32_16x16x32_bf16 v[60:63], v[8:11], v[72:75], v[60:63]
    v_bitop3_b32 v20, v20, v72, s56 bitop3:0xf6
    v_bitop3_b32 v20, v20, v74, s56 bitop3:0xf6
    s_waitcnt vmcnt(4)
    v_mfma_f32_16x16x32_bf16 v[60:63], v[8:11], v[76:79], v[60:63]
    v_bitop3_b32 v20, v20, v76, s56 bitop3:0xf6
    v_bitop3_b32 v20, v20, v78, s56 bitop3:0xf6
    v_and_b32 v20, 1, v20
    v_cmp_eq_u32 vcc, 1, v20
    s_nop 2
    v_add_f32_dpp v64, v60, v60 row_ror:8 row_mask:0xf bank_mask:0xf
    v_add_f32_dpp v65, v61, v61 row_ror:8 row_mask:0xf bank_mask:0xf
    v_add_f32_dpp v66, v62, v62 row_ror:8 row_mask:0xf bank_mask:0xf
    v_add_f32_dpp v67, v63, v63 row_ror:8 row_mask:0xf bank_mask:0xf
    v_cvt_pk_bf16_f32 v68, v64, v65
    v_cvt_pk_bf16_f32 v69, v66, v67
    s_cbranch_vccnz L_c3_rbno
L_c3_rbok:
    buffer_store_dwordx2 v[68:69], v5, s[4:7], s59 offen
    s_branch L_c3_rdone
L_c3_rbno:
    buffer_load_dwordx4 v[64:67], v3, s[4:7], s54 offen offset:0 sc1
    buffer_load_dwordx4 v[68:71], v3, s[4:7], s54 offen offset:1024 sc1
    buffer_load_dwordx4 v[72:75], v3, s[4:7], s54 offen offset:2048 sc1
    buffer_load_dwordx4 v[76:79], v3, s[4:7], s54 offen offset:3072 sc1
    s_branch L_c3_ra
L_c3_pad2:
    s_branch L_c3_pad3
.p2align 5
L_c3_no0:
    buffer_load_dwordx4 v[64:67], v31, s[4:7], s57 offen offset:0 sc1
    s_nop 0
    ds_read_b128 v[128:131], v2 offset:0
    ds_read_b128 v[132:135], v2 offset:1024
    ds_read_b128 v[136:139], v2 offset:2048
    ds_read_b128 v[140:143], v2 offset:3072
    v_mfma_f32_4x4x1_16b_f32 v[40:43], v23, v23, 0
    v_mfma_f32_4x4x1_16b_f32 v[44:47], v23, v23, 0
    s_nop 0
L_c3_c1:
    s_waitcnt vmcnt(4)
    v_cmp_eq_u32_e64 vcc, s12, v68
    v_smfmac_f32_16x16x64_bf16 v[40:43], v[68:71], a[0:7], v1
    v_smfmac_f32_16x16x64_bf16 v[44:47], v[68:71], a[8:15], v1
    s_cbranch_vccnz L_c3_no1
L_c3_go1:
    buffer_load_dwordx4 v31, s[4:7], s58 offen offset:2176 sc1 lds
    v_smfmac_f32_16x16x64_bf16 v[48:51], v[68:71], a[112:119], v1
    v_smfmac_f32_16x16x64_bf16 v[52:55], v[68:71], a[120:127], v1
    s_waitcnt lgkmcnt(0)
    v_smfmac_f32_16x16x64_bf16 v[56:59], v[68:71], v[128:135], v1
    ds_read_b128 v[128:131], v2 offset:4096
    v_smfmac_f32_16x16x64_bf16 v[60:63], v[68:71], v[136:143], v1
    s_waitcnt vmcnt(4)
    ds_read_b128 v[132:135], v2 offset:5120
    v_smfmac_f32_16x16x64_bf16 v[40:43], v[72:75], a[16:23], v1
    ds_read_b128 v[136:139], v2 offset:6144
    buffer_store_dwordx2 v[20:21], v5, s[4:7], s72 offen
    s_barrier
    v_smfmac_f32_16x16x64_bf16 v[44:47], v[72:75], a[24:31], v1
    ds_read_b128 v[140:143], v2 offset:7168
    v_smfmac_f32_16x16x64_bf16 v[48:51], v[72:75], a[128:135], v1
    v_smfmac_f32_16x16x64_bf16 v[52:55], v[72:75], a[136:143], v1
    v_smfmac_f32_16x16x64_bf16 v[56:59], v[72:75], a[208:215], v1
    buffer_load_dwordx4 v[144:147], v3, s[4:7], s100 offen offset:0 sc1
    v_smfmac_f32_16x16x64_bf16 v[60:63], v[72:75], a[216:223], v1
    s_waitcnt vmcnt(5) lgkmcnt(2)
    v_smfmac_f32_16x16x64_bf16 v[48:51], v[76:79], v[128:135], v1
    s_waitcnt lgkmcnt(0)
    ds_read_b128 v[128:131], v2 offset:24576
    v_smfmac_f32_16x16x64_bf16 v[52:55], v[76:79], v[136:143], v1
    ds_read_b128 v[132:135], v2 offset:25600
    v_smfmac_f32_16x16x64_bf16 v[40:43], v[76:79], a[32:39], v1
    ds_read_b128 v[136:139], v2 offset:26624
    buffer_load_dwordx4 v[148:151], v3, s[4:7], s100 offen offset:1024 sc1
    v_smfmac_f32_16x16x64_bf16 v[44:47], v[76:79], a[40:47], v1
    ds_read_b128 v[140:143], v2 offset:27648
    v_smfmac_f32_16x16x64_bf16 v[56:59], v[76:79], a[224:231], v1
    v_smfmac_f32_16x16x64_bf16 v[60:63], v[76:79], a[232:239], v1
    s_waitcnt vmcnt(4)
    v_smfmac_f32_16x16x64_bf16 v[48:51], v[64:67], a[96:103], v1
    s_waitcnt vmcnt(3)
    s_barrier
    v_smfmac_f32_16x16x64_bf16 v[52:55], v[64:67], a[104:111], v1
    s_waitcnt lgkmcnt(2)
    ds_read_b128 v[80:83], v3 offset:4096
    v_smfmac_f32_16x16x64_bf16 v[40:43], v[64:67], v[128:135], v1
    s_waitcnt lgkmcnt(1)
    ds_read_b128 v[84:87], v3 offset:5120
    buffer_load_dwordx4 v[12:15], v3, s[4:7], s101 offen offset:0 sc1
    v_smfmac_f32_16x16x64_bf16 v[44:47], v[64:67], v[136:143], v1
    ds_read_b128 v[128:131], v2 offset:8192
    v_smfmac_f32_16x16x64_bf16 v[56:59], v[64:67], a[192:199], v1
    ds_read_b128 v[88:91], v3 offset:6144
    v_smfmac_f32_16x16x64_bf16 v[60:63], v[64:67], a[200:207], v1
    s_waitcnt lgkmcnt(3)
    ds_read_b128 v[92:95], v3 offset:7168
    s_branch L_c3_j20
L_c3_pad3:
    s_branch L_c_warm0
.p2align 5
L_c3_no1:
    buffer_load_dwordx4 v[68:71], v31, s[4:7], s57 offen offset:2048 sc1
    s_nop 0
    ds_read_b128 v[128:131], v2 offset:4096
    ds_read_b128 v[132:135], v2 offset:5120
    ds_read_b128 v[136:139], v2 offset:6144
    ds_read_b128 v[140:143], v2 offset:7168
    v_mfma_f32_4x4x1_16b_f32 v[40:43], v23, v23, 0
    v_mfma_f32_4x4x1_16b_f32 v[44:47], v23, v23, 0
    s_nop 0
L_c3_c2:
    s_waitcnt vmcnt(4)
    v_cmp_eq_u32_e64 vcc, s12, v72
    v_smfmac_f32_16x16x64_bf16 v[40:43], v[72:75], a[16:23], v1
    v_smfmac_f32_16x16x64_bf16 v[44:47], v[72:75], a[24:31], v1
    s_cbranch_vccnz L_c3_no2
L_c3_go2:
    buffer_load_dwordx4 v31, s[4:7], s58 offen offset:2176 sc1 lds
    v_smfmac_f32_16x16x64_bf16 v[48:51], v[72:75], a[128:135], v1
    v_smfmac_f32_16x16x64_bf16 v[52:55], v[72:75], a[136:143], v1
    v_smfmac_f32_16x16x64_bf16 v[56:59], v[72:75], a[208:215], v1
    v_smfmac_f32_16x16x64_bf16 v[60:63], v[72:75], a[216:223], v1
    s_waitcnt vmcnt(4) lgkmcnt(0)
    v_smfmac_f32_16x16x64_bf16 v[48:51], v[76:79], v[128:135], v1
    ds_read_b128 v[128:131], v2 offset:24576
    buffer_store_dwordx2 v[20:21], v5, s[4:7], s72 offen
    s_barrier
    v_smfmac_f32_16x16x64_bf16 v[52:55], v[76:79], v[136:143], v1
    ds_read_b128 v[132:135], v2 offset:25600
    v_smfmac_f32_16x16x64_bf16 v[40:43], v[76:79], a[32:39], v1
    ds_read_b128 v[136:139], v2 offset:26624
    v_smfmac_f32_16x16x64_bf16 v[44:47], v[76:79], a[40:47], v1
    ds_read_b128 v[140:143], v2 offset:27648
    v_smfmac_f32_16x16x64_bf16 v[56:59], v[76:79], a[224:231], v1
    buffer_load_dwordx4 v[144:147], v3, s[4:7], s100 offen offset:0 sc1
    v_smfmac_f32_16x16x64_bf16 v[60:63], v[76:79], a[232:239], v1
    s_waitcnt vmcnt(4)
    v_smfmac_f32_16x16x64_bf16 v[48:51], v[64:67], a[96:103], v1
    v_smfmac_f32_16x16x64_bf16 v[52:55], v[64:67], a[104:111], v1
    s_waitcnt lgkmcnt(2)
    v_smfmac_f32_16x16x64_bf16 v[40:43], v[64:67], v[128:135], v1
    s_waitcnt lgkmcnt(0)
    ds_read_b128 v[128:131], v2 offset:0
    buffer_load_dwordx4 v[148:151], v3, s[4:7], s100 offen offset:1024 sc1
    v_smfmac_f32_16x16x64_bf16 v[44:47], v[64:67], v[136:143], v1
    ds_read_b128 v[132:135], v2 offset:1024
    v_smfmac_f32_16x16x64_bf16 v[56:59], v[64:67], a[192:199], v1
    ds_read_b128 v[136:139], v2 offset:2048
    v_smfmac_f32_16x16x64_bf16 v[60:63], v[64:67], a[200:207], v1
    s_waitcnt vmcnt(4)
    ds_read_b128 v[140:143], v2 offset:3072
    v_smfmac_f32_16x16x64_bf16 v[40:43], v[68:71], a[0:7], v1
    s_waitcnt vmcnt(3)
    s_barrier
    v_smfmac_f32_16x16x64_bf16 v[44:47], v[68:71], a[8:15], v1
    s_waitcnt lgkmcnt(2)
    ds_read_b128 v[80:83], v3 offset:4096
    v_smfmac_f32_16x16x64_bf16 v[56:59], v[68:71], v[128:135], v1
    s_waitcnt lgkmcnt(1)
    ds_read_b128 v[84:87], v3 offset:5120
    buffer_load_dwordx4 v[12:15], v3, s[4:7], s101 offen offset:0 sc1
    v_smfmac_f32_16x16x64_bf16 v[60:63], v[68:71], v[136:143], v1
    ds_read_b128 v[128:131], v2 offset:8192
    v_smfmac_f32_16x16x64_bf16 v[48:51], v[68:71], a[112:119], v1
    ds_read_b128 v[88:91], v3 offset:6144
    v_smfmac_f32_16x16x64_bf16 v[52:55], v[68:71], a[120:127], v1
    s_waitcnt lgkmcnt(3)
    ds_read_b128 v[92:95], v3 offset:7168
    s_branch L_c3_j20
L_c3_pad4:
    s_branch L_c3_pad5
.p2align 5
L_c3_no2:
    buffer_load_dwordx4 v[72:75], v31, s[4:7], s57 offen offset:128 sc1
    s_nop 0
    s_nop 3
    v_mfma_f32_4x4x1_16b_f32 v[40:43], v23, v23, 0
    v_mfma_f32_4x4x1_16b_f32 v[44:47], v23, v23, 0
    s_nop 0
L_c3_c3:
    s_waitcnt vmcnt(4)
    v_cmp_eq_u32_e64 vcc, s12, v76
    v_smfmac_f32_16x16x64_bf16 v[40:43], v[76:79], a[32:39], v1
    v_smfmac_f32_16x16x64_bf16 v[44:47], v[76:79], a[40:47], v1
    s_cbranch_vccnz L_c3_no3
L_c3_go3:
    s_waitcnt lgkmcnt(0)
    buffer_load_dwordx4 v31, s[4:7], s58 offen offset:2176 sc1 lds
    v_smfmac_f32_16x16x64_bf16 v[48:51], v[76:79], v[128:135], v1
    ds_read_b128 v[128:131], v2 offset:24576
    v_smfmac_f32_16x16x64_bf16 v[52:55], v[76:79], v[136:143], v1
    ds_read_b128 v[132:135], v2 offset:25600
    v_smfmac_f32_16x16x64_bf16 v[56:59], v[76:79], a[224:231], v1
    ds_read_b128 v[136:139], v2 offset:26624
    v_smfmac_f32_16x16x64_bf16 v[60:63], v[76:79], a[232:239], v1
    s_waitcnt vmcnt(3)
    ds_read_b128 v[140:143], v2 offset:27648
    v_smfmac_f32_16x16x64_bf16 v[48:51], v[64:67], a[96:103], v1
    buffer_store_dwordx2 v[20:21], v5, s[4:7], s72 offen
    s_barrier
    v_smfmac_f32_16x16x64_bf16 v[52:55], v[64:67], a[104:111], v1
    v_smfmac_f32_16x16x64_bf16 v[56:59], v[64:67], a[192:199], v1
    v_smfmac_f32_16x16x64_bf16 v[60:63], v[64:67], a[200:207], v1
    s_waitcnt lgkmcnt(2)
    v_smfmac_f32_16x16x64_bf16 v[40:43], v[64:67], v[128:135], v1
    s_waitcnt lgkmcnt(0)
    ds_read_b128 v[128:131], v2 offset:0
    buffer_load_dwordx4 v[144:147], v3, s[4:7], s100 offen offset:0 sc1
    v_smfmac_f32_16x16x64_bf16 v[44:47], v[64:67], v[136:143], v1
    s_waitcnt vmcnt(4)
    ds_read_b128 v[132:135], v2 offset:1024
    v_smfmac_f32_16x16x64_bf16 v[40:43], v[68:71], a[0:7], v1
    ds_read_b128 v[136:139], v2 offset:2048
    v_smfmac_f32_16x16x64_bf16 v[44:47], v[68:71], a[8:15], v1
    ds_read_b128 v[140:143], v2 offset:3072
    v_smfmac_f32_16x16x64_bf16 v[48:51], v[68:71], a[112:119], v1
    buffer_load_dwordx4 v[148:151], v3, s[4:7], s100 offen offset:1024 sc1
    v_smfmac_f32_16x16x64_bf16 v[52:55], v[68:71], a[120:127], v1
    s_waitcnt lgkmcnt(2)
    v_smfmac_f32_16x16x64_bf16 v[56:59], v[68:71], v[128:135], v1
    s_waitcnt lgkmcnt(0)
    v_smfmac_f32_16x16x64_bf16 v[60:63], v[68:71], v[136:143], v1
    s_waitcnt vmcnt(4)
    v_smfmac_f32_16x16x64_bf16 v[40:43], v[72:75], a[16:23], v1
    s_waitcnt vmcnt(3)
    s_barrier
    v_smfmac_f32_16x16x64_bf16 v[44:47], v[72:75], a[24:31], v1
    ds_read_b128 v[80:83], v3 offset:4096
    v_smfmac_f32_16x16x64_bf16 v[48:51], v[72:75], a[128:135], v1
    ds_read_b128 v[84:87], v3 offset:5120
    buffer_load_dwordx4 v[12:15], v3, s[4:7], s101 offen offset:0 sc1
    v_smfmac_f32_16x16x64_bf16 v[52:55], v[72:75], a[136:143], v1
    ds_read_b128 v[128:131], v2 offset:8192
    v_smfmac_f32_16x16x64_bf16 v[56:59], v[72:75], a[208:215], v1
    ds_read_b128 v[88:91], v3 offset:6144
    v_smfmac_f32_16x16x64_bf16 v[60:63], v[72:75], a[216:223], v1
    s_waitcnt lgkmcnt(3)
    ds_read_b128 v[92:95], v3 offset:7168
    s_branch L_c3_j20
L_c3_pad5:
    s_branch L_c3_pad6
.p2align 5
L_c3_no3:
    s_add_u32 s3, s3, 1
    s_cmp_gt_u32 s3, 262144
    s_cbranch_scc1 L_c3_go3
    buffer_load_dwordx4 v[76:79], v31, s[4:7], s57 offen offset:2176 sc1
    buffer_load_dwordx4 v31, s[4:7], s58 offen offset:2176 sc1 lds
    ds_read_b128 v[128:131], v2 offset:24576
    ds_read_b128 v[132:135], v2 offset:25600
    ds_read_b128 v[136:139], v2 offset:26624
    ds_read_b128 v[140:143], v2 offset:27648
    v_mfma_f32_4x4x1_16b_f32 v[40:43], v23, v23, 0
    v_mfma_f32_4x4x1_16b_f32 v[44:47], v23, v23, 0
    s_nop 0
    s_branch L_c3_c0
L_c3_nan:
    v_mov_b32 v20, 0
    v_max3_u32 v20, v20, v64, v65
    v_max3_u32 v20, v20, v66, v67
    v_max3_u32 v20, v20, v68, v69
    v_max3_u32 v20, v20, v70, v71
    v_max3_u32 v20, v20, v72, v73
    v_max3_u32 v20, v20, v74, v75
    v_max3_u32 v20, v20, v76, v77
    v_max3_u32 v20, v20, v78, v79
    v_max3_u32 v20, v20, v80, v81
    v_max3_u32 v20, v20, v82, v83
    v_max3_u32 v20, v20, v84, v85
    v_max3_u32 v20, v20, v86, v87
    v_max3_u32 v20, v20, v88, v89
    v_max3_u32 v20, v20, v90, v91
    v_max3_u32 v20, v20, v92, v93
    v_max3_u32 v20, v20, v94, v95
    v_cmp_eq_u32 vcc, s12, v20
    s_cbranch_vccz L_c3_nanok
L_c3_nanl:
    buffer_load_dwordx4 v[64:67], v31, s[4:7], s57 offen offset:0 sc1
    buffer_load_dwordx4 v[68:71], v31, s[4:7], s57 offen offset:2048 sc1
    buffer_load_dwordx4 v[72:75], v31, s[4:7], s57 offen offset:128 sc1
    buffer_load_dwordx4 v[76:79], v31, s[4:7], s57 offen offset:2176 sc1
    buffer_load_dwordx4 v[80:83], v31, s[4:7], s58 offen offset:0 sc1
    buffer_load_dwordx4 v[84:87], v31, s[4:7], s58 offen offset:2048 sc1
    buffer_load_dwordx4 v[88:91], v31, s[4:7], s58 offen offset:128 sc1
    buffer_load_dwordx4 v[92:95], v31, s[4:7], s58 offen offset:2176 sc1
    s_waitcnt vmcnt(0)
    v_mov_b32 v20, 0
    v_max3_u32 v20, v20, v64, v65
    v_max3_u32 v20, v20, v66, v67
    v_max3_u32 v20, v20, v68, v69
    v_max3_u32 v20, v20, v70, v71
    v_max3_u32 v20, v20, v72, v73
    v_max3_u32 v20, v20, v74, v75
    v_max3_u32 v20, v20, v76, v77
    v_max3_u32 v20, v20, v78, v79
    v_max3_u32 v20, v20, v80, v81
    v_max3_u32 v20, v20, v82, v83
    v_max3_u32 v20, v20, v84, v85
    v_max3_u32 v20, v20, v86, v87
    v_max3_u32 v20, v20, v88, v89
    v_max3_u32 v20, v20, v90, v91
    v_max3_u32 v20, v20, v92, v93
    v_max3_u32 v20, v20, v94, v95
    v_cmp_eq_u32 vcc, s12, v20
    s_cbranch_vccz L_c3_nanr
    s_add_u32 s3, s3, 1
    s_cmp_gt_u32 s3, 262144
    s_cbranch_scc1 L_c3_nanr
    s_branch L_c3_nanl
L_c3_nanr:
    s_waitcnt lgkmcnt(0)
    v_mov_b64 v[40:41], 0
    v_mov_b64 v[42:43], 0
    v_mov_b64 v[44:45], 0
    v_mov_b64 v[46:47], 0
    v_mov_b64 v[48:49], 0
    v_mov_b64 v[50:51], 0
    v_mov_b64 v[52:53], 0
    v_mov_b64 v[54:55], 0
    v_mov_b64 v[56:57], 0
    v_mov_b64 v[58:59], 0
    v_mov_b64 v[60:61], 0
    v_mov_b64 v[62:63], 0
    ds_read_b128 v[128:131], v2 offset:24576
    ds_read_b128 v[132:135], v2 offset:25600
    ds_read_b128 v[136:139], v2 offset:26624
    ds_read_b128 v[140:143], v2 offset:27648
    s_waitcnt lgkmcnt(0)
    v_smfmac_f32_16x16x64_bf16 v[40:43], v[64:67], v[128:135], v1
    v_smfmac_f32_16x16x64_bf16 v[44:47], v[64:67], v[136:143], v1
    v_smfmac_f32_16x16x64_bf16 v[48:51], v[64:67], a[96:103], v1
    v_smfmac_f32_16x16x64_bf16 v[52:55], v[64:67], a[104:111], v1
    v_smfmac_f32_16x16x64_bf16 v[56:59], v[64:67], a[192:199], v1
    v_smfmac_f32_16x16x64_bf16 v[60:63], v[64:67], a[200:207], v1
    v_smfmac_f32_16x16x64_bf16 v[40:43], v[68:71], a[0:7], v1
    v_smfmac_f32_16x16x64_bf16 v[44:47], v[68:71], a[8:15], v1
    v_smfmac_f32_16x16x64_bf16 v[48:51], v[68:71], a[112:119], v1
    v_smfmac_f32_16x16x64_bf16 v[52:55], v[68:71], a[120:127], v1
    ds_read_b128 v[128:131], v2 offset:0
    ds_read_b128 v[132:135], v2 offset:1024
    ds_read_b128 v[136:139], v2 offset:2048
    ds_read_b128 v[140:143], v2 offset:3072
    s_waitcnt lgkmcnt(0)
    v_smfmac_f32_16x16x64_bf16 v[56:59], v[68:71], v[128:135], v1
    v_smfmac_f32_16x16x64_bf16 v[60:63], v[68:71], v[136:143], v1
    v_smfmac_f32_16x16x64_bf16 v[40:43], v[72:75], a[16:23], v1
    v_smfmac_f32_16x16x64_bf16 v[44:47], v[72:75], a[24:31], v1
    v_smfmac_f32_16x16x64_bf16 v[48:51], v[72:75], a[128:135], v1
    v_smfmac_f32_16x16x64_bf16 v[52:55], v[72:75], a[136:143], v1
    v_smfmac_f32_16x16x64_bf16 v[56:59], v[72:75], a[208:215], v1
    v_smfmac_f32_16x16x64_bf16 v[60:63], v[72:75], a[216:223], v1
    v_smfmac_f32_16x16x64_bf16 v[40:43], v[76:79], a[32:39], v1
    v_smfmac_f32_16x16x64_bf16 v[44:47], v[76:79], a[40:47], v1
    ds_read_b128 v[128:131], v2 offset:4096
    ds_read_b128 v[132:135], v2 offset:5120
    ds_read_b128 v[136:139], v2 offset:6144
    ds_read_b128 v[140:143], v2 offset:7168
    s_waitcnt lgkmcnt(0)
    v_smfmac_f32_16x16x64_bf16 v[48:51], v[76:79], v[128:135], v1
    v_smfmac_f32_16x16x64_bf16 v[52:55], v[76:79], v[136:143], v1
    v_smfmac_f32_16x16x64_bf16 v[56:59], v[76:79], a[224:231], v1
    v_smfmac_f32_16x16x64_bf16 v[60:63], v[76:79], a[232:239], v1
    v_smfmac_f32_16x16x64_bf16 v[40:43], v[80:83], a[48:55], v1
    v_smfmac_f32_16x16x64_bf16 v[40:43], v[84:87], a[64:71], v1
    v_smfmac_f32_16x16x64_bf16 v[44:47], v[80:83], a[56:63], v1
    v_smfmac_f32_16x16x64_bf16 v[44:47], v[84:87], a[72:79], v1
    v_smfmac_f32_16x16x64_bf16 v[40:43], v[88:91], a[80:87], v1
    ds_read_b128 v[128:131], v2 offset:8192
    ds_read_b128 v[132:135], v2 offset:9216
    ds_read_b128 v[136:139], v2 offset:10240
    ds_read_b128 v[140:143], v2 offset:11264
    s_waitcnt lgkmcnt(0)
    v_smfmac_f32_16x16x64_bf16 v[40:43], v[92:95], v[128:135], v1
    v_smfmac_f32_16x16x64_bf16 v[44:47], v[88:91], a[88:95], v1
    v_smfmac_f32_16x16x64_bf16 v[44:47], v[92:95], v[136:143], v1
    v_smfmac_f32_16x16x64_bf16 v[48:51], v[80:83], a[144:151], v1
    v_smfmac_f32_16x16x64_bf16 v[48:51], v[84:87], a[160:167], v1
    v_smfmac_f32_16x16x64_bf16 v[48:51], v[88:91], a[176:183], v1
    ds_read_b128 v[128:131], v2 offset:20480
    ds_read_b128 v[132:135], v2 offset:21504
    ds_read_b128 v[136:139], v2 offset:22528
    ds_read_b128 v[140:143], v2 offset:23552
    s_waitcnt lgkmcnt(0)
    v_smfmac_f32_16x16x64_bf16 v[48:51], v[92:95], v[128:135], v1
    v_smfmac_f32_16x16x64_bf16 v[52:55], v[80:83], a[152:159], v1
    v_smfmac_f32_16x16x64_bf16 v[52:55], v[84:87], a[168:175], v1
    v_smfmac_f32_16x16x64_bf16 v[52:55], v[88:91], a[184:191], v1
    v_smfmac_f32_16x16x64_bf16 v[52:55], v[92:95], v[136:143], v1
    ds_read_b128 v[128:131], v2 offset:28672
    ds_read_b128 v[132:135], v2 offset:29696
    v_add_f32 v40, v40, v42
    v_add_f32 v41, v41, v43
    v_add_f32 v44, v44, v46
    v_add_f32 v45, v45, v47
    v_cvt_pk_bf16_f32 v42, v40, v44
    v_cvt_pk_bf16_f32 v43, v41, v45
    ds_write_b32 v6, v42
    ds_write_b32 v6, v43 offset:16
    v_add_f32 v48, v48, v50
    v_add_f32 v49, v49, v51
    s_waitcnt lgkmcnt(0)
    s_branch L_c3_nanok
L_c3_pad6:
    s_branch L_c_warm1
L_c3_done:
    buffer_store_dwordx4 v[52:55], v3, s[4:7], s61 offen sc1
    s_waitcnt vmcnt(0)
    s_endpgm
L_c_end:

.section .rodata,"a"
.p2align 6
.amdhsa_kernel recurrent_scan__memory_aug_recurrent_mem_tr__geglu_ffn__prompt_kernel
  .amdhsa_next_free_vgpr 512
  .amdhsa_next_free_sgpr 102
  .amdhsa_accum_offset 256
  .amdhsa_group_segment_fixed_size 0
  .amdhsa_kernarg_size 112
  .amdhsa_user_sgpr_count 2
  .amdhsa_user_sgpr_kernarg_segment_ptr 1
  .amdhsa_system_sgpr_workgroup_id_x 1
.end_amdhsa_kernel
```
